```python
import torch

def _softmax(x, axis=-1):
    return torch.softmax(x, dim=axis)

def _gelu(x):
    return torch.nn.functional.gelu(x, approximate='tanh')

def _silu(x):
    return torch.nn.functional.silu(x)

def _sigmoid(x):
    return torch.sigmoid(x)

def _layernorm(x, axis=-1, eps=1e-05):
    m = x.mean(dim=axis, keepdim=True)
    v = x.var(dim=axis, keepdim=True, unbiased=False)
    return (x - m) / torch.sqrt(v + eps)

def _scatter_add(tgt, idx, src, axis=0):
    return tgt.clone().index_add_(axis, idx, src)

def _segment_sum(src, seg, n):
    out = torch.zeros((n,) + src.shape[1:], dtype=src.dtype)
    return out.index_add_(0, seg, src)

def _pad(x, pw):
    flat = tuple((v for pair in reversed(pw) for v in pair))
    return torch.nn.functional.pad(x, flat)
kernel_name = 'sequential_preLN__memory_aug_recurrent_mem_tr__glu_gated_bilinear__prompt'

def setup_inputs():

    _w = lambda a: (lambda t: t.to(torch.bfloat16) if t.is_floating_point() else t)(torch.as_tensor(a))

    def _A_setup():
        B, S, Dm = (1, 2048, 512)
        H, Dh = (32, 128)
        M, seg = (8, 32)
        seg = min(seg, S)
        S = S // seg * seg
        return {'x': _w((lambda *s: torch.randn(*s, dtype=torch.bfloat16) * 0.05)(B, S, Dm)), 'mem0': _w((lambda *s: torch.randn(*s, dtype=torch.bfloat16) * 0.2)(B, M, Dm)), 'Wq': _w((lambda *s: torch.randn(*s, dtype=torch.bfloat16) * 1.6)(Dm, H, Dh) * Dm ** (-0.5)), 'Wk': _w((lambda *s: torch.randn(*s, dtype=torch.bfloat16) * 1.6)(Dm, H, Dh) * Dm ** (-0.5)), 'Wv': _w((lambda *s: torch.randn(*s, dtype=torch.bfloat16) * 0.2)(Dm, H, Dh) * Dm ** (-0.5)), 'Wo': _w((lambda *s: torch.randn(*s, dtype=torch.bfloat16) * 0.2)(H, Dh, Dm) * (H * Dh) ** (-0.5)), 'seg_len': seg}
    _A_in = _A_setup()

    def _B_setup():
        B, S, D, F = (1, 2048, 512, 1376)
        return {'x': _w((lambda *s: torch.randn(*s, dtype=torch.bfloat16) * 0.05)(B, S, D)), 'w_gate': _w((lambda *s: torch.randn(*s, dtype=torch.bfloat16) * 0.2)(D, F) * D ** (-0.5)), 'w_up': _w((lambda *s: torch.randn(*s, dtype=torch.bfloat16) * 0.2)(D, F) * D ** (-0.5)), 'w_down': _w((lambda *s: torch.randn(*s, dtype=torch.bfloat16) * 0.2)(F, D) * F ** (-0.5))}
    _B_in = _B_setup()
    return {'A_x': _A_in['x'], 'A_mem0': _A_in['mem0'], 'A_Wq': _A_in['Wq'], 'A_Wk': _A_in['Wk'], 'A_Wv': _A_in['Wv'], 'A_Wo': _A_in['Wo'], 'A_seg_len': _A_in['seg_len'], 'B_x': _B_in['x'], 'B_w_gate': _B_in['w_gate'], 'B_w_up': _B_in['w_up'], 'B_w_down': _B_in['w_down']}

def reference(A_x, A_mem0, A_Wq, A_Wk, A_Wv, A_Wo, A_seg_len, B_x, B_w_gate, B_w_up, B_w_down):

    def _A_ref(x, mem0, Wq, Wk, Wv, Wo, seg_len):
        B, S, Dm = x.shape
        H, Dh = (Wq.shape[1], Wq.shape[2])
        M = mem0.shape[1]
        scale = Dh ** (-0.5)
        n_seg = S // seg_len
        L = M + seg_len
        idx = torch.arange(L)
        mask = (idx[:, None] < M) | (idx[:, None] >= idx[None, :])
        mem = mem0
        outs = []
        for s in range(n_seg):
            xs = x[:, s * seg_len:(s + 1) * seg_len, :].clone()
            h = torch.concatenate([mem, xs], axis=1)
            q = torch.einsum('btd,dhe->bhte', h, Wq)
            k = torch.einsum('btd,dhe->bhte', h, Wk)
            v = torch.einsum('btd,dhe->bhte', h, Wv)
            scores = torch.einsum('bhqe,bhke->bhqk', q, k) * scale
            scores = torch.where(mask[None, None], scores, -1000000000.0)
            p = _softmax(scores, axis=-1)
            o = torch.einsum('bhqk,bhke->bhqe', p, v)
            o = torch.einsum('bhte,hed->btd', o, Wo)
            mem = o[:, :M, :].clone()
            outs.append(o[:, M:, :])
        return torch.concatenate(outs, axis=1)

    def _B_ref(x, w_gate, w_up, w_down):
        g = torch.einsum('bsd,df->bsf', x, w_gate)
        u = torch.einsum('bsd,df->bsf', x, w_up)
        h = g * u
        return torch.einsum('bsf,fd->bsd', h, w_down)
    x = A_x
    h = x + _A_ref(_layernorm(x, axis=-1), A_mem0, A_Wq, A_Wk, A_Wv, A_Wo, A_seg_len)
    h2 = h + _B_ref(_layernorm(h, axis=-1), B_w_gate, B_w_up, B_w_down)
    return h2
```

```asm
; @launch grid=(256,1,1) block=(256,1,1) lds=163840
.amdgcn_target "amdgcn-amd-amdhsa--gfx950"
.text
.globl sequential_preLN__memory_aug_recurrent_mem_tr__glu_gated_bilinear__prompt_kernel
.p2align 8
.type sequential_preLN__memory_aug_recurrent_mem_tr__glu_gated_bilinear__prompt_kernel,@function
sequential_preLN__memory_aug_recurrent_mem_tr__glu_gated_bilinear__prompt_kernel:
    s_cmp_ge_u32 s2, 256
    s_cbranch_scc1 L_EXIT
    s_getreg_b32 s92, hwreg(HW_REG_XCC_ID, 0, 4)
    s_load_dwordx2 s[8:9], s[0:1], 96
    s_and_b32 s92, s92, 7
    s_add_u32 s10, s92, 2
    s_mul_i32 s11, s10, 43
    s_lshr_b32 s11, s11, 7
    s_mul_i32 s12, s11, 3
    s_sub_u32 s10, s10, s12
    s_lshl_b32 s10, s10, 2
    s_lshl_b32 s11, s11, 6
    s_add_u32 s10, s10, s11
    s_cmp_eq_u32 s92, 0
    s_cselect_b32 s10, 0, s10
    s_cmp_eq_u32 s92, 7
    s_cselect_b32 s10, 4, s10
    v_mov_b32 v2, s10
    v_mov_b32 v3, 1
    s_waitcnt lgkmcnt(0)
    v_cmp_eq_u32 vcc, 0, v0
    s_and_saveexec_b64 s[10:11], vcc
    s_cbranch_execz L_NOTICKET
    global_atomic_add v4, v2, v3, s[8:9] sc0
    s_waitcnt vmcnt(0)
    v_mov_b32 v2, 0
    ds_write_b32 v2, v4
    s_waitcnt lgkmcnt(0)
L_NOTICKET:
    s_mov_b64 exec, s[10:11]
    s_barrier
    v_mov_b32 v2, 0
    ds_read_b32 v4, v2
    s_waitcnt lgkmcnt(0)
    v_readfirstlane_b32 s93, v4
    s_barrier
    s_cmp_ge_u32 s93, 32
    s_cbranch_scc1 L_EXIT
    s_cmp_eq_u32 s92, 0
    s_cbranch_scc0 L_WORKER
    s_mov_b32 s12, s93
    s_load_dwordx2 s[4:5], s[0:1], 104
    s_load_dwordx2 s[38:39], s[0:1], 96
    v_lshrrev_b32 v1, 6, v0
    s_nop 0
    v_readfirstlane_b32 s3, v1
    v_and_b32 v0, 63, v0
    s_waitcnt lgkmcnt(0)
    s_mov_b32 s6, 0x10000000
    s_mov_b32 s7, 0x20000
    v_lshlrev_b32 v1, 4, v0
    v_bfe_u32 v22, v0, 1, 1
    v_mov_b32 v23, 0x4444
    v_mov_b32 v20, 0xeeee
    v_cmp_eq_u32 vcc, 1, v22
    s_nop 1
    v_cndmask_b32 v2, v23, v20, vcc
    v_bfe_u32 v22, v0, 3, 1
    v_cmp_eq_u32 vcc, 1, v22
    s_nop 1
    v_cndmask_b32 v3, v23, v20, vcc
    v_bfe_u32 v22, v0, 2, 2
    v_lshlrev_b32 v22, 1, v22
    v_and_b32 v23, 1, v0
    v_add_u32 v22, v22, v23
    v_mul_u32_u24 v22, 1088, v22
    v_lshrrev_b32 v23, 4, v0
    v_lshlrev_b32 v23, 5, v23
    v_add_u32 v22, v22, v23
    v_bfe_u32 v23, v0, 1, 1
    v_lshlrev_b32 v23, 4, v23
    v_add_u32 v22, v22, v23
    v_add_u32 v4, 16384, v22
    s_lshl_b32 s30, s3, 13
    s_add_u32 s30, s30, 32768
    v_add_u32 v5, s30, v1
    v_add_u32 v6, 0x10000, v5
    v_and_b32 v22, 15, v0
    s_lshl_b32 s30, s3, 5
    v_add_u32 v22, s30, v22
    v_lshrrev_b32 v23, 4, v0
    v_lshlrev_b32 v20, 4, v22
    v_lshl_add_u32 v20, v23, 2, v20
    v_add_u32 v7, 25088, v20
    v_lshlrev_b32 v20, 5, v22
    v_lshl_add_u32 v20, v23, 3, v20
    v_add_u32 v8, 27136, v20
    v_lshrrev_b32 v22, 2, v0
    v_and_b32 v23, 1, v0
    v_lshlrev_b32 v20, 4, v22
    v_lshl_add_u32 v20, v23, 3, v20
    v_add_u32 v9, 25088, v20
    v_and_b32 v23, 3, v0
    v_lshlrev_b32 v20, 5, v22
    v_lshl_add_u32 v20, v23, 3, v20
    v_add_u32 v10, 27136, v20
    s_lshl_b32 s30, s3, 11
    s_add_u32 s35, s30, 0
    s_add_u32 s34, s30, 8192
    v_add_u32 v11, s35, v1
    v_lshrrev_b32 v22, 5, v0
    v_lshlrev_b32 v22, 2, v22
    v_bfe_u32 v23, v0, 2, 2
    v_add_u32 v22, v22, v23
    s_lshl_b32 s30, s3, 3
    v_add_u32 v22, s30, v22
    v_lshlrev_b32 v22, 13, v22
    v_bfe_u32 v23, v0, 4, 1
    v_lshlrev_b32 v23, 2, v23
    v_and_b32 v20, 3, v0
    v_add_u32 v23, v23, v20
    v_lshlrev_b32 v23, 4, v23
    s_lshl_b32 s30, s12, 7
    v_add3_u32 v12, v22, v23, s30
    v_bfe_u32 v22, v0, 2, 1
    s_and_b32 s30, s3, 2
    v_add_u32 v22, s30, v22
    v_lshlrev_b32 v22, 5, v22
    v_add_u32 v22, s12, v22
    v_lshlrev_b32 v22, 6, v22
    v_and_b32 v23, 3, v0
    v_lshlrev_b32 v23, 1, v23
    s_and_b32 s30, s3, 1
    v_add_u32 v23, s30, v23
    v_lshl_add_u32 v22, v23, 3, v22
    v_bfe_u32 v23, v0, 4, 1
    v_lshl_add_u32 v22, v23, 2, v22
    v_and_b32 v23, 0x28, v0
    v_mov_b32 v20, 0x40000000
    v_cmp_eq_u32 vcc, 0, v23
    s_nop 1
    v_cndmask_b32 v13, v20, v22, vcc
    v_lshrrev_b32 v22, 2, v0
    v_lshlrev_b32 v22, 7, v22
    v_and_b32 v23, 3, v0
    v_lshl_add_u32 v22, v23, 4, v22
    s_and_b32 s30, s3, 1
    s_lshl_b32 s30, s30, 6
    v_add_u32 v17, s30, v22
    s_lshl_b32 s30, s3, 11
    v_add_u32 v14, s30, v1
    v_and_b32 v22, 3, v0
    v_mul_u32_u24 v22, 1088, v22
    v_lshrrev_b32 v23, 2, v0
    v_lshl_add_u32 v22, v23, 3, v22
    s_lshl_b32 s30, s3, 8
    s_add_u32 s30, s30, 16384
    v_add_u32 v15, s30, v22
    v_and_b32 v22, 31, v0
    v_lshlrev_b32 v22, 6, v22
    s_lshl_b32 s30, s3, 11
    v_add_u32 v22, s30, v22
    v_lshrrev_b32 v23, 5, v0
    v_mul_u32_u24 v23, 0x100, v23
    v_lshlrev_b32 v23, 16, v23
    v_add_u32 v16, v22, v23
    v_mov_b32 v18, -1
    s_mov_b32 s33, 0x3e0293ee
    s_mov_b32 s76, 0x3e0293ee
    s_mov_b32 s77, 0x3e0293ee
    s_mov_b32 s78, 0
    s_lshl_b32 s30, s12, 7
    s_add_u32 s30, s30, 0x4410000
    v_mov_b32 v120, 0
    buffer_store_dword v120, off, s[4:7], s30 sc1
    v_mov_b32 v24, 0
    v_mov_b32 v25, 0
    v_mov_b32 v26, 0
    v_mov_b32 v27, 0
    s_lshl_b32 s30, s12, 13
    s_lshl_b32 s31, s3, 11
    s_add_u32 s30, s30, s31
    s_add_u32 s30, s30, 0x4300000
    s_add_u32 s31, s30, 0x40000
    buffer_store_dwordx4 v[24:27], v1, s[4:7], s30 offen offset:0
    buffer_store_dwordx4 v[24:27], v1, s[4:7], s31 offen offset:0
    buffer_store_dwordx4 v[24:27], v1, s[4:7], s30 offen offset:1024
    buffer_store_dwordx4 v[24:27], v1, s[4:7], s31 offen offset:1024
    s_mov_b32 s30, 0x4400000
    buffer_store_dword v18, v13, s[4:7], s30 offen
    s_mov_b32 s30, 0x4402000
    buffer_store_dword v18, v13, s[4:7], s30 offen
    s_mov_b32 s30, 0x4404000
    buffer_store_dword v18, v13, s[4:7], s30 offen
    s_waitcnt vmcnt(0)
    s_barrier
    s_load_dwordx2 s[96:97], s[0:1], 96
    v_mov_b32 v120, 192
    v_mov_b32 v121, 1
    v_or_b32 v122, s3, v0
    s_waitcnt lgkmcnt(0)
    v_cmp_eq_u32 vcc, 0, v122
    s_and_saveexec_b64 s[98:99], vcc
    s_cbranch_execz L_ADC
    global_atomic_add v120, v121, s[96:97]
L_ADC:
    s_mov_b64 exec, s[98:99]
    s_load_dwordx4 s[48:51], s[0:1], 16
    s_load_dwordx4 s[52:55], s[0:1], 32
    v_bfe_u32 v22, v0, 4, 1
    v_lshlrev_b32 v22, 1, v22
    v_and_b32 v23, 15, v0
    v_xor_b32 v22, v22, v23
    v_xor_b32 v22, 0, v22
    v_lshlrev_b32 v22, 4, v22
    v_lshrrev_b32 v23, 4, v0
    v_lshl_add_u32 v24, v23, 13, v22
    v_bfe_u32 v22, v0, 4, 1
    v_lshlrev_b32 v22, 1, v22
    v_and_b32 v23, 15, v0
    v_xor_b32 v22, v22, v23
    v_xor_b32 v22, 4, v22
    v_lshlrev_b32 v22, 4, v22
    v_lshrrev_b32 v23, 4, v0
    v_lshl_add_u32 v25, v23, 13, v22
    v_bfe_u32 v22, v0, 4, 1
    v_lshlrev_b32 v22, 1, v22
    v_and_b32 v23, 15, v0
    v_xor_b32 v22, v22, v23
    v_xor_b32 v22, 8, v22
    v_lshlrev_b32 v22, 4, v22
    v_lshrrev_b32 v23, 4, v0
    v_lshl_add_u32 v26, v23, 13, v22
    v_bfe_u32 v22, v0, 4, 1
    v_lshlrev_b32 v22, 1, v22
    v_and_b32 v23, 15, v0
    v_xor_b32 v22, v22, v23
    v_xor_b32 v22, 12, v22
    v_lshlrev_b32 v22, 4, v22
    v_lshrrev_b32 v23, 4, v0
    v_lshl_add_u32 v27, v23, 13, v22
    s_lshr_b32 s30, s3, 1
    s_lshl_b32 s30, s30, 3
    v_xor_b32 v22, 0, v0
    v_xor_b32 v22, s30, v22
    v_lshlrev_b32 v28, 4, v22
    v_xor_b32 v22, 4, v0
    v_xor_b32 v22, s30, v22
    v_lshlrev_b32 v29, 4, v22
    v_bfe_u32 v22, v0, 5, 1
    v_lshlrev_b32 v22, 4, v22
    v_bfe_u32 v23, v0, 4, 1
    v_lshl_add_u32 v22, v23, 2, v22
    v_bfe_u32 v23, v0, 3, 1
    v_lshl_add_u32 v22, v23, 3, v22
    v_bfe_u32 v23, v0, 2, 1
    v_add_u32 v22, v22, v23
    v_lshlrev_b32 v32, 8, v22
    v_bfe_u32 v22, v0, 2, 1
    v_lshlrev_b32 v22, 1, v22
    v_bfe_u32 v23, v0, 4, 1
    v_lshl_add_u32 v22, v23, 2, v22
    v_bfe_u32 v23, v0, 3, 1
    v_lshl_add_u32 v22, v23, 3, v22
    v_bfe_u32 v23, v0, 1, 1
    s_lshl_b32 s30, s3, 2
    s_add_u32 s30, s30, 0
    v_add_u32 v23, s30, v23
    v_xor_b32 v22, v22, v23
    v_lshlrev_b32 v22, 4, v22
    v_and_b32 v23, 1, v0
    v_lshl_add_u32 v22, v23, 3, v22
    v_add_u32 v32, v32, v22
    v_bfe_u32 v22, v0, 5, 1
    v_lshlrev_b32 v22, 4, v22
    v_bfe_u32 v23, v0, 4, 1
    v_lshl_add_u32 v22, v23, 2, v22
    v_bfe_u32 v23, v0, 3, 1
    v_lshl_add_u32 v22, v23, 3, v22
    v_bfe_u32 v23, v0, 2, 1
    v_add_u32 v22, v22, v23
    v_lshlrev_b32 v33, 8, v22
    v_bfe_u32 v22, v0, 2, 1
    v_lshlrev_b32 v22, 1, v22
    v_bfe_u32 v23, v0, 4, 1
    v_lshl_add_u32 v22, v23, 2, v22
    v_bfe_u32 v23, v0, 3, 1
    v_lshl_add_u32 v22, v23, 3, v22
    v_bfe_u32 v23, v0, 1, 1
    s_lshl_b32 s30, s3, 2
    s_add_u32 s30, s30, 2
    v_add_u32 v23, s30, v23
    v_xor_b32 v22, v22, v23
    v_lshlrev_b32 v22, 4, v22
    v_and_b32 v23, 1, v0
    v_lshl_add_u32 v22, v23, 3, v22
    v_add_u32 v33, v33, v22
    v_bfe_u32 v22, v0, 4, 1
    v_lshlrev_b32 v22, 4, v22
    v_bfe_u32 v23, v0, 5, 1
    v_lshl_add_u32 v22, v23, 2, v22
    v_bfe_u32 v23, v0, 2, 1
    v_add_u32 v22, v22, v23
    v_lshlrev_b32 v34, 10, v22
    v_bfe_u32 v22, v0, 2, 1
    v_lshlrev_b32 v22, 2, v22
    v_bfe_u32 v23, v0, 4, 1
    v_lshl_add_u32 v22, v23, 3, v22
    v_bfe_u32 v23, v0, 3, 1
    v_lshlrev_b32 v23, 1, v23
    v_bfe_u32 v20, v0, 1, 1
    v_add_u32 v23, v23, v20
    s_lshl_b32 s30, s3, 2
    v_add_u32 v23, s30, v23
    v_xor_b32 v22, v22, v23
    v_lshlrev_b32 v22, 4, v22
    v_and_b32 v23, 1, v0
    v_lshl_add_u32 v22, v23, 3, v22
    v_add_u32 v34, v34, v22
    s_waitcnt lgkmcnt(0)
    s_mov_b32 s56, s48
    s_mov_b32 s57, s49
    s_mov_b32 s58, 0x400000
    s_mov_b32 s59, 0x20000
    s_mov_b32 s60, s50
    s_mov_b32 s61, s51
    s_mov_b32 s62, 0x400000
    s_mov_b32 s63, 0x20000
    s_mov_b32 s64, s52
    s_mov_b32 s65, s53
    s_mov_b32 s66, 0x400000
    s_mov_b32 s67, 0x20000
    s_mov_b32 s68, s54
    s_mov_b32 s69, s55
    s_mov_b32 s70, 0x400000
    s_mov_b32 s71, 0x20000
    s_cmp_lt_u32 s3, 2
    s_cselect_b32 s72, s56, s60
    s_cselect_b32 s73, s57, s61
    s_mov_b32 s74, 0x400000
    s_mov_b32 s75, 0x20000
    s_lshl_b32 s30, s3, 5
    s_add_u32 s30, s30, 0
    s_lshl_b32 s30, s30, 13
    s_lshl_b32 s32, s12, 8
    s_add_u32 s30, s30, s32
    s_lshl_b32 s31, s3, 13
    s_add_u32 s31, s31, 131072
    s_mov_b32 m0, s31
    s_add_u32 s31, s31, 1024
    buffer_load_dwordx4 v24, s[64:67], s30 offen lds
    s_add_u32 s30, s30, 32768
    s_mov_b32 m0, s31
    s_add_u32 s31, s31, 1024
    buffer_load_dwordx4 v25, s[64:67], s30 offen lds
    s_add_u32 s30, s30, 32768
    s_mov_b32 m0, s31
    s_add_u32 s31, s31, 1024
    buffer_load_dwordx4 v26, s[64:67], s30 offen lds
    s_add_u32 s30, s30, 32768
    s_mov_b32 m0, s31
    s_add_u32 s31, s31, 1024
    buffer_load_dwordx4 v27, s[64:67], s30 offen lds
    s_add_u32 s30, s30, 32768
    s_mov_b32 m0, s31
    s_add_u32 s31, s31, 1024
    buffer_load_dwordx4 v24, s[64:67], s30 offen lds
    s_add_u32 s30, s30, 32768
    s_mov_b32 m0, s31
    s_add_u32 s31, s31, 1024
    buffer_load_dwordx4 v25, s[64:67], s30 offen lds
    s_add_u32 s30, s30, 32768
    s_mov_b32 m0, s31
    s_add_u32 s31, s31, 1024
    buffer_load_dwordx4 v26, s[64:67], s30 offen lds
    s_add_u32 s30, s30, 32768
    s_mov_b32 m0, s31
    s_add_u32 s31, s31, 1024
    buffer_load_dwordx4 v27, s[64:67], s30 offen lds
    s_add_u32 s30, s30, 32768
    s_lshl_b32 s30, s3, 5
    s_add_u32 s30, s30, 128
    s_lshl_b32 s30, s30, 13
    s_lshl_b32 s32, s12, 8
    s_add_u32 s30, s30, s32
    s_lshl_b32 s31, s3, 13
    s_add_u32 s31, s31, 0
    s_mov_b32 m0, s31
    s_add_u32 s31, s31, 1024
    buffer_load_dwordx4 v24, s[64:67], s30 offen lds
    s_add_u32 s30, s30, 32768
    s_mov_b32 m0, s31
    s_add_u32 s31, s31, 1024
    buffer_load_dwordx4 v25, s[64:67], s30 offen lds
    s_add_u32 s30, s30, 32768
    s_mov_b32 m0, s31
    s_add_u32 s31, s31, 1024
    buffer_load_dwordx4 v26, s[64:67], s30 offen lds
    s_add_u32 s30, s30, 32768
    s_mov_b32 m0, s31
    s_add_u32 s31, s31, 1024
    buffer_load_dwordx4 v27, s[64:67], s30 offen lds
    s_add_u32 s30, s30, 32768
    s_mov_b32 m0, s31
    s_add_u32 s31, s31, 1024
    buffer_load_dwordx4 v24, s[64:67], s30 offen lds
    s_add_u32 s30, s30, 32768
    s_mov_b32 m0, s31
    s_add_u32 s31, s31, 1024
    buffer_load_dwordx4 v25, s[64:67], s30 offen lds
    s_add_u32 s30, s30, 32768
    s_mov_b32 m0, s31
    s_add_u32 s31, s31, 1024
    buffer_load_dwordx4 v26, s[64:67], s30 offen lds
    s_add_u32 s30, s30, 32768
    s_mov_b32 m0, s31
    s_add_u32 s31, s31, 1024
    buffer_load_dwordx4 v27, s[64:67], s30 offen lds
    s_add_u32 s30, s30, 32768
    s_lshl_b32 s30, s3, 5
    s_add_u32 s30, s30, 256
    s_lshl_b32 s30, s30, 13
    s_lshl_b32 s32, s12, 8
    s_add_u32 s30, s30, s32
    s_lshl_b32 s31, s3, 13
    s_add_u32 s31, s31, 32768
    s_mov_b32 m0, s31
    s_add_u32 s31, s31, 1024
    buffer_load_dwordx4 v24, s[64:67], s30 offen lds
    s_add_u32 s30, s30, 32768
    s_mov_b32 m0, s31
    s_add_u32 s31, s31, 1024
    buffer_load_dwordx4 v25, s[64:67], s30 offen lds
    s_add_u32 s30, s30, 32768
    s_mov_b32 m0, s31
    s_add_u32 s31, s31, 1024
    buffer_load_dwordx4 v26, s[64:67], s30 offen lds
    s_add_u32 s30, s30, 32768
    s_mov_b32 m0, s31
    s_add_u32 s31, s31, 1024
    buffer_load_dwordx4 v27, s[64:67], s30 offen lds
    s_add_u32 s30, s30, 32768
    s_mov_b32 m0, s31
    s_add_u32 s31, s31, 1024
    buffer_load_dwordx4 v24, s[64:67], s30 offen lds
    s_add_u32 s30, s30, 32768
    s_mov_b32 m0, s31
    s_add_u32 s31, s31, 1024
    buffer_load_dwordx4 v25, s[64:67], s30 offen lds
    s_add_u32 s30, s30, 32768
    s_mov_b32 m0, s31
    s_add_u32 s31, s31, 1024
    buffer_load_dwordx4 v26, s[64:67], s30 offen lds
    s_add_u32 s30, s30, 32768
    s_mov_b32 m0, s31
    s_add_u32 s31, s31, 1024
    buffer_load_dwordx4 v27, s[64:67], s30 offen lds
    s_add_u32 s30, s30, 32768
    s_lshl_b32 s30, s3, 5
    s_add_u32 s30, s30, 384
    s_lshl_b32 s30, s30, 13
    s_lshl_b32 s32, s12, 8
    s_add_u32 s30, s30, s32
    s_lshl_b32 s31, s3, 13
    s_add_u32 s31, s31, 65536
    s_mov_b32 m0, s31
    s_add_u32 s31, s31, 1024
    buffer_load_dwordx4 v24, s[64:67], s30 offen lds
    s_add_u32 s30, s30, 32768
    s_mov_b32 m0, s31
    s_add_u32 s31, s31, 1024
    buffer_load_dwordx4 v25, s[64:67], s30 offen lds
    s_add_u32 s30, s30, 32768
    s_mov_b32 m0, s31
    s_add_u32 s31, s31, 1024
    buffer_load_dwordx4 v26, s[64:67], s30 offen lds
    s_add_u32 s30, s30, 32768
    s_mov_b32 m0, s31
    s_add_u32 s31, s31, 1024
    buffer_load_dwordx4 v27, s[64:67], s30 offen lds
    s_add_u32 s30, s30, 32768
    s_mov_b32 m0, s31
    s_add_u32 s31, s31, 1024
    buffer_load_dwordx4 v24, s[64:67], s30 offen lds
    s_add_u32 s30, s30, 32768
    s_mov_b32 m0, s31
    s_add_u32 s31, s31, 1024
    buffer_load_dwordx4 v25, s[64:67], s30 offen lds
    s_add_u32 s30, s30, 32768
    s_mov_b32 m0, s31
    s_add_u32 s31, s31, 1024
    buffer_load_dwordx4 v26, s[64:67], s30 offen lds
    s_add_u32 s30, s30, 32768
    s_mov_b32 m0, s31
    s_add_u32 s31, s31, 1024
    buffer_load_dwordx4 v27, s[64:67], s30 offen lds
    s_add_u32 s30, s30, 32768
    s_lshl_b32 s30, s12, 7
    s_lshl_b32 s32, s3, 3
    s_add_u32 s30, s30, s32
    s_add_u32 s30, s30, 0
    s_lshl_b32 s30, s30, 10
    s_lshl_b32 s31, s3, 13
    s_add_u32 s31, s31, 98304
    s_mov_b32 m0, s31
    s_add_u32 s31, s31, 1024
    buffer_load_dwordx4 v28, s[68:71], s30 offen lds
    s_add_u32 s30, s30, 1024
    s_mov_b32 m0, s31
    s_add_u32 s31, s31, 1024
    buffer_load_dwordx4 v29, s[68:71], s30 offen lds
    s_add_u32 s30, s30, 1024
    s_mov_b32 m0, s31
    s_add_u32 s31, s31, 1024
    buffer_load_dwordx4 v28, s[68:71], s30 offen lds
    s_add_u32 s30, s30, 1024
    s_mov_b32 m0, s31
    s_add_u32 s31, s31, 1024
    buffer_load_dwordx4 v29, s[68:71], s30 offen lds
    s_add_u32 s30, s30, 1024
    s_mov_b32 m0, s31
    s_add_u32 s31, s31, 1024
    buffer_load_dwordx4 v28, s[68:71], s30 offen lds
    s_add_u32 s30, s30, 1024
    s_mov_b32 m0, s31
    s_add_u32 s31, s31, 1024
    buffer_load_dwordx4 v29, s[68:71], s30 offen lds
    s_add_u32 s30, s30, 1024
    s_mov_b32 m0, s31
    s_add_u32 s31, s31, 1024
    buffer_load_dwordx4 v28, s[68:71], s30 offen lds
    s_add_u32 s30, s30, 1024
    s_mov_b32 m0, s31
    s_add_u32 s31, s31, 1024
    buffer_load_dwordx4 v29, s[68:71], s30 offen lds
    s_add_u32 s30, s30, 1024
    s_waitcnt vmcnt(32)
    s_barrier
    v_add_u32 v36, 131072, v32
    v_add_u32 v37, 131072, v33
    ds_read_b64_tr_b16 a[0:1], v36 offset:0
    ds_read_b64_tr_b16 a[2:3], v36 offset:512
    ds_read_b64_tr_b16 a[4:5], v36 offset:8192
    ds_read_b64_tr_b16 a[6:7], v36 offset:8704
    ds_read_b64_tr_b16 a[8:9], v37 offset:0
    ds_read_b64_tr_b16 a[10:11], v37 offset:512
    ds_read_b64_tr_b16 a[12:13], v37 offset:8192
    ds_read_b64_tr_b16 a[14:15], v37 offset:8704
    ds_read_b64_tr_b16 a[16:17], v36 offset:16384
    ds_read_b64_tr_b16 a[18:19], v36 offset:16896
    ds_read_b64_tr_b16 a[20:21], v36 offset:24576
    ds_read_b64_tr_b16 a[22:23], v36 offset:25088
    ds_read_b64_tr_b16 a[24:25], v37 offset:16384
    ds_read_b64_tr_b16 a[26:27], v37 offset:16896
    ds_read_b64_tr_b16 a[28:29], v37 offset:24576
    ds_read_b64_tr_b16 a[30:31], v37 offset:25088
    s_waitcnt lgkmcnt(0)
    s_barrier
    s_lshl_b32 s30, s12, 7
    s_lshl_b32 s32, s3, 3
    s_add_u32 s30, s30, s32
    s_add_u32 s30, s30, 32
    s_lshl_b32 s30, s30, 10
    s_lshl_b32 s31, s3, 13
    s_add_u32 s31, s31, 131072
    s_mov_b32 m0, s31
    s_add_u32 s31, s31, 1024
    buffer_load_dwordx4 v28, s[68:71], s30 offen lds
    s_add_u32 s30, s30, 1024
    s_mov_b32 m0, s31
    s_add_u32 s31, s31, 1024
    buffer_load_dwordx4 v29, s[68:71], s30 offen lds
    s_add_u32 s30, s30, 1024
    s_mov_b32 m0, s31
    s_add_u32 s31, s31, 1024
    buffer_load_dwordx4 v28, s[68:71], s30 offen lds
    s_add_u32 s30, s30, 1024
    s_mov_b32 m0, s31
    s_add_u32 s31, s31, 1024
    buffer_load_dwordx4 v29, s[68:71], s30 offen lds
    s_add_u32 s30, s30, 1024
    s_mov_b32 m0, s31
    s_add_u32 s31, s31, 1024
    buffer_load_dwordx4 v28, s[68:71], s30 offen lds
    s_add_u32 s30, s30, 1024
    s_mov_b32 m0, s31
    s_add_u32 s31, s31, 1024
    buffer_load_dwordx4 v29, s[68:71], s30 offen lds
    s_add_u32 s30, s30, 1024
    s_mov_b32 m0, s31
    s_add_u32 s31, s31, 1024
    buffer_load_dwordx4 v28, s[68:71], s30 offen lds
    s_add_u32 s30, s30, 1024
    s_mov_b32 m0, s31
    s_add_u32 s31, s31, 1024
    buffer_load_dwordx4 v29, s[68:71], s30 offen lds
    s_add_u32 s30, s30, 1024
    s_waitcnt vmcnt(32)
    s_barrier
    v_add_u32 v36, 0, v32
    v_add_u32 v37, 0, v33
    ds_read_b64_tr_b16 a[32:33], v36 offset:0
    ds_read_b64_tr_b16 a[34:35], v36 offset:512
    ds_read_b64_tr_b16 a[36:37], v36 offset:8192
    ds_read_b64_tr_b16 a[38:39], v36 offset:8704
    ds_read_b64_tr_b16 a[40:41], v37 offset:0
    ds_read_b64_tr_b16 a[42:43], v37 offset:512
    ds_read_b64_tr_b16 a[44:45], v37 offset:8192
    ds_read_b64_tr_b16 a[46:47], v37 offset:8704
    ds_read_b64_tr_b16 a[48:49], v36 offset:16384
    ds_read_b64_tr_b16 a[50:51], v36 offset:16896
    ds_read_b64_tr_b16 a[52:53], v36 offset:24576
    ds_read_b64_tr_b16 a[54:55], v36 offset:25088
    ds_read_b64_tr_b16 a[56:57], v37 offset:16384
    ds_read_b64_tr_b16 a[58:59], v37 offset:16896
    ds_read_b64_tr_b16 a[60:61], v37 offset:24576
    ds_read_b64_tr_b16 a[62:63], v37 offset:25088
    s_waitcnt lgkmcnt(0)
    s_barrier
    s_lshl_b32 s30, s12, 7
    s_lshl_b32 s32, s3, 3
    s_add_u32 s30, s30, s32
    s_add_u32 s30, s30, 64
    s_lshl_b32 s30, s30, 10
    s_lshl_b32 s31, s3, 13
    s_add_u32 s31, s31, 0
    s_mov_b32 m0, s31
    s_add_u32 s31, s31, 1024
    buffer_load_dwordx4 v28, s[68:71], s30 offen lds
    s_add_u32 s30, s30, 1024
    s_mov_b32 m0, s31
    s_add_u32 s31, s31, 1024
    buffer_load_dwordx4 v29, s[68:71], s30 offen lds
    s_add_u32 s30, s30, 1024
    s_mov_b32 m0, s31
    s_add_u32 s31, s31, 1024
    buffer_load_dwordx4 v28, s[68:71], s30 offen lds
    s_add_u32 s30, s30, 1024
    s_mov_b32 m0, s31
    s_add_u32 s31, s31, 1024
    buffer_load_dwordx4 v29, s[68:71], s30 offen lds
    s_add_u32 s30, s30, 1024
    s_mov_b32 m0, s31
    s_add_u32 s31, s31, 1024
    buffer_load_dwordx4 v28, s[68:71], s30 offen lds
    s_add_u32 s30, s30, 1024
    s_mov_b32 m0, s31
    s_add_u32 s31, s31, 1024
    buffer_load_dwordx4 v29, s[68:71], s30 offen lds
    s_add_u32 s30, s30, 1024
    s_mov_b32 m0, s31
    s_add_u32 s31, s31, 1024
    buffer_load_dwordx4 v28, s[68:71], s30 offen lds
    s_add_u32 s30, s30, 1024
    s_mov_b32 m0, s31
    s_add_u32 s31, s31, 1024
    buffer_load_dwordx4 v29, s[68:71], s30 offen lds
    s_add_u32 s30, s30, 1024
    s_waitcnt vmcnt(32)
    s_barrier
    v_add_u32 v36, 32768, v32
    v_add_u32 v37, 32768, v33
    ds_read_b64_tr_b16 a[64:65], v36 offset:0
    ds_read_b64_tr_b16 a[66:67], v36 offset:512
    ds_read_b64_tr_b16 a[68:69], v36 offset:8192
    ds_read_b64_tr_b16 a[70:71], v36 offset:8704
    ds_read_b64_tr_b16 a[72:73], v37 offset:0
    ds_read_b64_tr_b16 a[74:75], v37 offset:512
    ds_read_b64_tr_b16 a[76:77], v37 offset:8192
    ds_read_b64_tr_b16 a[78:79], v37 offset:8704
    ds_read_b64_tr_b16 a[80:81], v36 offset:16384
    ds_read_b64_tr_b16 a[82:83], v36 offset:16896
    ds_read_b64_tr_b16 a[84:85], v36 offset:24576
    ds_read_b64_tr_b16 a[86:87], v36 offset:25088
    ds_read_b64_tr_b16 a[88:89], v37 offset:16384
    ds_read_b64_tr_b16 a[90:91], v37 offset:16896
    ds_read_b64_tr_b16 a[92:93], v37 offset:24576
    ds_read_b64_tr_b16 a[94:95], v37 offset:25088
    s_waitcnt lgkmcnt(0)
    s_barrier
    s_lshl_b32 s30, s12, 7
    s_lshl_b32 s32, s3, 3
    s_add_u32 s30, s30, s32
    s_add_u32 s30, s30, 96
    s_lshl_b32 s30, s30, 10
    s_lshl_b32 s31, s3, 13
    s_add_u32 s31, s31, 32768
    s_mov_b32 m0, s31
    s_add_u32 s31, s31, 1024
    buffer_load_dwordx4 v28, s[68:71], s30 offen lds
    s_add_u32 s30, s30, 1024
    s_mov_b32 m0, s31
    s_add_u32 s31, s31, 1024
    buffer_load_dwordx4 v29, s[68:71], s30 offen lds
    s_add_u32 s30, s30, 1024
    s_mov_b32 m0, s31
    s_add_u32 s31, s31, 1024
    buffer_load_dwordx4 v28, s[68:71], s30 offen lds
    s_add_u32 s30, s30, 1024
    s_mov_b32 m0, s31
    s_add_u32 s31, s31, 1024
    buffer_load_dwordx4 v29, s[68:71], s30 offen lds
    s_add_u32 s30, s30, 1024
    s_mov_b32 m0, s31
    s_add_u32 s31, s31, 1024
    buffer_load_dwordx4 v28, s[68:71], s30 offen lds
    s_add_u32 s30, s30, 1024
    s_mov_b32 m0, s31
    s_add_u32 s31, s31, 1024
    buffer_load_dwordx4 v29, s[68:71], s30 offen lds
    s_add_u32 s30, s30, 1024
    s_mov_b32 m0, s31
    s_add_u32 s31, s31, 1024
    buffer_load_dwordx4 v28, s[68:71], s30 offen lds
    s_add_u32 s30, s30, 1024
    s_mov_b32 m0, s31
    s_add_u32 s31, s31, 1024
    buffer_load_dwordx4 v29, s[68:71], s30 offen lds
    s_add_u32 s30, s30, 1024
    s_waitcnt vmcnt(32)
    s_barrier
    v_add_u32 v36, 65536, v32
    v_add_u32 v37, 65536, v33
    ds_read_b64_tr_b16 a[96:97], v36 offset:0
    ds_read_b64_tr_b16 a[98:99], v36 offset:512
    ds_read_b64_tr_b16 a[100:101], v36 offset:8192
    ds_read_b64_tr_b16 a[102:103], v36 offset:8704
    ds_read_b64_tr_b16 a[104:105], v37 offset:0
    ds_read_b64_tr_b16 a[106:107], v37 offset:512
    ds_read_b64_tr_b16 a[108:109], v37 offset:8192
    ds_read_b64_tr_b16 a[110:111], v37 offset:8704
    ds_read_b64_tr_b16 a[112:113], v36 offset:16384
    ds_read_b64_tr_b16 a[114:115], v36 offset:16896
    ds_read_b64_tr_b16 a[116:117], v36 offset:24576
    ds_read_b64_tr_b16 a[118:119], v36 offset:25088
    ds_read_b64_tr_b16 a[120:121], v37 offset:16384
    ds_read_b64_tr_b16 a[122:123], v37 offset:16896
    ds_read_b64_tr_b16 a[124:125], v37 offset:24576
    ds_read_b64_tr_b16 a[126:127], v37 offset:25088
    s_waitcnt lgkmcnt(0)
    s_barrier
    s_and_b32 s30, s3, 1
    s_lshl_b32 s30, s30, 5
    s_add_u32 s30, s30, 128
    s_lshl_b32 s30, s30, 13
    s_lshl_b32 s32, s12, 8
    s_add_u32 s30, s30, s32
    s_lshl_b32 s31, s3, 13
    s_add_u32 s31, s31, 65536
    s_mov_b32 m0, s31
    s_add_u32 s31, s31, 1024
    buffer_load_dwordx4 v24, s[72:75], s30 offen lds
    s_add_u32 s30, s30, 32768
    s_mov_b32 m0, s31
    s_add_u32 s31, s31, 1024
    buffer_load_dwordx4 v25, s[72:75], s30 offen lds
    s_add_u32 s30, s30, 32768
    s_mov_b32 m0, s31
    s_add_u32 s31, s31, 1024
    buffer_load_dwordx4 v26, s[72:75], s30 offen lds
    s_add_u32 s30, s30, 32768
    s_mov_b32 m0, s31
    s_add_u32 s31, s31, 1024
    buffer_load_dwordx4 v27, s[72:75], s30 offen lds
    s_add_u32 s30, s30, 32768
    s_mov_b32 m0, s31
    s_add_u32 s31, s31, 1024
    buffer_load_dwordx4 v24, s[72:75], s30 offen lds
    s_add_u32 s30, s30, 32768
    s_mov_b32 m0, s31
    s_add_u32 s31, s31, 1024
    buffer_load_dwordx4 v25, s[72:75], s30 offen lds
    s_add_u32 s30, s30, 32768
    s_mov_b32 m0, s31
    s_add_u32 s31, s31, 1024
    buffer_load_dwordx4 v26, s[72:75], s30 offen lds
    s_add_u32 s30, s30, 32768
    s_mov_b32 m0, s31
    s_add_u32 s31, s31, 1024
    buffer_load_dwordx4 v27, s[72:75], s30 offen lds
    s_add_u32 s30, s30, 32768
    s_waitcnt vmcnt(32)
    s_barrier
    v_add_u32 v38, 98304, v34
    s_cmp_lg_u32 s3, 0
    s_cbranch_scc1 L_WO0_1
    ds_read_b64_tr_b16 a[128:129], v38 offset:0
    ds_read_b64_tr_b16 a[130:131], v38 offset:2048
    ds_read_b64_tr_b16 a[132:133], v38 offset:8192
    ds_read_b64_tr_b16 a[134:135], v38 offset:10240
    ds_read_b64_tr_b16 a[160:161], v38 offset:256
    ds_read_b64_tr_b16 a[162:163], v38 offset:2304
    ds_read_b64_tr_b16 a[164:165], v38 offset:8448
    ds_read_b64_tr_b16 a[166:167], v38 offset:10496
    ds_read_b64_tr_b16 a[192:193], v38 offset:512
    ds_read_b64_tr_b16 a[194:195], v38 offset:2560
    ds_read_b64_tr_b16 a[196:197], v38 offset:8704
    ds_read_b64_tr_b16 a[198:199], v38 offset:10752
    ds_read_b64_tr_b16 a[224:225], v38 offset:768
    ds_read_b64_tr_b16 a[226:227], v38 offset:2816
    ds_read_b64_tr_b16 a[228:229], v38 offset:8960
    ds_read_b64_tr_b16 a[230:231], v38 offset:11008
    s_branch L_WO0_E
L_WO0_1:
    s_cmp_lg_u32 s3, 1
    s_cbranch_scc1 L_WO0_2
    ds_read_b64_tr_b16 a[136:137], v38 offset:0
    ds_read_b64_tr_b16 a[138:139], v38 offset:2048
    ds_read_b64_tr_b16 a[140:141], v38 offset:8192
    ds_read_b64_tr_b16 a[142:143], v38 offset:10240
    ds_read_b64_tr_b16 a[168:169], v38 offset:256
    ds_read_b64_tr_b16 a[170:171], v38 offset:2304
    ds_read_b64_tr_b16 a[172:173], v38 offset:8448
    ds_read_b64_tr_b16 a[174:175], v38 offset:10496
    ds_read_b64_tr_b16 a[200:201], v38 offset:512
    ds_read_b64_tr_b16 a[202:203], v38 offset:2560
    ds_read_b64_tr_b16 a[204:205], v38 offset:8704
    ds_read_b64_tr_b16 a[206:207], v38 offset:10752
    ds_read_b64_tr_b16 a[232:233], v38 offset:768
    ds_read_b64_tr_b16 a[234:235], v38 offset:2816
    ds_read_b64_tr_b16 a[236:237], v38 offset:8960
    ds_read_b64_tr_b16 a[238:239], v38 offset:11008
    s_branch L_WO0_E
L_WO0_2:
    s_cmp_lg_u32 s3, 2
    s_cbranch_scc1 L_WO0_3
    ds_read_b64_tr_b16 a[144:145], v38 offset:0
    ds_read_b64_tr_b16 a[146:147], v38 offset:2048
    ds_read_b64_tr_b16 a[148:149], v38 offset:8192
    ds_read_b64_tr_b16 a[150:151], v38 offset:10240
    ds_read_b64_tr_b16 a[176:177], v38 offset:256
    ds_read_b64_tr_b16 a[178:179], v38 offset:2304
    ds_read_b64_tr_b16 a[180:181], v38 offset:8448
    ds_read_b64_tr_b16 a[182:183], v38 offset:10496
    ds_read_b64_tr_b16 a[208:209], v38 offset:512
    ds_read_b64_tr_b16 a[210:211], v38 offset:2560
    ds_read_b64_tr_b16 a[212:213], v38 offset:8704
    ds_read_b64_tr_b16 a[214:215], v38 offset:10752
    ds_read_b64_tr_b16 a[240:241], v38 offset:768
    ds_read_b64_tr_b16 a[242:243], v38 offset:2816
    ds_read_b64_tr_b16 a[244:245], v38 offset:8960
    ds_read_b64_tr_b16 a[246:247], v38 offset:11008
    s_branch L_WO0_E
L_WO0_3:
    ds_read_b64_tr_b16 a[152:153], v38 offset:0
    ds_read_b64_tr_b16 a[154:155], v38 offset:2048
    ds_read_b64_tr_b16 a[156:157], v38 offset:8192
    ds_read_b64_tr_b16 a[158:159], v38 offset:10240
    ds_read_b64_tr_b16 a[184:185], v38 offset:256
    ds_read_b64_tr_b16 a[186:187], v38 offset:2304
    ds_read_b64_tr_b16 a[188:189], v38 offset:8448
    ds_read_b64_tr_b16 a[190:191], v38 offset:10496
    ds_read_b64_tr_b16 a[216:217], v38 offset:512
    ds_read_b64_tr_b16 a[218:219], v38 offset:2560
    ds_read_b64_tr_b16 a[220:221], v38 offset:8704
    ds_read_b64_tr_b16 a[222:223], v38 offset:10752
    ds_read_b64_tr_b16 a[248:249], v38 offset:768
    ds_read_b64_tr_b16 a[250:251], v38 offset:2816
    ds_read_b64_tr_b16 a[252:253], v38 offset:8960
    ds_read_b64_tr_b16 a[254:255], v38 offset:11008
L_WO0_E:
    s_waitcnt lgkmcnt(0)
    s_barrier
    s_and_b32 s30, s3, 1
    s_lshl_b32 s30, s30, 5
    s_add_u32 s30, s30, 192
    s_lshl_b32 s30, s30, 13
    s_lshl_b32 s32, s12, 8
    s_add_u32 s30, s30, s32
    s_lshl_b32 s31, s3, 13
    s_add_u32 s31, s31, 98304
    s_mov_b32 m0, s31
    s_add_u32 s31, s31, 1024
    buffer_load_dwordx4 v24, s[72:75], s30 offen lds
    s_add_u32 s30, s30, 32768
    s_mov_b32 m0, s31
    s_add_u32 s31, s31, 1024
    buffer_load_dwordx4 v25, s[72:75], s30 offen lds
    s_add_u32 s30, s30, 32768
    s_mov_b32 m0, s31
    s_add_u32 s31, s31, 1024
    buffer_load_dwordx4 v26, s[72:75], s30 offen lds
    s_add_u32 s30, s30, 32768
    s_mov_b32 m0, s31
    s_add_u32 s31, s31, 1024
    buffer_load_dwordx4 v27, s[72:75], s30 offen lds
    s_add_u32 s30, s30, 32768
    s_mov_b32 m0, s31
    s_add_u32 s31, s31, 1024
    buffer_load_dwordx4 v24, s[72:75], s30 offen lds
    s_add_u32 s30, s30, 32768
    s_mov_b32 m0, s31
    s_add_u32 s31, s31, 1024
    buffer_load_dwordx4 v25, s[72:75], s30 offen lds
    s_add_u32 s30, s30, 32768
    s_mov_b32 m0, s31
    s_add_u32 s31, s31, 1024
    buffer_load_dwordx4 v26, s[72:75], s30 offen lds
    s_add_u32 s30, s30, 32768
    s_mov_b32 m0, s31
    s_add_u32 s31, s31, 1024
    buffer_load_dwordx4 v27, s[72:75], s30 offen lds
    s_add_u32 s30, s30, 32768
    s_waitcnt vmcnt(32)
    s_barrier
    v_add_u32 v38, 131072, v34
    s_cmp_lg_u32 s3, 0
    s_cbranch_scc1 L_WO1_1
    ds_read_b64_tr_b16 a[136:137], v38 offset:0
    ds_read_b64_tr_b16 a[138:139], v38 offset:2048
    ds_read_b64_tr_b16 a[140:141], v38 offset:8192
    ds_read_b64_tr_b16 a[142:143], v38 offset:10240
    ds_read_b64_tr_b16 a[168:169], v38 offset:256
    ds_read_b64_tr_b16 a[170:171], v38 offset:2304
    ds_read_b64_tr_b16 a[172:173], v38 offset:8448
    ds_read_b64_tr_b16 a[174:175], v38 offset:10496
    ds_read_b64_tr_b16 a[200:201], v38 offset:512
    ds_read_b64_tr_b16 a[202:203], v38 offset:2560
    ds_read_b64_tr_b16 a[204:205], v38 offset:8704
    ds_read_b64_tr_b16 a[206:207], v38 offset:10752
    ds_read_b64_tr_b16 a[232:233], v38 offset:768
    ds_read_b64_tr_b16 a[234:235], v38 offset:2816
    ds_read_b64_tr_b16 a[236:237], v38 offset:8960
    ds_read_b64_tr_b16 a[238:239], v38 offset:11008
    s_branch L_WO1_E
L_WO1_1:
    s_cmp_lg_u32 s3, 1
    s_cbranch_scc1 L_WO1_2
    ds_read_b64_tr_b16 a[128:129], v38 offset:0
    ds_read_b64_tr_b16 a[130:131], v38 offset:2048
    ds_read_b64_tr_b16 a[132:133], v38 offset:8192
    ds_read_b64_tr_b16 a[134:135], v38 offset:10240
    ds_read_b64_tr_b16 a[160:161], v38 offset:256
    ds_read_b64_tr_b16 a[162:163], v38 offset:2304
    ds_read_b64_tr_b16 a[164:165], v38 offset:8448
    ds_read_b64_tr_b16 a[166:167], v38 offset:10496
    ds_read_b64_tr_b16 a[192:193], v38 offset:512
    ds_read_b64_tr_b16 a[194:195], v38 offset:2560
    ds_read_b64_tr_b16 a[196:197], v38 offset:8704
    ds_read_b64_tr_b16 a[198:199], v38 offset:10752
    ds_read_b64_tr_b16 a[224:225], v38 offset:768
    ds_read_b64_tr_b16 a[226:227], v38 offset:2816
    ds_read_b64_tr_b16 a[228:229], v38 offset:8960
    ds_read_b64_tr_b16 a[230:231], v38 offset:11008
    s_branch L_WO1_E
L_WO1_2:
    s_cmp_lg_u32 s3, 2
    s_cbranch_scc1 L_WO1_3
    ds_read_b64_tr_b16 a[152:153], v38 offset:0
    ds_read_b64_tr_b16 a[154:155], v38 offset:2048
    ds_read_b64_tr_b16 a[156:157], v38 offset:8192
    ds_read_b64_tr_b16 a[158:159], v38 offset:10240
    ds_read_b64_tr_b16 a[184:185], v38 offset:256
    ds_read_b64_tr_b16 a[186:187], v38 offset:2304
    ds_read_b64_tr_b16 a[188:189], v38 offset:8448
    ds_read_b64_tr_b16 a[190:191], v38 offset:10496
    ds_read_b64_tr_b16 a[216:217], v38 offset:512
    ds_read_b64_tr_b16 a[218:219], v38 offset:2560
    ds_read_b64_tr_b16 a[220:221], v38 offset:8704
    ds_read_b64_tr_b16 a[222:223], v38 offset:10752
    ds_read_b64_tr_b16 a[248:249], v38 offset:768
    ds_read_b64_tr_b16 a[250:251], v38 offset:2816
    ds_read_b64_tr_b16 a[252:253], v38 offset:8960
    ds_read_b64_tr_b16 a[254:255], v38 offset:11008
    s_branch L_WO1_E
L_WO1_3:
    ds_read_b64_tr_b16 a[144:145], v38 offset:0
    ds_read_b64_tr_b16 a[146:147], v38 offset:2048
    ds_read_b64_tr_b16 a[148:149], v38 offset:8192
    ds_read_b64_tr_b16 a[150:151], v38 offset:10240
    ds_read_b64_tr_b16 a[176:177], v38 offset:256
    ds_read_b64_tr_b16 a[178:179], v38 offset:2304
    ds_read_b64_tr_b16 a[180:181], v38 offset:8448
    ds_read_b64_tr_b16 a[182:183], v38 offset:10496
    ds_read_b64_tr_b16 a[208:209], v38 offset:512
    ds_read_b64_tr_b16 a[210:211], v38 offset:2560
    ds_read_b64_tr_b16 a[212:213], v38 offset:8704
    ds_read_b64_tr_b16 a[214:215], v38 offset:10752
    ds_read_b64_tr_b16 a[240:241], v38 offset:768
    ds_read_b64_tr_b16 a[242:243], v38 offset:2816
    ds_read_b64_tr_b16 a[244:245], v38 offset:8960
    ds_read_b64_tr_b16 a[246:247], v38 offset:11008
L_WO1_E:
    s_waitcnt lgkmcnt(0)
    s_barrier
    s_and_b32 s30, s3, 1
    s_lshl_b32 s30, s30, 5
    s_add_u32 s30, s30, 256
    s_lshl_b32 s30, s30, 13
    s_lshl_b32 s32, s12, 8
    s_add_u32 s30, s30, s32
    s_lshl_b32 s31, s3, 13
    s_add_u32 s31, s31, 131072
    s_mov_b32 m0, s31
    s_add_u32 s31, s31, 1024
    buffer_load_dwordx4 v24, s[72:75], s30 offen lds
    s_add_u32 s30, s30, 32768
    s_mov_b32 m0, s31
    s_add_u32 s31, s31, 1024
    buffer_load_dwordx4 v25, s[72:75], s30 offen lds
    s_add_u32 s30, s30, 32768
    s_mov_b32 m0, s31
    s_add_u32 s31, s31, 1024
    buffer_load_dwordx4 v26, s[72:75], s30 offen lds
    s_add_u32 s30, s30, 32768
    s_mov_b32 m0, s31
    s_add_u32 s31, s31, 1024
    buffer_load_dwordx4 v27, s[72:75], s30 offen lds
    s_add_u32 s30, s30, 32768
    s_mov_b32 m0, s31
    s_add_u32 s31, s31, 1024
    buffer_load_dwordx4 v24, s[72:75], s30 offen lds
    s_add_u32 s30, s30, 32768
    s_mov_b32 m0, s31
    s_add_u32 s31, s31, 1024
    buffer_load_dwordx4 v25, s[72:75], s30 offen lds
    s_add_u32 s30, s30, 32768
    s_mov_b32 m0, s31
    s_add_u32 s31, s31, 1024
    buffer_load_dwordx4 v26, s[72:75], s30 offen lds
    s_add_u32 s30, s30, 32768
    s_mov_b32 m0, s31
    s_add_u32 s31, s31, 1024
    buffer_load_dwordx4 v27, s[72:75], s30 offen lds
    s_add_u32 s30, s30, 32768
    s_waitcnt vmcnt(32)
    s_barrier
    v_add_u32 v38, 0, v34
    s_cmp_lg_u32 s3, 0
    s_cbranch_scc1 L_WO2_1
    ds_read_b64_tr_b16 a[144:145], v38 offset:0
    ds_read_b64_tr_b16 a[146:147], v38 offset:2048
    ds_read_b64_tr_b16 a[148:149], v38 offset:8192
    ds_read_b64_tr_b16 a[150:151], v38 offset:10240
    ds_read_b64_tr_b16 a[176:177], v38 offset:256
    ds_read_b64_tr_b16 a[178:179], v38 offset:2304
    ds_read_b64_tr_b16 a[180:181], v38 offset:8448
    ds_read_b64_tr_b16 a[182:183], v38 offset:10496
    ds_read_b64_tr_b16 a[208:209], v38 offset:512
    ds_read_b64_tr_b16 a[210:211], v38 offset:2560
    ds_read_b64_tr_b16 a[212:213], v38 offset:8704
    ds_read_b64_tr_b16 a[214:215], v38 offset:10752
    ds_read_b64_tr_b16 a[240:241], v38 offset:768
    ds_read_b64_tr_b16 a[242:243], v38 offset:2816
    ds_read_b64_tr_b16 a[244:245], v38 offset:8960
    ds_read_b64_tr_b16 a[246:247], v38 offset:11008
    s_branch L_WO2_E
L_WO2_1:
    s_cmp_lg_u32 s3, 1
    s_cbranch_scc1 L_WO2_2
    ds_read_b64_tr_b16 a[152:153], v38 offset:0
    ds_read_b64_tr_b16 a[154:155], v38 offset:2048
    ds_read_b64_tr_b16 a[156:157], v38 offset:8192
    ds_read_b64_tr_b16 a[158:159], v38 offset:10240
    ds_read_b64_tr_b16 a[184:185], v38 offset:256
    ds_read_b64_tr_b16 a[186:187], v38 offset:2304
    ds_read_b64_tr_b16 a[188:189], v38 offset:8448
    ds_read_b64_tr_b16 a[190:191], v38 offset:10496
    ds_read_b64_tr_b16 a[216:217], v38 offset:512
    ds_read_b64_tr_b16 a[218:219], v38 offset:2560
    ds_read_b64_tr_b16 a[220:221], v38 offset:8704
    ds_read_b64_tr_b16 a[222:223], v38 offset:10752
    ds_read_b64_tr_b16 a[248:249], v38 offset:768
    ds_read_b64_tr_b16 a[250:251], v38 offset:2816
    ds_read_b64_tr_b16 a[252:253], v38 offset:8960
    ds_read_b64_tr_b16 a[254:255], v38 offset:11008
    s_branch L_WO2_E
L_WO2_2:
    s_cmp_lg_u32 s3, 2
    s_cbranch_scc1 L_WO2_3
    ds_read_b64_tr_b16 a[128:129], v38 offset:0
    ds_read_b64_tr_b16 a[130:131], v38 offset:2048
    ds_read_b64_tr_b16 a[132:133], v38 offset:8192
    ds_read_b64_tr_b16 a[134:135], v38 offset:10240
    ds_read_b64_tr_b16 a[160:161], v38 offset:256
    ds_read_b64_tr_b16 a[162:163], v38 offset:2304
    ds_read_b64_tr_b16 a[164:165], v38 offset:8448
    ds_read_b64_tr_b16 a[166:167], v38 offset:10496
    ds_read_b64_tr_b16 a[192:193], v38 offset:512
    ds_read_b64_tr_b16 a[194:195], v38 offset:2560
    ds_read_b64_tr_b16 a[196:197], v38 offset:8704
    ds_read_b64_tr_b16 a[198:199], v38 offset:10752
    ds_read_b64_tr_b16 a[224:225], v38 offset:768
    ds_read_b64_tr_b16 a[226:227], v38 offset:2816
    ds_read_b64_tr_b16 a[228:229], v38 offset:8960
    ds_read_b64_tr_b16 a[230:231], v38 offset:11008
    s_branch L_WO2_E
L_WO2_3:
    ds_read_b64_tr_b16 a[136:137], v38 offset:0
    ds_read_b64_tr_b16 a[138:139], v38 offset:2048
    ds_read_b64_tr_b16 a[140:141], v38 offset:8192
    ds_read_b64_tr_b16 a[142:143], v38 offset:10240
    ds_read_b64_tr_b16 a[168:169], v38 offset:256
    ds_read_b64_tr_b16 a[170:171], v38 offset:2304
    ds_read_b64_tr_b16 a[172:173], v38 offset:8448
    ds_read_b64_tr_b16 a[174:175], v38 offset:10496
    ds_read_b64_tr_b16 a[200:201], v38 offset:512
    ds_read_b64_tr_b16 a[202:203], v38 offset:2560
    ds_read_b64_tr_b16 a[204:205], v38 offset:8704
    ds_read_b64_tr_b16 a[206:207], v38 offset:10752
    ds_read_b64_tr_b16 a[232:233], v38 offset:768
    ds_read_b64_tr_b16 a[234:235], v38 offset:2816
    ds_read_b64_tr_b16 a[236:237], v38 offset:8960
    ds_read_b64_tr_b16 a[238:239], v38 offset:11008
L_WO2_E:
    s_waitcnt lgkmcnt(0)
    s_barrier
    s_and_b32 s30, s3, 1
    s_lshl_b32 s30, s30, 5
    s_add_u32 s30, s30, 320
    s_lshl_b32 s30, s30, 13
    s_lshl_b32 s32, s12, 8
    s_add_u32 s30, s30, s32
    s_lshl_b32 s31, s3, 13
    s_add_u32 s31, s31, 0
    s_mov_b32 m0, s31
    s_add_u32 s31, s31, 1024
    buffer_load_dwordx4 v24, s[72:75], s30 offen lds
    s_add_u32 s30, s30, 32768
    s_mov_b32 m0, s31
    s_add_u32 s31, s31, 1024
    buffer_load_dwordx4 v25, s[72:75], s30 offen lds
    s_add_u32 s30, s30, 32768
    s_mov_b32 m0, s31
    s_add_u32 s31, s31, 1024
    buffer_load_dwordx4 v26, s[72:75], s30 offen lds
    s_add_u32 s30, s30, 32768
    s_mov_b32 m0, s31
    s_add_u32 s31, s31, 1024
    buffer_load_dwordx4 v27, s[72:75], s30 offen lds
    s_add_u32 s30, s30, 32768
    s_mov_b32 m0, s31
    s_add_u32 s31, s31, 1024
    buffer_load_dwordx4 v24, s[72:75], s30 offen lds
    s_add_u32 s30, s30, 32768
    s_mov_b32 m0, s31
    s_add_u32 s31, s31, 1024
    buffer_load_dwordx4 v25, s[72:75], s30 offen lds
    s_add_u32 s30, s30, 32768
    s_mov_b32 m0, s31
    s_add_u32 s31, s31, 1024
    buffer_load_dwordx4 v26, s[72:75], s30 offen lds
    s_add_u32 s30, s30, 32768
    s_mov_b32 m0, s31
    s_add_u32 s31, s31, 1024
    buffer_load_dwordx4 v27, s[72:75], s30 offen lds
    s_add_u32 s30, s30, 32768
    s_waitcnt vmcnt(32)
    s_barrier
    v_add_u32 v38, 32768, v34
    s_cmp_lg_u32 s3, 0
    s_cbranch_scc1 L_WO3_1
    ds_read_b64_tr_b16 a[152:153], v38 offset:0
    ds_read_b64_tr_b16 a[154:155], v38 offset:2048
    ds_read_b64_tr_b16 a[156:157], v38 offset:8192
    ds_read_b64_tr_b16 a[158:159], v38 offset:10240
    ds_read_b64_tr_b16 a[184:185], v38 offset:256
    ds_read_b64_tr_b16 a[186:187], v38 offset:2304
    ds_read_b64_tr_b16 a[188:189], v38 offset:8448
    ds_read_b64_tr_b16 a[190:191], v38 offset:10496
    ds_read_b64_tr_b16 a[216:217], v38 offset:512
    ds_read_b64_tr_b16 a[218:219], v38 offset:2560
    ds_read_b64_tr_b16 a[220:221], v38 offset:8704
    ds_read_b64_tr_b16 a[222:223], v38 offset:10752
    ds_read_b64_tr_b16 a[248:249], v38 offset:768
    ds_read_b64_tr_b16 a[250:251], v38 offset:2816
    ds_read_b64_tr_b16 a[252:253], v38 offset:8960
    ds_read_b64_tr_b16 a[254:255], v38 offset:11008
    s_branch L_WO3_E
L_WO3_1:
    s_cmp_lg_u32 s3, 1
    s_cbranch_scc1 L_WO3_2
    ds_read_b64_tr_b16 a[144:145], v38 offset:0
    ds_read_b64_tr_b16 a[146:147], v38 offset:2048
    ds_read_b64_tr_b16 a[148:149], v38 offset:8192
    ds_read_b64_tr_b16 a[150:151], v38 offset:10240
    ds_read_b64_tr_b16 a[176:177], v38 offset:256
    ds_read_b64_tr_b16 a[178:179], v38 offset:2304
    ds_read_b64_tr_b16 a[180:181], v38 offset:8448
    ds_read_b64_tr_b16 a[182:183], v38 offset:10496
    ds_read_b64_tr_b16 a[208:209], v38 offset:512
    ds_read_b64_tr_b16 a[210:211], v38 offset:2560
    ds_read_b64_tr_b16 a[212:213], v38 offset:8704
    ds_read_b64_tr_b16 a[214:215], v38 offset:10752
    ds_read_b64_tr_b16 a[240:241], v38 offset:768
    ds_read_b64_tr_b16 a[242:243], v38 offset:2816
    ds_read_b64_tr_b16 a[244:245], v38 offset:8960
    ds_read_b64_tr_b16 a[246:247], v38 offset:11008
    s_branch L_WO3_E
L_WO3_2:
    s_cmp_lg_u32 s3, 2
    s_cbranch_scc1 L_WO3_3
    ds_read_b64_tr_b16 a[136:137], v38 offset:0
    ds_read_b64_tr_b16 a[138:139], v38 offset:2048
    ds_read_b64_tr_b16 a[140:141], v38 offset:8192
    ds_read_b64_tr_b16 a[142:143], v38 offset:10240
    ds_read_b64_tr_b16 a[168:169], v38 offset:256
    ds_read_b64_tr_b16 a[170:171], v38 offset:2304
    ds_read_b64_tr_b16 a[172:173], v38 offset:8448
    ds_read_b64_tr_b16 a[174:175], v38 offset:10496
    ds_read_b64_tr_b16 a[200:201], v38 offset:512
    ds_read_b64_tr_b16 a[202:203], v38 offset:2560
    ds_read_b64_tr_b16 a[204:205], v38 offset:8704
    ds_read_b64_tr_b16 a[206:207], v38 offset:10752
    ds_read_b64_tr_b16 a[232:233], v38 offset:768
    ds_read_b64_tr_b16 a[234:235], v38 offset:2816
    ds_read_b64_tr_b16 a[236:237], v38 offset:8960
    ds_read_b64_tr_b16 a[238:239], v38 offset:11008
    s_branch L_WO3_E
L_WO3_3:
    ds_read_b64_tr_b16 a[128:129], v38 offset:0
    ds_read_b64_tr_b16 a[130:131], v38 offset:2048
    ds_read_b64_tr_b16 a[132:133], v38 offset:8192
    ds_read_b64_tr_b16 a[134:135], v38 offset:10240
    ds_read_b64_tr_b16 a[160:161], v38 offset:256
    ds_read_b64_tr_b16 a[162:163], v38 offset:2304
    ds_read_b64_tr_b16 a[164:165], v38 offset:8448
    ds_read_b64_tr_b16 a[166:167], v38 offset:10496
    ds_read_b64_tr_b16 a[192:193], v38 offset:512
    ds_read_b64_tr_b16 a[194:195], v38 offset:2560
    ds_read_b64_tr_b16 a[196:197], v38 offset:8704
    ds_read_b64_tr_b16 a[198:199], v38 offset:10752
    ds_read_b64_tr_b16 a[224:225], v38 offset:768
    ds_read_b64_tr_b16 a[226:227], v38 offset:2816
    ds_read_b64_tr_b16 a[228:229], v38 offset:8960
    ds_read_b64_tr_b16 a[230:231], v38 offset:11008
L_WO3_E:
    s_waitcnt lgkmcnt(0)
    s_barrier
    s_and_b32 s30, s3, 1
    s_lshl_b32 s30, s30, 5
    s_add_u32 s30, s30, 0
    s_lshl_b32 s30, s30, 13
    s_lshl_b32 s32, s12, 8
    s_add_u32 s30, s30, s32
    s_lshl_b32 s31, s3, 13
    s_add_u32 s31, s31, 32768
    s_mov_b32 m0, s31
    s_add_u32 s31, s31, 1024
    buffer_load_dwordx4 v24, s[72:75], s30 offen lds
    s_add_u32 s30, s30, 32768
    s_mov_b32 m0, s31
    s_add_u32 s31, s31, 1024
    buffer_load_dwordx4 v25, s[72:75], s30 offen lds
    s_add_u32 s30, s30, 32768
    s_mov_b32 m0, s31
    s_add_u32 s31, s31, 1024
    buffer_load_dwordx4 v26, s[72:75], s30 offen lds
    s_add_u32 s30, s30, 32768
    s_mov_b32 m0, s31
    s_add_u32 s31, s31, 1024
    buffer_load_dwordx4 v27, s[72:75], s30 offen lds
    s_add_u32 s30, s30, 32768
    s_mov_b32 m0, s31
    s_add_u32 s31, s31, 1024
    buffer_load_dwordx4 v24, s[72:75], s30 offen lds
    s_add_u32 s30, s30, 32768
    s_mov_b32 m0, s31
    s_add_u32 s31, s31, 1024
    buffer_load_dwordx4 v25, s[72:75], s30 offen lds
    s_add_u32 s30, s30, 32768
    s_mov_b32 m0, s31
    s_add_u32 s31, s31, 1024
    buffer_load_dwordx4 v26, s[72:75], s30 offen lds
    s_add_u32 s30, s30, 32768
    s_mov_b32 m0, s31
    s_add_u32 s31, s31, 1024
    buffer_load_dwordx4 v27, s[72:75], s30 offen lds
    s_add_u32 s30, s30, 32768
    s_waitcnt vmcnt(32)
    s_barrier
    v_add_u32 v36, 65536, v32
    v_add_u32 v37, 65536, v33
    ds_read_b64_tr_b16 v[128:129], v36 offset:0
    ds_read_b64_tr_b16 v[130:131], v36 offset:512
    ds_read_b64_tr_b16 v[132:133], v36 offset:8192
    ds_read_b64_tr_b16 v[134:135], v36 offset:8704
    ds_read_b64_tr_b16 v[136:137], v37 offset:0
    ds_read_b64_tr_b16 v[138:139], v37 offset:512
    ds_read_b64_tr_b16 v[140:141], v37 offset:8192
    ds_read_b64_tr_b16 v[142:143], v37 offset:8704
    ds_read_b64_tr_b16 v[144:145], v36 offset:16384
    ds_read_b64_tr_b16 v[146:147], v36 offset:16896
    ds_read_b64_tr_b16 v[148:149], v36 offset:24576
    ds_read_b64_tr_b16 v[150:151], v36 offset:25088
    ds_read_b64_tr_b16 v[152:153], v37 offset:16384
    ds_read_b64_tr_b16 v[154:155], v37 offset:16896
    ds_read_b64_tr_b16 v[156:157], v37 offset:24576
    ds_read_b64_tr_b16 v[158:159], v37 offset:25088
    s_waitcnt lgkmcnt(0)
    s_barrier
    s_and_b32 s30, s3, 1
    s_lshl_b32 s30, s30, 5
    s_add_u32 s30, s30, 64
    s_lshl_b32 s30, s30, 13
    s_lshl_b32 s32, s12, 8
    s_add_u32 s30, s30, s32
    s_lshl_b32 s31, s3, 13
    s_add_u32 s31, s31, 65536
    s_mov_b32 m0, s31
    s_add_u32 s31, s31, 1024
    buffer_load_dwordx4 v24, s[72:75], s30 offen lds
    s_add_u32 s30, s30, 32768
    s_mov_b32 m0, s31
    s_add_u32 s31, s31, 1024
    buffer_load_dwordx4 v25, s[72:75], s30 offen lds
    s_add_u32 s30, s30, 32768
    s_mov_b32 m0, s31
    s_add_u32 s31, s31, 1024
    buffer_load_dwordx4 v26, s[72:75], s30 offen lds
    s_add_u32 s30, s30, 32768
    s_mov_b32 m0, s31
    s_add_u32 s31, s31, 1024
    buffer_load_dwordx4 v27, s[72:75], s30 offen lds
    s_add_u32 s30, s30, 32768
    s_mov_b32 m0, s31
    s_add_u32 s31, s31, 1024
    buffer_load_dwordx4 v24, s[72:75], s30 offen lds
    s_add_u32 s30, s30, 32768
    s_mov_b32 m0, s31
    s_add_u32 s31, s31, 1024
    buffer_load_dwordx4 v25, s[72:75], s30 offen lds
    s_add_u32 s30, s30, 32768
    s_mov_b32 m0, s31
    s_add_u32 s31, s31, 1024
    buffer_load_dwordx4 v26, s[72:75], s30 offen lds
    s_add_u32 s30, s30, 32768
    s_mov_b32 m0, s31
    s_add_u32 s31, s31, 1024
    buffer_load_dwordx4 v27, s[72:75], s30 offen lds
    s_add_u32 s30, s30, 32768
    s_waitcnt vmcnt(32)
    s_barrier
    v_add_u32 v36, 98304, v32
    v_add_u32 v37, 98304, v33
    ds_read_b64_tr_b16 v[160:161], v36 offset:0
    ds_read_b64_tr_b16 v[162:163], v36 offset:512
    ds_read_b64_tr_b16 v[164:165], v36 offset:8192
    ds_read_b64_tr_b16 v[166:167], v36 offset:8704
    ds_read_b64_tr_b16 v[168:169], v37 offset:0
    ds_read_b64_tr_b16 v[170:171], v37 offset:512
    ds_read_b64_tr_b16 v[172:173], v37 offset:8192
    ds_read_b64_tr_b16 v[174:175], v37 offset:8704
    ds_read_b64_tr_b16 v[176:177], v36 offset:16384
    ds_read_b64_tr_b16 v[178:179], v36 offset:16896
    ds_read_b64_tr_b16 v[180:181], v36 offset:24576
    ds_read_b64_tr_b16 v[182:183], v36 offset:25088
    ds_read_b64_tr_b16 v[184:185], v37 offset:16384
    ds_read_b64_tr_b16 v[186:187], v37 offset:16896
    ds_read_b64_tr_b16 v[188:189], v37 offset:24576
    ds_read_b64_tr_b16 v[190:191], v37 offset:25088
    s_waitcnt lgkmcnt(0)
    s_barrier
    s_and_b32 s30, s3, 1
    s_lshl_b32 s30, s30, 5
    s_add_u32 s30, s30, 384
    s_lshl_b32 s30, s30, 13
    s_lshl_b32 s32, s12, 8
    s_add_u32 s30, s30, s32
    s_lshl_b32 s31, s3, 13
    s_add_u32 s31, s31, 98304
    s_mov_b32 m0, s31
    s_add_u32 s31, s31, 1024
    buffer_load_dwordx4 v24, s[72:75], s30 offen lds
    s_add_u32 s30, s30, 32768
    s_mov_b32 m0, s31
    s_add_u32 s31, s31, 1024
    buffer_load_dwordx4 v25, s[72:75], s30 offen lds
    s_add_u32 s30, s30, 32768
    s_mov_b32 m0, s31
    s_add_u32 s31, s31, 1024
    buffer_load_dwordx4 v26, s[72:75], s30 offen lds
    s_add_u32 s30, s30, 32768
    s_mov_b32 m0, s31
    s_add_u32 s31, s31, 1024
    buffer_load_dwordx4 v27, s[72:75], s30 offen lds
    s_add_u32 s30, s30, 32768
    s_mov_b32 m0, s31
    s_add_u32 s31, s31, 1024
    buffer_load_dwordx4 v24, s[72:75], s30 offen lds
    s_add_u32 s30, s30, 32768
    s_mov_b32 m0, s31
    s_add_u32 s31, s31, 1024
    buffer_load_dwordx4 v25, s[72:75], s30 offen lds
    s_add_u32 s30, s30, 32768
    s_mov_b32 m0, s31
    s_add_u32 s31, s31, 1024
    buffer_load_dwordx4 v26, s[72:75], s30 offen lds
    s_add_u32 s30, s30, 32768
    s_mov_b32 m0, s31
    s_add_u32 s31, s31, 1024
    buffer_load_dwordx4 v27, s[72:75], s30 offen lds
    s_add_u32 s30, s30, 32768
    s_waitcnt vmcnt(32)
    s_barrier
    v_add_u32 v36, 131072, v32
    v_add_u32 v37, 131072, v33
    ds_read_b64_tr_b16 v[192:193], v36 offset:0
    ds_read_b64_tr_b16 v[194:195], v36 offset:512
    ds_read_b64_tr_b16 v[196:197], v36 offset:8192
    ds_read_b64_tr_b16 v[198:199], v36 offset:8704
    ds_read_b64_tr_b16 v[200:201], v37 offset:0
    ds_read_b64_tr_b16 v[202:203], v37 offset:512
    ds_read_b64_tr_b16 v[204:205], v37 offset:8192
    ds_read_b64_tr_b16 v[206:207], v37 offset:8704
    ds_read_b64_tr_b16 v[208:209], v36 offset:16384
    ds_read_b64_tr_b16 v[210:211], v36 offset:16896
    ds_read_b64_tr_b16 v[212:213], v36 offset:24576
    ds_read_b64_tr_b16 v[214:215], v36 offset:25088
    ds_read_b64_tr_b16 v[216:217], v37 offset:16384
    ds_read_b64_tr_b16 v[218:219], v37 offset:16896
    ds_read_b64_tr_b16 v[220:221], v37 offset:24576
    ds_read_b64_tr_b16 v[222:223], v37 offset:25088
    s_waitcnt lgkmcnt(0)
    s_barrier
    s_and_b32 s30, s3, 1
    s_lshl_b32 s30, s30, 5
    s_add_u32 s30, s30, 448
    s_lshl_b32 s30, s30, 13
    s_lshl_b32 s32, s12, 8
    s_add_u32 s30, s30, s32
    s_lshl_b32 s31, s3, 13
    s_add_u32 s31, s31, 131072
    s_mov_b32 m0, s31
    s_add_u32 s31, s31, 1024
    buffer_load_dwordx4 v24, s[72:75], s30 offen lds
    s_add_u32 s30, s30, 32768
    s_mov_b32 m0, s31
    s_add_u32 s31, s31, 1024
    buffer_load_dwordx4 v25, s[72:75], s30 offen lds
    s_add_u32 s30, s30, 32768
    s_mov_b32 m0, s31
    s_add_u32 s31, s31, 1024
    buffer_load_dwordx4 v26, s[72:75], s30 offen lds
    s_add_u32 s30, s30, 32768
    s_mov_b32 m0, s31
    s_add_u32 s31, s31, 1024
    buffer_load_dwordx4 v27, s[72:75], s30 offen lds
    s_add_u32 s30, s30, 32768
    s_mov_b32 m0, s31
    s_add_u32 s31, s31, 1024
    buffer_load_dwordx4 v24, s[72:75], s30 offen lds
    s_add_u32 s30, s30, 32768
    s_mov_b32 m0, s31
    s_add_u32 s31, s31, 1024
    buffer_load_dwordx4 v25, s[72:75], s30 offen lds
    s_add_u32 s30, s30, 32768
    s_mov_b32 m0, s31
    s_add_u32 s31, s31, 1024
    buffer_load_dwordx4 v26, s[72:75], s30 offen lds
    s_add_u32 s30, s30, 32768
    s_mov_b32 m0, s31
    s_add_u32 s31, s31, 1024
    buffer_load_dwordx4 v27, s[72:75], s30 offen lds
    s_add_u32 s30, s30, 32768
    s_waitcnt vmcnt(32)
    s_barrier
    v_add_u32 v36, 0, v32
    v_add_u32 v37, 0, v33
    ds_read_b64_tr_b16 v[224:225], v36 offset:0
    ds_read_b64_tr_b16 v[226:227], v36 offset:512
    ds_read_b64_tr_b16 v[228:229], v36 offset:8192
    ds_read_b64_tr_b16 v[230:231], v36 offset:8704
    ds_read_b64_tr_b16 v[232:233], v37 offset:0
    ds_read_b64_tr_b16 v[234:235], v37 offset:512
    ds_read_b64_tr_b16 v[236:237], v37 offset:8192
    ds_read_b64_tr_b16 v[238:239], v37 offset:8704
    ds_read_b64_tr_b16 v[240:241], v36 offset:16384
    ds_read_b64_tr_b16 v[242:243], v36 offset:16896
    ds_read_b64_tr_b16 v[244:245], v36 offset:24576
    ds_read_b64_tr_b16 v[246:247], v36 offset:25088
    ds_read_b64_tr_b16 v[248:249], v37 offset:16384
    ds_read_b64_tr_b16 v[250:251], v37 offset:16896
    ds_read_b64_tr_b16 v[252:253], v37 offset:24576
    ds_read_b64_tr_b16 v[254:255], v37 offset:25088
    s_waitcnt lgkmcnt(0)
    s_barrier
    s_waitcnt vmcnt(24)
    s_barrier
    v_add_u32 v36, 32768, v32
    v_add_u32 v37, 32768, v33
    ds_read_b64_tr_b16 v[56:57], v36 offset:0
    ds_read_b64_tr_b16 v[58:59], v36 offset:512
    ds_read_b64_tr_b16 v[60:61], v36 offset:8192
    ds_read_b64_tr_b16 v[62:63], v36 offset:8704
    ds_read_b64_tr_b16 v[64:65], v37 offset:0
    ds_read_b64_tr_b16 v[66:67], v37 offset:512
    ds_read_b64_tr_b16 v[68:69], v37 offset:8192
    ds_read_b64_tr_b16 v[70:71], v37 offset:8704
    ds_read_b64_tr_b16 v[72:73], v36 offset:16384
    ds_read_b64_tr_b16 v[74:75], v36 offset:16896
    ds_read_b64_tr_b16 v[76:77], v36 offset:24576
    ds_read_b64_tr_b16 v[78:79], v36 offset:25088
    ds_read_b64_tr_b16 v[80:81], v37 offset:16384
    ds_read_b64_tr_b16 v[82:83], v37 offset:16896
    ds_read_b64_tr_b16 v[84:85], v37 offset:24576
    ds_read_b64_tr_b16 v[86:87], v37 offset:25088
    s_waitcnt lgkmcnt(0)
    s_barrier
    ds_write_b128 v5, v[56:59] offset:0
    ds_write_b128 v5, v[60:63] offset:1024
    ds_write_b128 v5, v[64:67] offset:2048
    ds_write_b128 v5, v[68:71] offset:3072
    ds_write_b128 v5, v[72:75] offset:4096
    ds_write_b128 v5, v[76:79] offset:5120
    ds_write_b128 v5, v[80:83] offset:6144
    ds_write_b128 v5, v[84:87] offset:7168
    s_waitcnt vmcnt(16)
    s_barrier
    v_add_u32 v36, 65536, v32
    v_add_u32 v37, 65536, v33
    ds_read_b64_tr_b16 v[56:57], v36 offset:0
    ds_read_b64_tr_b16 v[58:59], v36 offset:512
    ds_read_b64_tr_b16 v[60:61], v36 offset:8192
    ds_read_b64_tr_b16 v[62:63], v36 offset:8704
    ds_read_b64_tr_b16 v[64:65], v37 offset:0
    ds_read_b64_tr_b16 v[66:67], v37 offset:512
    ds_read_b64_tr_b16 v[68:69], v37 offset:8192
    ds_read_b64_tr_b16 v[70:71], v37 offset:8704
    ds_read_b64_tr_b16 v[72:73], v36 offset:16384
    ds_read_b64_tr_b16 v[74:75], v36 offset:16896
    ds_read_b64_tr_b16 v[76:77], v36 offset:24576
    ds_read_b64_tr_b16 v[78:79], v36 offset:25088
    ds_read_b64_tr_b16 v[80:81], v37 offset:16384
    ds_read_b64_tr_b16 v[82:83], v37 offset:16896
    ds_read_b64_tr_b16 v[84:85], v37 offset:24576
    ds_read_b64_tr_b16 v[86:87], v37 offset:25088
    s_waitcnt lgkmcnt(0)
    s_barrier
    ds_write_b128 v5, v[56:59] offset:32768
    ds_write_b128 v5, v[60:63] offset:33792
    ds_write_b128 v5, v[64:67] offset:34816
    ds_write_b128 v5, v[68:71] offset:35840
    ds_write_b128 v5, v[72:75] offset:36864
    ds_write_b128 v5, v[76:79] offset:37888
    ds_write_b128 v5, v[80:83] offset:38912
    ds_write_b128 v5, v[84:87] offset:39936
    s_waitcnt vmcnt(8)
    s_barrier
    v_add_u32 v36, 98304, v32
    v_add_u32 v37, 98304, v33
    ds_read_b64_tr_b16 v[56:57], v36 offset:0
    ds_read_b64_tr_b16 v[58:59], v36 offset:512
    ds_read_b64_tr_b16 v[60:61], v36 offset:8192
    ds_read_b64_tr_b16 v[62:63], v36 offset:8704
    ds_read_b64_tr_b16 v[64:65], v37 offset:0
    ds_read_b64_tr_b16 v[66:67], v37 offset:512
    ds_read_b64_tr_b16 v[68:69], v37 offset:8192
    ds_read_b64_tr_b16 v[70:71], v37 offset:8704
    ds_read_b64_tr_b16 v[72:73], v36 offset:16384
    ds_read_b64_tr_b16 v[74:75], v36 offset:16896
    ds_read_b64_tr_b16 v[76:77], v36 offset:24576
    ds_read_b64_tr_b16 v[78:79], v36 offset:25088
    ds_read_b64_tr_b16 v[80:81], v37 offset:16384
    ds_read_b64_tr_b16 v[82:83], v37 offset:16896
    ds_read_b64_tr_b16 v[84:85], v37 offset:24576
    ds_read_b64_tr_b16 v[86:87], v37 offset:25088
    s_waitcnt lgkmcnt(0)
    s_barrier
    ds_write_b128 v6, v[56:59] offset:0
    ds_write_b128 v6, v[60:63] offset:1024
    ds_write_b128 v6, v[64:67] offset:2048
    ds_write_b128 v6, v[68:71] offset:3072
    ds_write_b128 v6, v[72:75] offset:4096
    ds_write_b128 v6, v[76:79] offset:5120
    ds_write_b128 v6, v[80:83] offset:6144
    ds_write_b128 v6, v[84:87] offset:7168
    s_waitcnt vmcnt(0)
    s_barrier
    v_add_u32 v36, 131072, v32
    v_add_u32 v37, 131072, v33
    ds_read_b64_tr_b16 v[56:57], v36 offset:0
    ds_read_b64_tr_b16 v[58:59], v36 offset:512
    ds_read_b64_tr_b16 v[60:61], v36 offset:8192
    ds_read_b64_tr_b16 v[62:63], v36 offset:8704
    ds_read_b64_tr_b16 v[64:65], v37 offset:0
    ds_read_b64_tr_b16 v[66:67], v37 offset:512
    ds_read_b64_tr_b16 v[68:69], v37 offset:8192
    ds_read_b64_tr_b16 v[70:71], v37 offset:8704
    ds_read_b64_tr_b16 v[72:73], v36 offset:16384
    ds_read_b64_tr_b16 v[74:75], v36 offset:16896
    ds_read_b64_tr_b16 v[76:77], v36 offset:24576
    ds_read_b64_tr_b16 v[78:79], v36 offset:25088
    ds_read_b64_tr_b16 v[80:81], v37 offset:16384
    ds_read_b64_tr_b16 v[82:83], v37 offset:16896
    ds_read_b64_tr_b16 v[84:85], v37 offset:24576
    ds_read_b64_tr_b16 v[86:87], v37 offset:25088
    s_waitcnt lgkmcnt(0)
    s_barrier
    ds_write_b128 v6, v[56:59] offset:32768
    ds_write_b128 v6, v[60:63] offset:33792
    ds_write_b128 v6, v[64:67] offset:34816
    ds_write_b128 v6, v[68:71] offset:35840
    ds_write_b128 v6, v[72:75] offset:36864
    ds_write_b128 v6, v[76:79] offset:37888
    ds_write_b128 v6, v[80:83] offset:38912
    ds_write_b128 v6, v[84:87] offset:39936
    s_waitcnt lgkmcnt(0)
    s_load_dwordx2 s[48:49], s[0:1], 8
    v_lshrrev_b32 v22, 3, v0
    v_and_b32 v23, 7, v0
    v_lshlrev_b32 v23, 4, v23
    s_lshl_b32 s30, s3, 8
    v_add_u32 v23, s30, v23
    v_lshl_add_u32 v20, v22, 10, v23
    v_mul_u32_u24 v22, 1088, v22
    v_add_u32 v22, v22, v23
    v_add_u32 v22, 16384, v22
    s_waitcnt lgkmcnt(0)
    s_mov_b32 s50, 8192
    s_mov_b32 s51, 0x20000
    buffer_load_dwordx4 v[28:31], v20, s[48:51], 0 offen
    buffer_load_dwordx4 v[32:35], v20, s[48:51], 0 offen offset:128
    s_waitcnt vmcnt(1)
    ds_write_b128 v22, v[28:31]
    s_waitcnt vmcnt(0)
    ds_write_b128 v22, v[32:35] offset:128
    s_waitcnt vmcnt(0) lgkmcnt(0)
    s_load_dwordx2 s[96:97], s[0:1], 96
    v_mov_b32 v120, 192
    s_mov_b32 s94, 0
    s_waitcnt lgkmcnt(0)
L_WDC:
    global_load_dword v121, v120, s[96:97] sc1
    s_waitcnt vmcnt(0)
    v_readfirstlane_b32 s95, v121
    s_add_u32 s94, s94, 1
    s_cmp_gt_u32 s94, 2000000
    s_cbranch_scc1 L_GBAIL
    s_cmp_ge_u32 s95, 256
    s_cbranch_scc1 L_WDOKC
    s_sleep 4
    s_branch L_WDC
L_WDOKC:
    s_barrier
    s_mov_b32 s13, 0
    s_mov_b32 s79, 0
    s_mov_b32 s15, 1
    s_mov_b32 s16, 0x4300000
    s_mov_b32 s17, 0x4301000
    s_lshl_b32 s20, s12, 13
    s_lshr_b32 s30, s3, 1
    s_lshl_b32 s30, s30, 12
    s_add_u32 s20, s20, s30
    s_add_u32 s20, s20, 0x4300000
    s_mov_b32 s21, 0x4400000
    s_mov_b32 s22, 0x4402000
    s_mov_b32 s23, 0x4404000
    s_lshl_b32 s30, s12, 13
    s_lshl_b32 s31, s3, 11
    s_add_u32 s24, s30, s31
    s_add_u32 s25, s24, 0x1000000
    s_add_u32 s26, s30, 0x40000
    s_lshl_b32 s30, s12, 12
    s_lshl_b32 s31, s3, 10
    s_add_u32 s30, s30, s31
    s_add_u32 s27, s30, 0x3200000
    s_add_u32 s28, s30, 0x3a40000
    s_lshl_b32 s30, s12, 7
    s_add_u32 s36, s30, 0x4410000
    s_lshl_b32 s37, s3, 10
    v_or_b32 v22, s3, v0
    v_mov_b32 v23, 0x40000000
    v_cmp_eq_u32 vcc, 0, v22
    s_nop 1
    v_cndmask_b32 v21, v23, 0, vcc
    s_lshl_b32 s30, s12, 9
    s_add_u32 s90, s30, 0x4420000
    s_add_u32 s88, s90, 0
    s_mov_b32 s29, 0
L_KV00:
    buffer_load_dword v0, off, s[4:7], s88 sc1
    s_waitcnt vmcnt(0)
    v_readfirstlane_b32 s30, v0
    s_add_u32 s29, s29, 1
    s_cmp_gt_u32 s29, 800000
    s_cbranch_scc1 L_BAIL
    s_cmp_lt_u32 s30, 1
    s_cbranch_scc1 L_KV00
    s_add_u32 s88, s90, 128
    s_mov_b32 s29, 0
L_KV01:
    buffer_load_dword v0, off, s[4:7], s88 sc1
    s_waitcnt vmcnt(0)
    v_readfirstlane_b32 s30, v0
    s_add_u32 s29, s29, 1
    s_cmp_gt_u32 s29, 800000
    s_cbranch_scc1 L_BAIL
    s_cmp_lt_u32 s30, 1
    s_cbranch_scc1 L_KV01
    s_add_u32 s88, s90, 256
    s_mov_b32 s89, 1
    s_mov_b32 s29, 0
    s_mov_b32 m0, s34
    s_nop 0
    buffer_load_dwordx4 v1, s[4:7], s24 offen lds
    buffer_load_dwordx4 v1, s[4:7], s24 offen offset:1024 lds
    ds_read_b128 v[56:59], v5 offset:0
    ds_read_b128 v[60:63], v5 offset:1024
    ds_read_b128 v[64:67], v5 offset:2048
    ds_read_b128 v[68:71], v5 offset:3072
    ds_read_b128 v[72:75], v5 offset:4096
    ds_read_b128 v[76:79], v5 offset:5120
    ds_read_b128 v[80:83], v5 offset:6144
    ds_read_b128 v[84:87], v5 offset:7168
    ds_read_b128 v[88:91], v5 offset:32768
    ds_read_b128 v[92:95], v5 offset:33792
    ds_read_b128 v[96:99], v5 offset:34816
    ds_read_b128 v[100:103], v5 offset:35840
    v_mov_b64 v[104:105], 0
    v_mov_b64 v[106:107], 0
    v_mov_b64 v[108:109], 0
    v_mov_b64 v[110:111], 0
    v_mov_b64 v[112:113], 0
    v_mov_b64 v[114:115], 0
    v_mov_b64 v[116:117], 0
    v_mov_b64 v[118:119], 0
    v_mov_b64 v[120:121], 0
    v_mov_b64 v[122:123], 0
    v_mov_b64 v[124:125], 0
    v_mov_b64 v[126:127], 0
    s_waitcnt vmcnt(0) lgkmcnt(0)
    s_barrier
    s_branch L_T0
.p2align 6
L_STEP:
    buffer_load_dwordx4 v[24:27], v14, s[4:7], s21 offen sc1
    buffer_load_dwordx4 v[28:31], v14, s[4:7], s21 offen offset:1024 sc1
    v_mov_b64 v[104:105], 0
    v_mov_b64 v[106:107], 0
    v_mov_b64 v[108:109], 0
    v_mov_b64 v[110:111], 0
    v_mov_b64 v[112:113], 0
    v_mov_b64 v[114:115], 0
    v_mov_b64 v[116:117], 0
    v_mov_b64 v[118:119], 0
    v_mov_b64 v[120:121], 0
    v_mov_b64 v[122:123], 0
    v_mov_b64 v[124:125], 0
    v_mov_b64 v[126:127], 0
L_GCHECK:
    s_waitcnt vmcnt(0)
    ds_write_b64 v15, v[24:25] offset:0
    ds_write_b64 v15, v[26:27] offset:4352
    ds_write_b64 v15, v[28:29] offset:128
    ds_write_b64 v15, v[30:31] offset:4480
    v_max3_u32 v22, v24, v25, v26
    v_max3_u32 v23, v27, v28, v29
    v_max3_u32 v22, v22, v30, v31
    v_max_u32 v22, v22, v23
    v_cmp_eq_u32 vcc, -1, v22
    s_cbranch_vccnz L_GFAIL
L_GOK:
    s_waitcnt lgkmcnt(0)
    s_barrier
L_T0:
    ds_read_b128 v[24:27], v4 offset:0
    ds_read_b128 v[28:31], v4 offset:128
    ds_read_b128 v[32:35], v4 offset:256
    ds_read_b128 v[48:51], v4 offset:768
    s_mov_b32 m0, s35
    v_mov_b32 v19, s79
    buffer_load_dwordx4 v1, s[4:7], s25 offen lds
    buffer_load_dwordx4 v1, s[4:7], s25 offen offset:1024 lds
    buffer_store_dwordx4 v[40:43], v1, s[4:7], s27 offen sc1
    buffer_store_dwordx4 v[44:47], v1, s[4:7], s28 offen sc1
    s_waitcnt lgkmcnt(3)
    v_smfmac_f32_16x16x64_bf16 v[104:107], v[24:27], v[56:63], v2
    ds_read_b128 v[56:59], v6 offset:0
    v_smfmac_f32_16x16x64_bf16 v[108:111], v[24:27], v[64:71], v2
    ds_read_b128 v[60:63], v6 offset:1024
    v_smfmac_f32_16x16x64_bf16 v[112:115], v[24:27], v[72:79], v2
    ds_read_b128 v[36:39], v4 offset:384
    v_smfmac_f32_16x16x64_bf16 v[116:119], v[24:27], v[80:87], v2
    ds_read_b128 v[64:67], v6 offset:2048
    s_waitcnt lgkmcnt(6)
    v_smfmac_f32_16x16x64_bf16 v[104:107], v[28:31], v[88:95], v2
    ds_read_b128 v[68:71], v6 offset:3072
    v_smfmac_f32_16x16x64_bf16 v[108:111], v[28:31], v[96:103], v2
    ds_read_b128 v[52:55], v4 offset:896
    s_waitcnt lgkmcnt(7)
    v_smfmac_f32_16x16x64_bf16 v[104:107], v[32:35], v[128:135], v2
    ds_read_b128 v[72:75], v6 offset:32768
    v_smfmac_f32_16x16x64_bf16 v[108:111], v[32:35], v[136:143], v2
    ds_read_b128 v[76:79], v6 offset:33792
    s_waitcnt lgkmcnt(6)
    v_smfmac_f32_16x16x64_bf16 v[104:107], v[48:51], v[56:63], v2
    ds_read_b128 v[40:43], v4 offset:512
    s_waitcnt lgkmcnt(6)
    v_smfmac_f32_16x16x64_bf16 v[104:107], v[36:39], v[160:167], v2
    ds_read_b128 v[80:83], v6 offset:34816
    s_waitcnt lgkmcnt(5)
    v_smfmac_f32_16x16x64_bf16 v[108:111], v[48:51], v[64:71], v2
    ds_read_b128 v[84:87], v6 offset:35840
    v_smfmac_f32_16x16x64_bf16 v[108:111], v[36:39], v[168:175], v2
    ds_read_b128 v[44:47], v4 offset:640
    s_waitcnt lgkmcnt(4)
    v_smfmac_f32_16x16x64_bf16 v[104:107], v[52:55], v[72:79], v2
    ds_read_b128 v[88:91], v5 offset:36864
    s_waitcnt lgkmcnt(4)
    v_smfmac_f32_16x16x64_bf16 v[104:107], v[40:43], v[192:199], v2
    ds_read_b128 v[92:95], v5 offset:37888
    v_smfmac_f32_16x16x64_bf16 v[108:111], v[40:43], v[200:207], v2
    ds_read_b128 v[96:99], v5 offset:38912
    s_waitcnt lgkmcnt(4)
    v_smfmac_f32_16x16x64_bf16 v[108:111], v[52:55], v[80:87], v2
    ds_read_b128 v[100:103], v5 offset:39936
    s_waitcnt lgkmcnt(4)
    v_smfmac_f32_16x16x64_bf16 v[104:107], v[44:47], v[224:231], v2
    ds_read_b128 v[56:59], v6 offset:4096
    v_smfmac_f32_16x16x64_bf16 v[108:111], v[44:47], v[232:239], v2
    ds_read_b128 v[60:63], v6 offset:5120
    s_waitcnt lgkmcnt(4)
    v_smfmac_f32_16x16x64_bf16 v[112:115], v[28:31], v[88:95], v2
    ds_read_b128 v[64:67], v6 offset:6144
    v_smfmac_f32_16x16x64_bf16 v[112:115], v[32:35], v[144:151], v2
    ds_read_b128 v[68:71], v6 offset:7168
    s_waitcnt lgkmcnt(4)
    v_smfmac_f32_16x16x64_bf16 v[116:119], v[28:31], v[96:103], v2
    ds_read_b128 v[72:75], v6 offset:36864
    v_smfmac_f32_16x16x64_bf16 v[116:119], v[32:35], v[152:159], v2
    ds_read_b128 v[76:79], v6 offset:37888
    s_waitcnt lgkmcnt(4)
    v_smfmac_f32_16x16x64_bf16 v[112:115], v[48:51], v[56:63], v2
    ds_read_b128 v[80:83], v6 offset:38912
    v_smfmac_f32_16x16x64_bf16 v[112:115], v[36:39], v[176:183], v2
    ds_read_b128 v[84:87], v6 offset:39936
    s_waitcnt lgkmcnt(4)
    v_smfmac_f32_16x16x64_bf16 v[116:119], v[48:51], v[64:71], v2
    ds_read_b128 v[88:91], v1 offset:8192
    v_smfmac_f32_16x16x64_bf16 v[116:119], v[36:39], v[184:191], v2
    ds_read_b128 v[92:95], v1 offset:12288
    s_waitcnt lgkmcnt(4)
    v_smfmac_f32_16x16x64_bf16 v[112:115], v[52:55], v[72:79], v2
    ds_read_b128 v[96:99], v1 offset:9216
    v_smfmac_f32_16x16x64_bf16 v[112:115], v[40:43], v[208:215], v2
    ds_read_b128 v[100:103], v1 offset:13312
    s_waitcnt lgkmcnt(4)
    v_smfmac_f32_16x16x64_bf16 v[116:119], v[52:55], v[80:87], v2
    v_pk_add_f32 v[104:105], v[104:105], v[106:107]
    v_smfmac_f32_16x16x64_bf16 v[112:115], v[44:47], v[240:247], v2
    v_pk_add_f32 v[108:109], v[108:109], v[110:111]
    v_smfmac_f32_16x16x64_bf16 v[116:119], v[40:43], v[216:223], v2
    v_cvt_pk_bf16_f32 v104, v104, v105
    v_smfmac_f32_16x16x64_bf16 v[116:119], v[44:47], v[248:255], v2
    v_cvt_pk_bf16_f32 v108, v108, v109
    ds_write_b32 v7, v104 offset:0
    ds_write_b32 v7, v108 offset:256
    buffer_store_dword v19, v21, s[4:7], s36 offen sc1
    v_pk_add_f32 v[112:113], v[112:113], v[114:115]
    v_cvt_pk_bf16_f32 v112, v112, v113
    ds_write2_b32 v8, v112, v112 offset0:0 offset1:1
    s_nop 0
    v_pk_add_f32 v[116:117], v[116:117], v[118:119]
    v_cvt_pk_bf16_f32 v116, v116, v117
    ds_write2_b32 v8, v116, v116 offset0:128 offset1:129
    buffer_store_dword v18, v13, s[4:7], s23 offen
    buffer_load_dword v20, v16, s[4:7], s26 offen
    buffer_load_dword v0, off, s[4:7], s88 sc1
    v_smfmac_f32_16x16x64_bf16 v[120:123], v[24:27], a[0:7], v2
    v_smfmac_f32_16x16x64_bf16 v[124:127], v[24:27], a[8:15], v2
    v_smfmac_f32_16x16x64_bf16 v[120:123], v[28:31], a[16:23], v2
    v_smfmac_f32_16x16x64_bf16 v[124:127], v[28:31], a[24:31], v2
    v_smfmac_f32_16x16x64_bf16 v[120:123], v[32:35], a[32:39], v2
    v_smfmac_f32_16x16x64_bf16 v[124:127], v[32:35], a[40:47], v2
    s_waitcnt lgkmcnt(0)
    s_barrier
    ds_read_b64_tr_b16 v[72:73], v9 offset:0
    ds_read_b64_tr_b16 v[74:75], v9 offset:256
    ds_read_b64_tr_b16 v[80:81], v10 offset:0
    ds_read_b64_tr_b16 v[82:83], v10 offset:512
    ds_read_b64_tr_b16 v[76:77], v9 offset:512
    ds_read_b64_tr_b16 v[78:79], v9 offset:768
    ds_read_b64_tr_b16 v[84:85], v10 offset:1024
    ds_read_b64_tr_b16 v[86:87], v10 offset:1536
    ds_read_b64_tr_b16 v[116:117], v9 offset:1024
    ds_read_b64_tr_b16 v[118:119], v9 offset:1280
    v_smfmac_f32_16x16x64_bf16 v[120:123], v[36:39], a[48:55], v2
    v_smfmac_f32_16x16x64_bf16 v[124:127], v[36:39], a[56:63], v2
    v_smfmac_f32_16x16x64_bf16 v[120:123], v[40:43], a[64:71], v2
    ds_read_b128 v[56:59], v1 offset:10240
    s_waitcnt lgkmcnt(9)
    v_mfma_f32_16x16x32_bf16 v[104:107], v[88:91], v[72:75], 0
    ds_read_b128 v[60:63], v1 offset:14336
    v_mfma_f32_16x16x32_bf16 v[108:111], v[92:95], v[72:75], 0
    ds_read_b128 v[64:67], v1 offset:11264
    s_waitcnt lgkmcnt(9)
    v_mfma_f32_16x16x32_bf16 v[112:115], v[80:83], v[72:75], 0
    ds_read_b128 v[68:71], v1 offset:15360
    s_waitcnt lgkmcnt(8)
    v_mfma_f32_16x16x32_bf16 v[104:107], v[96:99], v[76:79], v[104:107]
    ds_read_b64_tr_b16 v[80:81], v10 offset:2048
    ds_read_b64_tr_b16 v[82:83], v10 offset:2560
    v_mfma_f32_16x16x32_bf16 v[108:111], v[100:103], v[76:79], v[108:111]
    ds_read_b64_tr_b16 v[72:73], v9 offset:1536
    ds_read_b64_tr_b16 v[74:75], v9 offset:1792
    s_waitcnt lgkmcnt(10)
    v_mfma_f32_16x16x32_bf16 v[112:115], v[84:87], v[76:79], v[112:115]
    ds_read_b64_tr_b16 v[84:85], v10 offset:3072
    ds_read_b64_tr_b16 v[86:87], v10 offset:3584
    s_waitcnt lgkmcnt(9)
    v_mfma_f32_16x16x32_bf16 v[104:107], v[56:59], v[116:119], v[104:107]
    s_waitcnt lgkmcnt(8)
    v_mfma_f32_16x16x32_bf16 v[108:111], v[60:63], v[116:119], v[108:111]
    s_waitcnt vmcnt(6)
    s_waitcnt lgkmcnt(4)
    v_mfma_f32_16x16x32_bf16 v[112:115], v[80:83], v[116:119], v[112:115]
    ds_read_b128 v[88:91], v11 offset:0
    ds_read_b128 v[92:95], v11 offset:1024
    s_waitcnt lgkmcnt(4)
    v_mfma_f32_16x16x32_bf16 v[104:107], v[64:67], v[72:75], v[104:107]
    v_mfma_f32_16x16x32_bf16 v[108:111], v[68:71], v[72:75], v[108:111]
    s_waitcnt lgkmcnt(2)
    v_mfma_f32_16x16x32_bf16 v[112:115], v[84:87], v[72:75], v[112:115]
    v_smfmac_f32_16x16x64_bf16 v[124:127], v[40:43], a[72:79], v2
    v_smfmac_f32_16x16x64_bf16 v[120:123], v[44:47], a[80:87], v2
    s_nop 2
    v_max3_f32 v22, v104, v105, v106
    v_max3_f32 v23, v107, v108, v109
    v_max3_f32 v22, v22, v110, v111
    v_max3_f32 v23, v23, v112, v113
    v_max_f32 v22, v22, v23
    v_mov_b32 v23, v22
    v_smfmac_f32_16x16x64_bf16 v[124:127], v[44:47], a[88:95], v2
    s_nop 0
    v_permlane16_swap_b32 v23, v22
    v_max_f32 v22, v22, v23
    v_mov_b32 v23, v22
    v_smfmac_f32_16x16x64_bf16 v[120:123], v[48:51], a[96:103], v2
    s_nop 0
    v_permlane32_swap_b32 v23, v22
    v_max_f32 v22, v22, v23
    v_mul_f32 v22, s33, v22
    v_pk_fma_f32 v[104:105], v[104:105], s[76:77], v[22:23] op_sel_hi:[1,0,0] neg_lo:[0,0,1] neg_hi:[0,0,1]
    v_pk_fma_f32 v[106:107], v[106:107], s[76:77], v[22:23] op_sel_hi:[1,0,0] neg_lo:[0,0,1] neg_hi:[0,0,1]
    v_pk_fma_f32 v[108:109], v[108:109], s[76:77], v[22:23] op_sel_hi:[1,0,0] neg_lo:[0,0,1] neg_hi:[0,0,1]
    v_pk_fma_f32 v[110:111], v[110:111], s[76:77], v[22:23] op_sel_hi:[1,0,0] neg_lo:[0,0,1] neg_hi:[0,0,1]
    v_pk_fma_f32 v[112:113], v[112:113], s[76:77], v[22:23] op_sel_hi:[1,0,0] neg_lo:[0,0,1] neg_hi:[0,0,1]
    v_smfmac_f32_16x16x64_bf16 v[124:127], v[48:51], a[104:111], v2
    v_smfmac_f32_16x16x64_bf16 v[120:123], v[52:55], a[112:119], v2
    v_smfmac_f32_16x16x64_bf16 v[124:127], v[52:55], a[120:127], v2
    v_exp_f32 v104, v104
    v_exp_f32 v105, v105
    v_exp_f32 v106, v106
    v_exp_f32 v107, v107
    v_exp_f32 v108, v108
    v_exp_f32 v109, v109
    v_exp_f32 v110, v110
    v_exp_f32 v111, v111
    v_cvt_pk_bf16_f32 v72, v104, v105
    v_cvt_pk_bf16_f32 v73, v106, v107
    v_cvt_pk_bf16_f32 v74, v108, v109
    v_cvt_pk_bf16_f32 v75, v110, v111
    s_waitcnt lgkmcnt(1)
    s_nop 0
    v_mfma_f32_16x16x32_bf16 v[56:59], v[88:91], v[72:75], 0
    v_exp_f32 v112, v112
    s_waitcnt lgkmcnt(0)
    v_mfma_f32_16x16x32_bf16 v[60:63], v[92:95], v[72:75], 0
    v_exp_f32 v113, v113
    v_cvt_pk_bf16_f32 v44, v120, v121
    v_cvt_pk_bf16_f32 v45, v122, v123
    v_cvt_pk_bf16_f32 v46, v124, v125
    v_cvt_pk_bf16_f32 v47, v126, v127
    v_cvt_pk_bf16_f32 v76, v112, v113
    v_cvt_pk_bf16_f32 v77, v112, v113
    v_pk_add_f32 v[104:105], v[104:105], v[106:107]
    v_pk_add_f32 v[108:109], v[108:109], v[110:111]
    v_mfma_f32_16x16x16_bf16 v[56:59], v[44:45], v[76:77], v[56:59]
    v_pk_add_f32 v[104:105], v[104:105], v[112:113]
    v_pk_add_f32 v[104:105], v[104:105], v[108:109]
    v_mfma_f32_16x16x16_bf16 v[60:63], v[46:47], v[76:77], v[60:63]
    v_add_f32 v104, v104, v105
    v_mov_b32 v105, v104
    v_mov_b64 v[24:25], 0
    v_mov_b64 v[26:27], 0
    v_permlane16_swap_b32 v105, v104
    v_add_f32 v104, v104, v105
    v_mov_b32 v105, v104
    v_mov_b64 v[28:29], 0
    v_mov_b64 v[30:31], 0
    v_permlane32_swap_b32 v105, v104
    v_add_f32 v104, v104, v105
    v_rcp_f32 v22, v104
    v_mov_b64 v[32:33], 0
    v_pk_mul_f32 v[56:57], v[56:57], v[22:23] op_sel_hi:[1,0]
    v_pk_mul_f32 v[58:59], v[58:59], v[22:23] op_sel_hi:[1,0]
    v_pk_mul_f32 v[60:61], v[60:61], v[22:23] op_sel_hi:[1,0]
    v_pk_mul_f32 v[62:63], v[62:63], v[22:23] op_sel_hi:[1,0]
    v_cvt_pk_bf16_f32 v88, v56, v57
    v_cvt_pk_bf16_f32 v89, v58, v59
    v_cvt_pk_bf16_f32 v90, v60, v61
    v_cvt_pk_bf16_f32 v91, v62, v63
    ds_write_b128 v11, v[88:91]
    v_mov_b64 v[34:35], 0
    v_mov_b64 v[36:37], 0
    v_mov_b64 v[38:39], 0
    v_smfmac_f32_16x16x64_bf16 v[24:27], v[88:91], a[128:135], v3
    v_xor_b32 v64, 0x800, v11
    v_smfmac_f32_16x16x64_bf16 v[28:31], v[88:91], a[160:167], v3
    v_xor_b32 v65, 0x1000, v11
    v_smfmac_f32_16x16x64_bf16 v[32:35], v[88:91], a[192:199], v3
    v_xor_b32 v66, 0x1800, v11
    v_add_u32 v67, s37, v10
    s_cmp_eq_u32 s13, 63
    s_waitcnt lgkmcnt(0)
    s_barrier
    ds_read_b128 v[92:95], v64
    ds_read_b128 v[96:99], v65
    ds_read_b128 v[100:103], v66
    ds_read_b64_tr_b16 v[40:41], v67 offset:0
    ds_read_b64_tr_b16 v[42:43], v67 offset:512
    s_cbranch_scc1 L_DONE
    v_smfmac_f32_16x16x64_bf16 v[36:39], v[88:91], a[224:231], v3
    s_waitcnt lgkmcnt(4)
    v_smfmac_f32_16x16x64_bf16 v[24:27], v[92:95], a[136:143], v3
    v_smfmac_f32_16x16x64_bf16 v[28:31], v[92:95], a[168:175], v3
    s_waitcnt lgkmcnt(3)
    v_smfmac_f32_16x16x64_bf16 v[24:27], v[96:99], a[144:151], v3
    v_smfmac_f32_16x16x64_bf16 v[28:31], v[96:99], a[176:183], v3
    s_waitcnt lgkmcnt(2)
    v_smfmac_f32_16x16x64_bf16 v[24:27], v[100:103], a[152:159], v3
    v_smfmac_f32_16x16x64_bf16 v[28:31], v[100:103], a[184:191], v3
    v_smfmac_f32_16x16x64_bf16 v[32:35], v[92:95], a[200:207], v3
    v_smfmac_f32_16x16x64_bf16 v[36:39], v[92:95], a[232:239], v3
    v_smfmac_f32_16x16x64_bf16 v[32:35], v[96:99], a[208:215], v3
    v_smfmac_f32_16x16x64_bf16 v[36:39], v[96:99], a[240:247], v3
    s_nop 2
    v_cvt_pk_bf16_f32 v72, v24, v25
    v_smfmac_f32_16x16x64_bf16 v[32:35], v[100:103], a[216:223], v3
    v_cvt_pk_bf16_f32 v73, v26, v27
    v_smfmac_f32_16x16x64_bf16 v[36:39], v[100:103], a[248:255], v3
    v_cvt_pk_bf16_f32 v74, v28, v29
    v_cvt_pk_bf16_f32 v75, v30, v31
    v_bfi_b32 v72, 1, s15, v72
    buffer_store_dwordx4 v[72:75], v12, s[4:7], s16 offen
    s_nop 1
    v_cvt_pk_bf16_f32 v76, v32, v33
    v_cvt_pk_bf16_f32 v77, v34, v35
    v_cvt_pk_bf16_f32 v78, v36, v37
    v_cvt_pk_bf16_f32 v79, v38, v39
    v_bfi_b32 v76, 1, s15, v76
    buffer_store_dwordx4 v[76:79], v12, s[4:7], s17 offen
    s_add_u32 s24, s24, 262144
    s_mov_b32 m0, s34
    s_add_u32 s25, s25, 262144
    buffer_load_dwordx4 v1, s[4:7], s24 offen lds
    buffer_load_dwordx4 v1, s[4:7], s24 offen offset:1024 lds
    v_bfe_u32 v22, v1, 4, 4
    v_and_b32 v23, 16, v1
    s_waitcnt vmcnt(5)
    v_mov_b32 v20, 0x3f80
    v_lshlrev_b32 v20, v23, v20
    v_lshrrev_b32 v22, 1, v22
    v_cmp_eq_u32 s[8:9], 0, v22
    v_mov_b32 v32, 0
    v_cmp_eq_u32 s[10:11], 1, v22
    v_mov_b32 v33, 0
    v_cndmask_b32 v32, v32, v20, s[8:9]
    v_cndmask_b32 v33, v33, v20, s[10:11]
    v_cmp_eq_u32 s[8:9], 2, v22
    v_mov_b32 v34, 0
    v_cmp_eq_u32 s[10:11], 3, v22
    v_mov_b32 v35, 0
    v_cndmask_b32 v34, v34, v20, s[8:9]
    v_cndmask_b32 v35, v35, v20, s[10:11]
    s_nop 15
    s_nop 15
    s_nop 15
    s_nop 1
    s_cmp_lt_u32 s3, 2
    s_cbranch_scc1 L_D1S
    s_nop 15
    s_nop 15
    s_nop 4
L_D1S:
    buffer_load_dwordx4 v[24:27], v17, s[4:7], s20 offen offset:0 sc1
    buffer_load_dwordx4 v[28:31], v17, s[4:7], s20 offen offset:2048 sc1
    ds_read_b128 v[56:59], v5 offset:0
    ds_read_b128 v[60:63], v5 offset:1024
    ds_read_b128 v[64:67], v5 offset:2048
    ds_read_b128 v[68:71], v5 offset:3072
    ds_read_b128 v[72:75], v5 offset:4096
    ds_read_b128 v[76:79], v5 offset:5120
    ds_read_b128 v[80:83], v5 offset:6144
    ds_read_b128 v[84:87], v5 offset:7168
    ds_read_b128 v[88:91], v5 offset:32768
    ds_read_b128 v[92:95], v5 offset:33792
    ds_read_b128 v[96:99], v5 offset:34816
    ds_read_b128 v[100:103], v5 offset:35840
    s_waitcnt vmcnt(6)
    v_readfirstlane_b32 s30, v0
    s_nop 0
    s_cmp_ge_u32 s30, s89
    s_cbranch_scc0 L_KVWAIT
L_KVOK:
    s_add_u32 s30, s13, 3
    s_lshr_b32 s89, s30, 2
    s_add_u32 s89, s89, 1
    s_cmp_lt_u32 s30, 64
    s_cselect_b32 s89, s89, 0
    s_and_b32 s30, s30, 3
    s_lshl_b32 s30, s30, 7
    s_add_u32 s88, s90, s30
    s_mov_b32 s79, s13
    s_add_u32 s13, s13, 1
    s_lshr_b32 s30, s13, 1
    s_and_b32 s30, s30, 1
    s_xor_b32 s14, s30, 1
    s_xor_b32 s16, s16, 0x40000
    s_xor_b32 s17, s17, 0x40000
    s_mov_b32 s30, s21
    s_mov_b32 s21, s22
    s_mov_b32 s18, s22
    s_mov_b32 s22, s23
    s_mov_b32 s23, s30
    s_add_u32 s26, s26, 262144
    s_add_u32 s27, s27, 131072
    s_add_u32 s28, s28, 131072
    s_mov_b32 s29, 0
L_PCHECK:
    s_waitcnt vmcnt(0)
    v_mfma_f32_16x16x32_bf16 v[36:39], v[24:27], v[32:35], 0
    v_bitop3_b32 v22, -1, v24, s15 bitop3:0x90
    v_bitop3_b32 v22, v22, v28, s15 bitop3:0x90
    v_mfma_f32_16x16x32_bf16 v[36:39], v[28:31], v[32:35], v[36:39]
    v_and_b32 v22, 1, v22
    v_cmp_eq_u32 vcc, 0, v22
    s_cbranch_vccnz L_PFAIL
L_POK:
    s_mov_b32 s15, s14
    s_xor_b32 s20, s20, 0x40000
    s_nop 2
    v_permlane32_swap_b32 v36, v37
    v_permlane32_swap_b32 v38, v39
    v_add_f32 v36, v36, v37
    v_add_f32 v38, v38, v39
    s_nop 1
    v_permlane16_swap_b32 v36, v38
    v_add_f32 v36, v36, v38
    v_mov_b32 v37, v36
    s_nop 1
    v_permlane32_swap_b32 v36, v37
    v_cvt_pk_bf16_f32 v36, v36, v37
    v_min_u32 v36, 0xfffffffe, v36
    buffer_store_dword v36, v13, s[4:7], s18 offen
    s_nop 15
    s_nop 15
    s_nop 15
    s_nop 15
    s_nop 10
    s_branch L_STEP
L_KVWAIT:
    s_add_u32 s29, s29, 1
    s_cmp_gt_u32 s29, 800000
    s_cbranch_scc1 L_BAIL
    buffer_load_dword v0, off, s[4:7], s88 sc1
    s_waitcnt vmcnt(0)
    s_nop 0
    v_readfirstlane_b32 s30, v0
    s_nop 1
    s_cmp_ge_u32 s30, s89
    s_cbranch_scc0 L_KVWAIT
    s_mov_b32 s29, 0
    s_branch L_KVOK
L_GFAIL:
    s_add_u32 s29, s29, 1
    s_add_u32 s78, s78, 0x1
    s_cmp_lt_u32 s29, 200000
    s_cbranch_scc0 L_BAIL
    s_mov_b64 exec, vcc
    buffer_load_dwordx4 v[24:27], v14, s[4:7], s21 offen sc1
    buffer_load_dwordx4 v[28:31], v14, s[4:7], s21 offen offset:1024 sc1
    s_mov_b64 exec, -1
    s_branch L_GCHECK
L_PFAIL:
    s_add_u32 s29, s29, 1
    s_add_u32 s78, s78, 0x10000
    s_cmp_lt_u32 s29, 200000
    s_cbranch_scc0 L_BAIL
    s_mov_b64 exec, vcc
    buffer_load_dwordx4 v[24:27], v17, s[4:7], s20 offen offset:0 sc1
    buffer_load_dwordx4 v[28:31], v17, s[4:7], s20 offen offset:2048 sc1
    s_mov_b64 exec, -1
    s_branch L_PCHECK
L_DONE:
    s_waitcnt lgkmcnt(0)
    s_add_u32 s27, s27, 131072
    s_add_u32 s28, s28, 131072
    buffer_store_dwordx4 v[40:43], v1, s[4:7], s27 offen sc1
    buffer_store_dwordx4 v[44:47], v1, s[4:7], s28 offen sc1
    s_waitcnt vmcnt(0)
    s_barrier
    v_mov_b32 v19, 64
    buffer_store_dword v19, v21, s[4:7], s36 offen sc1
    s_waitcnt vmcnt(0)
    s_endpgm
L_BAIL:
    s_load_dwordx2 s[96:97], s[0:1], 96
    v_mov_b32 v120, 0x100
    v_or_b32 v120, s13, v120
    v_mov_b32 v121, 208
    s_waitcnt lgkmcnt(0)
    global_store_dword v121, v120, s[96:97]
    s_waitcnt vmcnt(0)
    s_endpgm
L_WORKER:
    s_load_dwordx2 s[4:5], s[0:1], 104
    v_lshrrev_b32 v1, 6, v0
    s_nop 0
    v_readfirstlane_b32 s3, v1
    v_and_b32 v0, 63, v0
    s_waitcnt lgkmcnt(0)
    s_mov_b32 s6, 0x10000000
    s_mov_b32 s7, 0x20000
    s_sub_u32 s80, s92, 1
    s_mov_b32 s81, s93
    s_mov_b32 s12, s80
    s_mov_b32 s13, s81
    s_lshl_b32 s20, s12, 22
    s_add_u32 s20, s20, 0x4a10000
    s_lshl_b32 s21, s13, 2
    s_add_u32 s20, s20, s21
    v_lshlrev_b32 v120, 7, v0
    v_mov_b32 v121, 0x40000000
    v_cmp_gt_u32 vcc, 3, v0
    s_nop 1
    v_cndmask_b32 v120, v121, v120, vcc
    v_mov_b32 v121, 0
    buffer_store_dword v121, v120, s[4:7], s20 offen
    s_cmp_eq_u32 s80, 6
    s_cbranch_scc1 L_LN
    s_lshl_b32 s12, s80, 3
    s_lshr_b32 s20, s81, 2
    s_add_u32 s12, s12, s20
    s_and_b32 s13, s81, 3
    s_lshl_b32 s20, s12, 2
    s_add_u32 s20, s20, s13
    s_lshl_b32 s20, s20, 7
    s_add_u32 s20, s20, 0x4420000
    v_mov_b32 v120, 0
    buffer_store_dword v120, off, s[4:7], s20 sc1
    s_waitcnt vmcnt(0)
    s_barrier
    s_load_dwordx2 s[96:97], s[0:1], 96
    v_mov_b32 v120, 192
    v_mov_b32 v121, 1
    v_or_b32 v122, s3, v0
    s_waitcnt lgkmcnt(0)
    v_cmp_eq_u32 vcc, 0, v122
    s_and_saveexec_b64 s[98:99], vcc
    s_cbranch_execz L_ADQ
    global_atomic_add v120, v121, s[96:97]
L_ADQ:
    s_mov_b64 exec, s[98:99]
    s_cmp_lt_u32 s12, 32
    s_cbranch_scc1 L_QNOW
    s_load_dwordx2 s[96:97], s[0:1], 96
    v_mov_b32 v120, 196
    s_mov_b32 s94, 0
    s_waitcnt lgkmcnt(0)
L_WDQE:
    global_load_dword v121, v120, s[96:97] sc1
    s_waitcnt vmcnt(0)
    v_readfirstlane_b32 s95, v121
    s_add_u32 s94, s94, 1
    s_cmp_gt_u32 s94, 2000000
    s_cbranch_scc1 L_GBAIL
    s_cmp_ge_u32 s95, 32
    s_cbranch_scc1 L_WDOKQE
    s_sleep 4
    s_branch L_WDQE
L_WDOKQE:
L_QNOW:
    s_load_dwordx4 s[48:51], s[0:1], 16
    s_load_dwordx2 s[52:53], s[0:1], 32
    v_lshlrev_b32 v1, 4, v0
    v_bfe_u32 v6, v0, 4, 1
    v_lshlrev_b32 v6, 1, v6
    v_and_b32 v7, 15, v0
    v_xor_b32 v6, v6, v7
    v_xor_b32 v6, 0, v6
    v_lshlrev_b32 v6, 4, v6
    v_lshrrev_b32 v7, 4, v0
    v_lshl_add_u32 v8, v7, 13, v6
    v_bfe_u32 v6, v0, 4, 1
    v_lshlrev_b32 v6, 1, v6
    v_and_b32 v7, 15, v0
    v_xor_b32 v6, v6, v7
    v_xor_b32 v6, 4, v6
    v_lshlrev_b32 v6, 4, v6
    v_lshrrev_b32 v7, 4, v0
    v_lshl_add_u32 v9, v7, 13, v6
    v_bfe_u32 v6, v0, 4, 1
    v_lshlrev_b32 v6, 1, v6
    v_and_b32 v7, 15, v0
    v_xor_b32 v6, v6, v7
    v_xor_b32 v6, 8, v6
    v_lshlrev_b32 v6, 4, v6
    v_lshrrev_b32 v7, 4, v0
    v_lshl_add_u32 v10, v7, 13, v6
    v_bfe_u32 v6, v0, 4, 1
    v_lshlrev_b32 v6, 1, v6
    v_and_b32 v7, 15, v0
    v_xor_b32 v6, v6, v7
    v_xor_b32 v6, 12, v6
    v_lshlrev_b32 v6, 4, v6
    v_lshrrev_b32 v7, 4, v0
    v_lshl_add_u32 v11, v7, 13, v6
    s_waitcnt lgkmcnt(0)
    s_lshr_b32 s20, s3, 1
    s_cmp_lt_u32 s12, 32
    s_cbranch_scc0 L_QKV_ISQ
    s_cmp_eq_u32 s20, 0
    s_cselect_b32 s56, s50, s52
    s_cselect_b32 s57, s51, s53
    s_mov_b32 s54, s12
    s_mov_b32 s16, s20
    s_branch L_QKV_SRC
L_QKV_ISQ:
    s_mov_b32 s56, s48
    s_mov_b32 s57, s49
    s_sub_u32 s54, s12, 32
    s_lshl_b32 s54, s54, 1
    s_add_u32 s54, s54, s20
    s_mov_b32 s16, 0
L_QKV_SRC:
    s_mov_b32 s58, 0x400000
    s_mov_b32 s59, 0x20000
    v_bfe_u32 v6, v0, 5, 1
    v_lshlrev_b32 v6, 3, v6
    v_bfe_u32 v7, v0, 2, 2
    v_add_u32 v6, v6, v7
    v_add_u32 v6, 0, v6
    v_lshlrev_b32 v12, 8, v6
    v_bfe_u32 v6, v0, 2, 1
    v_lshlrev_b32 v6, 1, v6
    v_bfe_u32 v7, v0, 5, 1
    v_lshl_add_u32 v6, v7, 3, v6
    v_or_b32 v6, 0, v6
    v_bfe_u32 v7, v0, 4, 1
    v_lshlrev_b32 v7, 1, v7
    v_bfe_u32 v16, v0, 1, 1
    v_add_u32 v7, v7, v16
    s_and_b32 s21, s3, 1
    s_lshl_b32 s21, s21, 3
    s_add_u32 s21, s21, 0
    v_add_u32 v7, s21, v7
    v_xor_b32 v6, v6, v7
    v_lshlrev_b32 v6, 4, v6
    v_and_b32 v7, 1, v0
    v_lshl_add_u32 v6, v7, 3, v6
    v_add_u32 v12, v12, v6
    s_lshr_b32 s21, s3, 1
    s_lshl_b32 s21, s21, 14
    v_add_u32 v12, s21, v12
    v_bfe_u32 v6, v0, 5, 1
    v_lshlrev_b32 v6, 3, v6
    v_bfe_u32 v7, v0, 2, 2
    v_add_u32 v6, v6, v7
    v_add_u32 v6, 4, v6
    v_lshlrev_b32 v13, 8, v6
    v_bfe_u32 v6, v0, 2, 1
    v_lshlrev_b32 v6, 1, v6
    v_bfe_u32 v7, v0, 5, 1
    v_lshl_add_u32 v6, v7, 3, v6
    v_or_b32 v6, 4, v6
    v_bfe_u32 v7, v0, 4, 1
    v_lshlrev_b32 v7, 1, v7
    v_bfe_u32 v16, v0, 1, 1
    v_add_u32 v7, v7, v16
    s_and_b32 s21, s3, 1
    s_lshl_b32 s21, s21, 3
    s_add_u32 s21, s21, 0
    v_add_u32 v7, s21, v7
    v_xor_b32 v6, v6, v7
    v_lshlrev_b32 v6, 4, v6
    v_and_b32 v7, 1, v0
    v_lshl_add_u32 v6, v7, 3, v6
    v_add_u32 v13, v13, v6
    s_lshr_b32 s21, s3, 1
    s_lshl_b32 s21, s21, 14
    v_add_u32 v13, s21, v13
    v_bfe_u32 v6, v0, 5, 1
    v_lshlrev_b32 v6, 3, v6
    v_bfe_u32 v7, v0, 2, 2
    v_add_u32 v6, v6, v7
    v_add_u32 v6, 0, v6
    v_lshlrev_b32 v14, 8, v6
    v_bfe_u32 v6, v0, 2, 1
    v_lshlrev_b32 v6, 1, v6
    v_bfe_u32 v7, v0, 5, 1
    v_lshl_add_u32 v6, v7, 3, v6
    v_or_b32 v6, 0, v6
    v_bfe_u32 v7, v0, 4, 1
    v_lshlrev_b32 v7, 1, v7
    v_bfe_u32 v16, v0, 1, 1
    v_add_u32 v7, v7, v16
    s_and_b32 s21, s3, 1
    s_lshl_b32 s21, s21, 3
    s_add_u32 s21, s21, 4
    v_add_u32 v7, s21, v7
    v_xor_b32 v6, v6, v7
    v_lshlrev_b32 v6, 4, v6
    v_and_b32 v7, 1, v0
    v_lshl_add_u32 v6, v7, 3, v6
    v_add_u32 v14, v14, v6
    s_lshr_b32 s21, s3, 1
    s_lshl_b32 s21, s21, 14
    v_add_u32 v14, s21, v14
    v_bfe_u32 v6, v0, 5, 1
    v_lshlrev_b32 v6, 3, v6
    v_bfe_u32 v7, v0, 2, 2
    v_add_u32 v6, v6, v7
    v_add_u32 v6, 4, v6
    v_lshlrev_b32 v15, 8, v6
    v_bfe_u32 v6, v0, 2, 1
    v_lshlrev_b32 v6, 1, v6
    v_bfe_u32 v7, v0, 5, 1
    v_lshl_add_u32 v6, v7, 3, v6
    v_or_b32 v6, 4, v6
    v_bfe_u32 v7, v0, 4, 1
    v_lshlrev_b32 v7, 1, v7
    v_bfe_u32 v16, v0, 1, 1
    v_add_u32 v7, v7, v16
    s_and_b32 s21, s3, 1
    s_lshl_b32 s21, s21, 3
    s_add_u32 s21, s21, 4
    v_add_u32 v7, s21, v7
    v_xor_b32 v6, v6, v7
    v_lshlrev_b32 v6, 4, v6
    v_and_b32 v7, 1, v0
    v_lshl_add_u32 v6, v7, 3, v6
    v_add_u32 v15, v15, v6
    s_lshr_b32 s21, s3, 1
    s_lshl_b32 s21, s21, 14
    v_add_u32 v15, s21, v15
    s_and_b32 s20, s3, 1
    s_lshl_b32 s20, s20, 5
    s_add_u32 s20, s20, 0
    s_lshl_b32 s20, s20, 13
    s_lshl_b32 s21, s54, 8
    s_add_u32 s20, s20, s21
    s_lshl_b32 s22, s3, 13
    s_add_u32 s22, s22, 0
    s_mov_b32 m0, s22
    s_add_u32 s22, s22, 1024
    buffer_load_dwordx4 v8, s[56:59], s20 offen lds
    s_add_u32 s20, s20, 32768
    s_mov_b32 m0, s22
    s_add_u32 s22, s22, 1024
    buffer_load_dwordx4 v9, s[56:59], s20 offen lds
    s_add_u32 s20, s20, 32768
    s_mov_b32 m0, s22
    s_add_u32 s22, s22, 1024
    buffer_load_dwordx4 v10, s[56:59], s20 offen lds
    s_add_u32 s20, s20, 32768
    s_mov_b32 m0, s22
    s_add_u32 s22, s22, 1024
    buffer_load_dwordx4 v11, s[56:59], s20 offen lds
    s_add_u32 s20, s20, 32768
    s_mov_b32 m0, s22
    s_add_u32 s22, s22, 1024
    buffer_load_dwordx4 v8, s[56:59], s20 offen lds
    s_add_u32 s20, s20, 32768
    s_mov_b32 m0, s22
    s_add_u32 s22, s22, 1024
    buffer_load_dwordx4 v9, s[56:59], s20 offen lds
    s_add_u32 s20, s20, 32768
    s_mov_b32 m0, s22
    s_add_u32 s22, s22, 1024
    buffer_load_dwordx4 v10, s[56:59], s20 offen lds
    s_add_u32 s20, s20, 32768
    s_mov_b32 m0, s22
    s_add_u32 s22, s22, 1024
    buffer_load_dwordx4 v11, s[56:59], s20 offen lds
    s_add_u32 s20, s20, 32768
    s_and_b32 s20, s3, 1
    s_lshl_b32 s20, s20, 5
    s_add_u32 s20, s20, 64
    s_lshl_b32 s20, s20, 13
    s_lshl_b32 s21, s54, 8
    s_add_u32 s20, s20, s21
    s_lshl_b32 s22, s3, 13
    s_add_u32 s22, s22, 32768
    s_mov_b32 m0, s22
    s_add_u32 s22, s22, 1024
    buffer_load_dwordx4 v8, s[56:59], s20 offen lds
    s_add_u32 s20, s20, 32768
    s_mov_b32 m0, s22
    s_add_u32 s22, s22, 1024
    buffer_load_dwordx4 v9, s[56:59], s20 offen lds
    s_add_u32 s20, s20, 32768
    s_mov_b32 m0, s22
    s_add_u32 s22, s22, 1024
    buffer_load_dwordx4 v10, s[56:59], s20 offen lds
    s_add_u32 s20, s20, 32768
    s_mov_b32 m0, s22
    s_add_u32 s22, s22, 1024
    buffer_load_dwordx4 v11, s[56:59], s20 offen lds
    s_add_u32 s20, s20, 32768
    s_mov_b32 m0, s22
    s_add_u32 s22, s22, 1024
    buffer_load_dwordx4 v8, s[56:59], s20 offen lds
    s_add_u32 s20, s20, 32768
    s_mov_b32 m0, s22
    s_add_u32 s22, s22, 1024
    buffer_load_dwordx4 v9, s[56:59], s20 offen lds
    s_add_u32 s20, s20, 32768
    s_mov_b32 m0, s22
    s_add_u32 s22, s22, 1024
    buffer_load_dwordx4 v10, s[56:59], s20 offen lds
    s_add_u32 s20, s20, 32768
    s_mov_b32 m0, s22
    s_add_u32 s22, s22, 1024
    buffer_load_dwordx4 v11, s[56:59], s20 offen lds
    s_add_u32 s20, s20, 32768
    s_and_b32 s20, s3, 1
    s_lshl_b32 s20, s20, 5
    s_add_u32 s20, s20, 128
    s_lshl_b32 s20, s20, 13
    s_lshl_b32 s21, s54, 8
    s_add_u32 s20, s20, s21
    s_lshl_b32 s22, s3, 13
    s_add_u32 s22, s22, 65536
    s_mov_b32 m0, s22
    s_add_u32 s22, s22, 1024
    buffer_load_dwordx4 v8, s[56:59], s20 offen lds
    s_add_u32 s20, s20, 32768
    s_mov_b32 m0, s22
    s_add_u32 s22, s22, 1024
    buffer_load_dwordx4 v9, s[56:59], s20 offen lds
    s_add_u32 s20, s20, 32768
    s_mov_b32 m0, s22
    s_add_u32 s22, s22, 1024
    buffer_load_dwordx4 v10, s[56:59], s20 offen lds
    s_add_u32 s20, s20, 32768
    s_mov_b32 m0, s22
    s_add_u32 s22, s22, 1024
    buffer_load_dwordx4 v11, s[56:59], s20 offen lds
    s_add_u32 s20, s20, 32768
    s_mov_b32 m0, s22
    s_add_u32 s22, s22, 1024
    buffer_load_dwordx4 v8, s[56:59], s20 offen lds
    s_add_u32 s20, s20, 32768
    s_mov_b32 m0, s22
    s_add_u32 s22, s22, 1024
    buffer_load_dwordx4 v9, s[56:59], s20 offen lds
    s_add_u32 s20, s20, 32768
    s_mov_b32 m0, s22
    s_add_u32 s22, s22, 1024
    buffer_load_dwordx4 v10, s[56:59], s20 offen lds
    s_add_u32 s20, s20, 32768
    s_mov_b32 m0, s22
    s_add_u32 s22, s22, 1024
    buffer_load_dwordx4 v11, s[56:59], s20 offen lds
    s_add_u32 s20, s20, 32768
    s_and_b32 s20, s3, 1
    s_lshl_b32 s20, s20, 5
    s_add_u32 s20, s20, 192
    s_lshl_b32 s20, s20, 13
    s_lshl_b32 s21, s54, 8
    s_add_u32 s20, s20, s21
    s_lshl_b32 s22, s3, 13
    s_add_u32 s22, s22, 98304
    s_mov_b32 m0, s22
    s_add_u32 s22, s22, 1024
    buffer_load_dwordx4 v8, s[56:59], s20 offen lds
    s_add_u32 s20, s20, 32768
    s_mov_b32 m0, s22
    s_add_u32 s22, s22, 1024
    buffer_load_dwordx4 v9, s[56:59], s20 offen lds
    s_add_u32 s20, s20, 32768
    s_mov_b32 m0, s22
    s_add_u32 s22, s22, 1024
    buffer_load_dwordx4 v10, s[56:59], s20 offen lds
    s_add_u32 s20, s20, 32768
    s_mov_b32 m0, s22
    s_add_u32 s22, s22, 1024
    buffer_load_dwordx4 v11, s[56:59], s20 offen lds
    s_add_u32 s20, s20, 32768
    s_mov_b32 m0, s22
    s_add_u32 s22, s22, 1024
    buffer_load_dwordx4 v8, s[56:59], s20 offen lds
    s_add_u32 s20, s20, 32768
    s_mov_b32 m0, s22
    s_add_u32 s22, s22, 1024
    buffer_load_dwordx4 v9, s[56:59], s20 offen lds
    s_add_u32 s20, s20, 32768
    s_mov_b32 m0, s22
    s_add_u32 s22, s22, 1024
    buffer_load_dwordx4 v10, s[56:59], s20 offen lds
    s_add_u32 s20, s20, 32768
    s_mov_b32 m0, s22
    s_add_u32 s22, s22, 1024
    buffer_load_dwordx4 v11, s[56:59], s20 offen lds
    s_add_u32 s20, s20, 32768
    s_waitcnt vmcnt(24)
    s_barrier
    v_add_u32 v16, 0, v12
    v_add_u32 v17, 0, v13
    v_add_u32 v18, 0, v14
    v_add_u32 v19, 0, v15
    ds_read_b64_tr_b16 a[0:1], v16 offset:0
    ds_read_b64_tr_b16 a[2:3], v17 offset:0
    ds_read_b64_tr_b16 a[4:5], v18 offset:0
    ds_read_b64_tr_b16 a[6:7], v19 offset:0
    ds_read_b64_tr_b16 a[8:9], v16 offset:4096
    ds_read_b64_tr_b16 a[10:11], v17 offset:4096
    ds_read_b64_tr_b16 a[12:13], v18 offset:4096
    ds_read_b64_tr_b16 a[14:15], v19 offset:4096
    ds_read_b64_tr_b16 a[16:17], v16 offset:8192
    ds_read_b64_tr_b16 a[18:19], v17 offset:8192
    ds_read_b64_tr_b16 a[20:21], v18 offset:8192
    ds_read_b64_tr_b16 a[22:23], v19 offset:8192
    ds_read_b64_tr_b16 a[24:25], v16 offset:12288
    ds_read_b64_tr_b16 a[26:27], v17 offset:12288
    ds_read_b64_tr_b16 a[28:29], v18 offset:12288
    ds_read_b64_tr_b16 a[30:31], v19 offset:12288
    s_waitcnt lgkmcnt(0)
    s_barrier
    s_and_b32 s20, s3, 1
    s_lshl_b32 s20, s20, 5
    s_add_u32 s20, s20, 256
    s_lshl_b32 s20, s20, 13
    s_lshl_b32 s21, s54, 8
    s_add_u32 s20, s20, s21
    s_lshl_b32 s22, s3, 13
    s_add_u32 s22, s22, 0
    s_mov_b32 m0, s22
    s_add_u32 s22, s22, 1024
    buffer_load_dwordx4 v8, s[56:59], s20 offen lds
    s_add_u32 s20, s20, 32768
    s_mov_b32 m0, s22
    s_add_u32 s22, s22, 1024
    buffer_load_dwordx4 v9, s[56:59], s20 offen lds
    s_add_u32 s20, s20, 32768
    s_mov_b32 m0, s22
    s_add_u32 s22, s22, 1024
    buffer_load_dwordx4 v10, s[56:59], s20 offen lds
    s_add_u32 s20, s20, 32768
    s_mov_b32 m0, s22
    s_add_u32 s22, s22, 1024
    buffer_load_dwordx4 v11, s[56:59], s20 offen lds
    s_add_u32 s20, s20, 32768
    s_mov_b32 m0, s22
    s_add_u32 s22, s22, 1024
    buffer_load_dwordx4 v8, s[56:59], s20 offen lds
    s_add_u32 s20, s20, 32768
    s_mov_b32 m0, s22
    s_add_u32 s22, s22, 1024
    buffer_load_dwordx4 v9, s[56:59], s20 offen lds
    s_add_u32 s20, s20, 32768
    s_mov_b32 m0, s22
    s_add_u32 s22, s22, 1024
    buffer_load_dwordx4 v10, s[56:59], s20 offen lds
    s_add_u32 s20, s20, 32768
    s_mov_b32 m0, s22
    s_add_u32 s22, s22, 1024
    buffer_load_dwordx4 v11, s[56:59], s20 offen lds
    s_add_u32 s20, s20, 32768
    s_waitcnt vmcnt(24)
    s_barrier
    v_add_u32 v16, 32768, v12
    v_add_u32 v17, 32768, v13
    v_add_u32 v18, 32768, v14
    v_add_u32 v19, 32768, v15
    ds_read_b64_tr_b16 a[32:33], v16 offset:0
    ds_read_b64_tr_b16 a[34:35], v17 offset:0
    ds_read_b64_tr_b16 a[36:37], v18 offset:0
    ds_read_b64_tr_b16 a[38:39], v19 offset:0
    ds_read_b64_tr_b16 a[40:41], v16 offset:4096
    ds_read_b64_tr_b16 a[42:43], v17 offset:4096
    ds_read_b64_tr_b16 a[44:45], v18 offset:4096
    ds_read_b64_tr_b16 a[46:47], v19 offset:4096
    ds_read_b64_tr_b16 a[48:49], v16 offset:8192
    ds_read_b64_tr_b16 a[50:51], v17 offset:8192
    ds_read_b64_tr_b16 a[52:53], v18 offset:8192
    ds_read_b64_tr_b16 a[54:55], v19 offset:8192
    ds_read_b64_tr_b16 a[56:57], v16 offset:12288
    ds_read_b64_tr_b16 a[58:59], v17 offset:12288
    ds_read_b64_tr_b16 a[60:61], v18 offset:12288
    ds_read_b64_tr_b16 a[62:63], v19 offset:12288
    s_waitcnt lgkmcnt(0)
    s_barrier
    s_and_b32 s20, s3, 1
    s_lshl_b32 s20, s20, 5
    s_add_u32 s20, s20, 320
    s_lshl_b32 s20, s20, 13
    s_lshl_b32 s21, s54, 8
    s_add_u32 s20, s20, s21
    s_lshl_b32 s22, s3, 13
    s_add_u32 s22, s22, 32768
    s_mov_b32 m0, s22
    s_add_u32 s22, s22, 1024
    buffer_load_dwordx4 v8, s[56:59], s20 offen lds
    s_add_u32 s20, s20, 32768
    s_mov_b32 m0, s22
    s_add_u32 s22, s22, 1024
    buffer_load_dwordx4 v9, s[56:59], s20 offen lds
    s_add_u32 s20, s20, 32768
    s_mov_b32 m0, s22
    s_add_u32 s22, s22, 1024
    buffer_load_dwordx4 v10, s[56:59], s20 offen lds
    s_add_u32 s20, s20, 32768
    s_mov_b32 m0, s22
    s_add_u32 s22, s22, 1024
    buffer_load_dwordx4 v11, s[56:59], s20 offen lds
    s_add_u32 s20, s20, 32768
    s_mov_b32 m0, s22
    s_add_u32 s22, s22, 1024
    buffer_load_dwordx4 v8, s[56:59], s20 offen lds
    s_add_u32 s20, s20, 32768
    s_mov_b32 m0, s22
    s_add_u32 s22, s22, 1024
    buffer_load_dwordx4 v9, s[56:59], s20 offen lds
    s_add_u32 s20, s20, 32768
    s_mov_b32 m0, s22
    s_add_u32 s22, s22, 1024
    buffer_load_dwordx4 v10, s[56:59], s20 offen lds
    s_add_u32 s20, s20, 32768
    s_mov_b32 m0, s22
    s_add_u32 s22, s22, 1024
    buffer_load_dwordx4 v11, s[56:59], s20 offen lds
    s_add_u32 s20, s20, 32768
    s_waitcnt vmcnt(24)
    s_barrier
    v_add_u32 v16, 65536, v12
    v_add_u32 v17, 65536, v13
    v_add_u32 v18, 65536, v14
    v_add_u32 v19, 65536, v15
    ds_read_b64_tr_b16 a[64:65], v16 offset:0
    ds_read_b64_tr_b16 a[66:67], v17 offset:0
    ds_read_b64_tr_b16 a[68:69], v18 offset:0
    ds_read_b64_tr_b16 a[70:71], v19 offset:0
    ds_read_b64_tr_b16 a[72:73], v16 offset:4096
    ds_read_b64_tr_b16 a[74:75], v17 offset:4096
    ds_read_b64_tr_b16 a[76:77], v18 offset:4096
    ds_read_b64_tr_b16 a[78:79], v19 offset:4096
    ds_read_b64_tr_b16 a[80:81], v16 offset:8192
    ds_read_b64_tr_b16 a[82:83], v17 offset:8192
    ds_read_b64_tr_b16 a[84:85], v18 offset:8192
    ds_read_b64_tr_b16 a[86:87], v19 offset:8192
    ds_read_b64_tr_b16 a[88:89], v16 offset:12288
    ds_read_b64_tr_b16 a[90:91], v17 offset:12288
    ds_read_b64_tr_b16 a[92:93], v18 offset:12288
    ds_read_b64_tr_b16 a[94:95], v19 offset:12288
    s_waitcnt lgkmcnt(0)
    s_barrier
    s_and_b32 s20, s3, 1
    s_lshl_b32 s20, s20, 5
    s_add_u32 s20, s20, 384
    s_lshl_b32 s20, s20, 13
    s_lshl_b32 s21, s54, 8
    s_add_u32 s20, s20, s21
    s_lshl_b32 s22, s3, 13
    s_add_u32 s22, s22, 65536
    s_mov_b32 m0, s22
    s_add_u32 s22, s22, 1024
    buffer_load_dwordx4 v8, s[56:59], s20 offen lds
    s_add_u32 s20, s20, 32768
    s_mov_b32 m0, s22
    s_add_u32 s22, s22, 1024
    buffer_load_dwordx4 v9, s[56:59], s20 offen lds
    s_add_u32 s20, s20, 32768
    s_mov_b32 m0, s22
    s_add_u32 s22, s22, 1024
    buffer_load_dwordx4 v10, s[56:59], s20 offen lds
    s_add_u32 s20, s20, 32768
    s_mov_b32 m0, s22
    s_add_u32 s22, s22, 1024
    buffer_load_dwordx4 v11, s[56:59], s20 offen lds
    s_add_u32 s20, s20, 32768
    s_mov_b32 m0, s22
    s_add_u32 s22, s22, 1024
    buffer_load_dwordx4 v8, s[56:59], s20 offen lds
    s_add_u32 s20, s20, 32768
    s_mov_b32 m0, s22
    s_add_u32 s22, s22, 1024
    buffer_load_dwordx4 v9, s[56:59], s20 offen lds
    s_add_u32 s20, s20, 32768
    s_mov_b32 m0, s22
    s_add_u32 s22, s22, 1024
    buffer_load_dwordx4 v10, s[56:59], s20 offen lds
    s_add_u32 s20, s20, 32768
    s_mov_b32 m0, s22
    s_add_u32 s22, s22, 1024
    buffer_load_dwordx4 v11, s[56:59], s20 offen lds
    s_add_u32 s20, s20, 32768
    s_waitcnt vmcnt(24)
    s_barrier
    v_add_u32 v16, 98304, v12
    v_add_u32 v17, 98304, v13
    v_add_u32 v18, 98304, v14
    v_add_u32 v19, 98304, v15
    ds_read_b64_tr_b16 a[96:97], v16 offset:0
    ds_read_b64_tr_b16 a[98:99], v17 offset:0
    ds_read_b64_tr_b16 a[100:101], v18 offset:0
    ds_read_b64_tr_b16 a[102:103], v19 offset:0
    ds_read_b64_tr_b16 a[104:105], v16 offset:4096
    ds_read_b64_tr_b16 a[106:107], v17 offset:4096
    ds_read_b64_tr_b16 a[108:109], v18 offset:4096
    ds_read_b64_tr_b16 a[110:111], v19 offset:4096
    ds_read_b64_tr_b16 a[112:113], v16 offset:8192
    ds_read_b64_tr_b16 a[114:115], v17 offset:8192
    ds_read_b64_tr_b16 a[116:117], v18 offset:8192
    ds_read_b64_tr_b16 a[118:119], v19 offset:8192
    ds_read_b64_tr_b16 a[120:121], v16 offset:12288
    ds_read_b64_tr_b16 a[122:123], v17 offset:12288
    ds_read_b64_tr_b16 a[124:125], v18 offset:12288
    ds_read_b64_tr_b16 a[126:127], v19 offset:12288
    s_waitcnt lgkmcnt(0)
    s_barrier
    s_and_b32 s20, s3, 1
    s_lshl_b32 s20, s20, 5
    s_add_u32 s20, s20, 448
    s_lshl_b32 s20, s20, 13
    s_lshl_b32 s21, s54, 8
    s_add_u32 s20, s20, s21
    s_lshl_b32 s22, s3, 13
    s_add_u32 s22, s22, 98304
    s_mov_b32 m0, s22
    s_add_u32 s22, s22, 1024
    buffer_load_dwordx4 v8, s[56:59], s20 offen lds
    s_add_u32 s20, s20, 32768
    s_mov_b32 m0, s22
    s_add_u32 s22, s22, 1024
    buffer_load_dwordx4 v9, s[56:59], s20 offen lds
    s_add_u32 s20, s20, 32768
    s_mov_b32 m0, s22
    s_add_u32 s22, s22, 1024
    buffer_load_dwordx4 v10, s[56:59], s20 offen lds
    s_add_u32 s20, s20, 32768
    s_mov_b32 m0, s22
    s_add_u32 s22, s22, 1024
    buffer_load_dwordx4 v11, s[56:59], s20 offen lds
    s_add_u32 s20, s20, 32768
    s_mov_b32 m0, s22
    s_add_u32 s22, s22, 1024
    buffer_load_dwordx4 v8, s[56:59], s20 offen lds
    s_add_u32 s20, s20, 32768
    s_mov_b32 m0, s22
    s_add_u32 s22, s22, 1024
    buffer_load_dwordx4 v9, s[56:59], s20 offen lds
    s_add_u32 s20, s20, 32768
    s_mov_b32 m0, s22
    s_add_u32 s22, s22, 1024
    buffer_load_dwordx4 v10, s[56:59], s20 offen lds
    s_add_u32 s20, s20, 32768
    s_mov_b32 m0, s22
    s_add_u32 s22, s22, 1024
    buffer_load_dwordx4 v11, s[56:59], s20 offen lds
    s_add_u32 s20, s20, 32768
    s_waitcnt vmcnt(24)
    s_barrier
    v_add_u32 v16, 0, v12
    v_add_u32 v17, 0, v13
    v_add_u32 v18, 0, v14
    v_add_u32 v19, 0, v15
    ds_read_b64_tr_b16 a[128:129], v16 offset:0
    ds_read_b64_tr_b16 a[130:131], v17 offset:0
    ds_read_b64_tr_b16 a[132:133], v18 offset:0
    ds_read_b64_tr_b16 a[134:135], v19 offset:0
    ds_read_b64_tr_b16 a[136:137], v16 offset:4096
    ds_read_b64_tr_b16 a[138:139], v17 offset:4096
    ds_read_b64_tr_b16 a[140:141], v18 offset:4096
    ds_read_b64_tr_b16 a[142:143], v19 offset:4096
    ds_read_b64_tr_b16 a[144:145], v16 offset:8192
    ds_read_b64_tr_b16 a[146:147], v17 offset:8192
    ds_read_b64_tr_b16 a[148:149], v18 offset:8192
    ds_read_b64_tr_b16 a[150:151], v19 offset:8192
    ds_read_b64_tr_b16 a[152:153], v16 offset:12288
    ds_read_b64_tr_b16 a[154:155], v17 offset:12288
    ds_read_b64_tr_b16 a[156:157], v18 offset:12288
    ds_read_b64_tr_b16 a[158:159], v19 offset:12288
    s_waitcnt lgkmcnt(0)
    s_barrier
    s_waitcnt vmcnt(16)
    s_barrier
    v_add_u32 v16, 32768, v12
    v_add_u32 v17, 32768, v13
    v_add_u32 v18, 32768, v14
    v_add_u32 v19, 32768, v15
    ds_read_b64_tr_b16 a[160:161], v16 offset:0
    ds_read_b64_tr_b16 a[162:163], v17 offset:0
    ds_read_b64_tr_b16 a[164:165], v18 offset:0
    ds_read_b64_tr_b16 a[166:167], v19 offset:0
    ds_read_b64_tr_b16 a[168:169], v16 offset:4096
    ds_read_b64_tr_b16 a[170:171], v17 offset:4096
    ds_read_b64_tr_b16 a[172:173], v18 offset:4096
    ds_read_b64_tr_b16 a[174:175], v19 offset:4096
    ds_read_b64_tr_b16 a[176:177], v16 offset:8192
    ds_read_b64_tr_b16 a[178:179], v17 offset:8192
    ds_read_b64_tr_b16 a[180:181], v18 offset:8192
    ds_read_b64_tr_b16 a[182:183], v19 offset:8192
    ds_read_b64_tr_b16 a[184:185], v16 offset:12288
    ds_read_b64_tr_b16 a[186:187], v17 offset:12288
    ds_read_b64_tr_b16 a[188:189], v18 offset:12288
    ds_read_b64_tr_b16 a[190:191], v19 offset:12288
    s_waitcnt lgkmcnt(0)
    s_barrier
    s_waitcnt vmcnt(8)
    s_barrier
    v_add_u32 v16, 65536, v12
    v_add_u32 v17, 65536, v13
    v_add_u32 v18, 65536, v14
    v_add_u32 v19, 65536, v15
    ds_read_b64_tr_b16 a[192:193], v16 offset:0
    ds_read_b64_tr_b16 a[194:195], v17 offset:0
    ds_read_b64_tr_b16 a[196:197], v18 offset:0
    ds_read_b64_tr_b16 a[198:199], v19 offset:0
    ds_read_b64_tr_b16 a[200:201], v16 offset:4096
    ds_read_b64_tr_b16 a[202:203], v17 offset:4096
    ds_read_b64_tr_b16 a[204:205], v18 offset:4096
    ds_read_b64_tr_b16 a[206:207], v19 offset:4096
    ds_read_b64_tr_b16 a[208:209], v16 offset:8192
    ds_read_b64_tr_b16 a[210:211], v17 offset:8192
    ds_read_b64_tr_b16 a[212:213], v18 offset:8192
    ds_read_b64_tr_b16 a[214:215], v19 offset:8192
    ds_read_b64_tr_b16 a[216:217], v16 offset:12288
    ds_read_b64_tr_b16 a[218:219], v17 offset:12288
    ds_read_b64_tr_b16 a[220:221], v18 offset:12288
    ds_read_b64_tr_b16 a[222:223], v19 offset:12288
    s_waitcnt lgkmcnt(0)
    s_barrier
    s_waitcnt vmcnt(0)
    s_barrier
    v_add_u32 v16, 98304, v12
    v_add_u32 v17, 98304, v13
    v_add_u32 v18, 98304, v14
    v_add_u32 v19, 98304, v15
    ds_read_b64_tr_b16 a[224:225], v16 offset:0
    ds_read_b64_tr_b16 a[226:227], v17 offset:0
    ds_read_b64_tr_b16 a[228:229], v18 offset:0
    ds_read_b64_tr_b16 a[230:231], v19 offset:0
    ds_read_b64_tr_b16 a[232:233], v16 offset:4096
    ds_read_b64_tr_b16 a[234:235], v17 offset:4096
    ds_read_b64_tr_b16 a[236:237], v18 offset:4096
    ds_read_b64_tr_b16 a[238:239], v19 offset:4096
    ds_read_b64_tr_b16 a[240:241], v16 offset:8192
    ds_read_b64_tr_b16 a[242:243], v17 offset:8192
    ds_read_b64_tr_b16 a[244:245], v18 offset:8192
    ds_read_b64_tr_b16 a[246:247], v19 offset:8192
    ds_read_b64_tr_b16 a[248:249], v16 offset:12288
    ds_read_b64_tr_b16 a[250:251], v17 offset:12288
    ds_read_b64_tr_b16 a[252:253], v18 offset:12288
    ds_read_b64_tr_b16 a[254:255], v19 offset:12288
    s_waitcnt lgkmcnt(0)
    s_barrier
    s_load_dwordx2 s[96:97], s[0:1], 96
    v_mov_b32 v120, 192
    s_mov_b32 s94, 0
    s_waitcnt lgkmcnt(0)
L_WDQ:
    global_load_dword v121, v120, s[96:97] sc1
    s_waitcnt vmcnt(0)
    v_readfirstlane_b32 s95, v121
    s_add_u32 s94, s94, 1
    s_cmp_gt_u32 s94, 2000000
    s_cbranch_scc1 L_GBAIL
    s_cmp_ge_u32 s95, 256
    s_cbranch_scc1 L_WDOKQ
    s_sleep 4
    s_branch L_WDQ
L_WDOKQ:
    s_load_dwordx2 s[96:97], s[0:1], 96
    v_mov_b32 v120, 196
    s_mov_b32 s94, 0
    s_waitcnt lgkmcnt(0)
L_WDQL:
    global_load_dword v121, v120, s[96:97] sc1
    s_waitcnt vmcnt(0)
    v_readfirstlane_b32 s95, v121
    s_add_u32 s94, s94, 1
    s_cmp_gt_u32 s94, 2000000
    s_cbranch_scc1 L_GBAIL
    s_cmp_ge_u32 s95, 32
    s_cbranch_scc1 L_WDOKQL
    s_sleep 4
    s_branch L_WDQL
L_WDOKQL:
    s_cmp_lt_u32 s12, 32
    s_cselect_b32 s20, 0x0, 0x2000000
    s_cmp_eq_u32 s16, 1
    s_cselect_b32 s20, 0x1000000, s20
    s_mov_b32 s14, s13
    s_lshl_b32 s21, s14, 18
    s_add_u32 s20, s20, s21
    s_lshl_b32 s21, s54, 13
    s_add_u32 s15, s20, s21
    v_and_b32 v6, 15, v0
    v_lshlrev_b32 v6, 4, v6
    v_lshrrev_b32 v7, 5, v0
    v_lshl_add_u32 v6, v7, 8, v6
    v_bfe_u32 v7, v0, 4, 1
    s_cmp_eq_u32 s16, 1
    s_cselect_b32 s20, 10, 12
    s_cselect_b32 s21, 12, 11
    v_lshlrev_b32 v7, s20, v7
    v_add_u32 v6, v6, v7
    s_and_b32 s22, s3, 1
    s_lshl_b32 s22, s22, s21
    v_add_u32 v2, s22, v6
    s_mov_b32 s24, 1024
    s_lshl_b32 s24, s24, s16
    s_lshl_b32 s25, s14, 15
    s_lshl_b32 s20, s3, 13
    s_add_u32 s25, s25, s20
    s_add_u32 s25, s25, 0x3000000
    s_lshl_b32 s26, s3, 13
    s_mov_b32 s27, 0
    s_lshl_b32 s23, s12, 2
    s_add_u32 s23, s23, s13
    s_lshl_b32 s23, s23, 7
    s_add_u32 s23, s23, 0x4420000
    v_or_b32 v6, s3, v0
    v_mov_b32 v7, 0x40000000
    v_cmp_eq_u32 vcc, 0, v6
    s_nop 1
    v_cndmask_b32 v5, v7, 0, vcc
    s_mov_b32 s29, 0
    s_mov_b32 s17, 0
    s_add_u32 s22, s26, s27
    s_mov_b32 m0, s22
    s_add_u32 s22, s22, 1024
    buffer_load_dwordx4 v1, s[4:7], s25 offen lds
    s_add_u32 s25, s25, 1024
    s_mov_b32 m0, s22
    s_add_u32 s22, s22, 1024
    buffer_load_dwordx4 v1, s[4:7], s25 offen lds
    s_add_u32 s25, s25, 1024
    s_mov_b32 m0, s22
    s_add_u32 s22, s22, 1024
    buffer_load_dwordx4 v1, s[4:7], s25 offen lds
    s_add_u32 s25, s25, 1024
    s_mov_b32 m0, s22
    s_add_u32 s22, s22, 1024
    buffer_load_dwordx4 v1, s[4:7], s25 offen lds
    s_add_u32 s25, s25, 1024
    s_mov_b32 m0, s22
    s_add_u32 s22, s22, 1024
    buffer_load_dwordx4 v1, s[4:7], s25 offen lds
    s_add_u32 s25, s25, 1024
    s_mov_b32 m0, s22
    s_add_u32 s22, s22, 1024
    buffer_load_dwordx4 v1, s[4:7], s25 offen lds
    s_add_u32 s25, s25, 1024
    s_mov_b32 m0, s22
    s_add_u32 s22, s22, 1024
    buffer_load_dwordx4 v1, s[4:7], s25 offen lds
    s_add_u32 s25, s25, 1024
    s_mov_b32 m0, s22
    s_add_u32 s22, s22, 1024
    buffer_load_dwordx4 v1, s[4:7], s25 offen lds
    s_add_u32 s25, s25, 1024
    s_add_u32 s25, s25, 122880
    s_add_u32 s27, s27, 32768
    s_cmp_eq_u32 s27, 98304
    s_cselect_b32 s27, 0, s27
    s_add_u32 s22, s26, s27
    s_mov_b32 m0, s22
    s_add_u32 s22, s22, 1024
    buffer_load_dwordx4 v1, s[4:7], s25 offen lds
    s_add_u32 s25, s25, 1024
    s_mov_b32 m0, s22
    s_add_u32 s22, s22, 1024
    buffer_load_dwordx4 v1, s[4:7], s25 offen lds
    s_add_u32 s25, s25, 1024
    s_mov_b32 m0, s22
    s_add_u32 s22, s22, 1024
    buffer_load_dwordx4 v1, s[4:7], s25 offen lds
    s_add_u32 s25, s25, 1024
    s_mov_b32 m0, s22
    s_add_u32 s22, s22, 1024
    buffer_load_dwordx4 v1, s[4:7], s25 offen lds
    s_add_u32 s25, s25, 1024
    s_mov_b32 m0, s22
    s_add_u32 s22, s22, 1024
    buffer_load_dwordx4 v1, s[4:7], s25 offen lds
    s_add_u32 s25, s25, 1024
    s_mov_b32 m0, s22
    s_add_u32 s22, s22, 1024
    buffer_load_dwordx4 v1, s[4:7], s25 offen lds
    s_add_u32 s25, s25, 1024
    s_mov_b32 m0, s22
    s_add_u32 s22, s22, 1024
    buffer_load_dwordx4 v1, s[4:7], s25 offen lds
    s_add_u32 s25, s25, 1024
    s_mov_b32 m0, s22
    s_add_u32 s22, s22, 1024
    buffer_load_dwordx4 v1, s[4:7], s25 offen lds
    s_add_u32 s25, s25, 1024
    s_add_u32 s25, s25, 122880
    s_add_u32 s27, s27, 32768
    s_cmp_eq_u32 s27, 98304
    s_cselect_b32 s27, 0, s27
    s_cmp_eq_u32 s16, 1
    s_cbranch_scc1 L_QKV_V
    s_waitcnt vmcnt(8)
    s_barrier
    s_sub_i32 s20, s17, 1
    s_max_i32 s20, s20, 0
    v_mov_b32 v6, s20
    buffer_store_dword v6, v5, s[4:7], s23 offen sc1
    s_add_u32 s22, s26, s27
    s_mov_b32 m0, s22
    s_add_u32 s22, s22, 1024
    buffer_load_dwordx4 v1, s[4:7], s25 offen lds
    s_add_u32 s25, s25, 1024
    s_mov_b32 m0, s22
    s_add_u32 s22, s22, 1024
    buffer_load_dwordx4 v1, s[4:7], s25 offen lds
    s_add_u32 s25, s25, 1024
    s_mov_b32 m0, s22
    s_add_u32 s22, s22, 1024
    buffer_load_dwordx4 v1, s[4:7], s25 offen lds
    s_add_u32 s25, s25, 1024
    s_mov_b32 m0, s22
    s_add_u32 s22, s22, 1024
    buffer_load_dwordx4 v1, s[4:7], s25 offen lds
    s_add_u32 s25, s25, 1024
    s_mov_b32 m0, s22
    s_add_u32 s22, s22, 1024
    buffer_load_dwordx4 v1, s[4:7], s25 offen lds
    s_add_u32 s25, s25, 1024
    s_mov_b32 m0, s22
    s_add_u32 s22, s22, 1024
    buffer_load_dwordx4 v1, s[4:7], s25 offen lds
    s_add_u32 s25, s25, 1024
    s_mov_b32 m0, s22
    s_add_u32 s22, s22, 1024
    buffer_load_dwordx4 v1, s[4:7], s25 offen lds
    s_add_u32 s25, s25, 1024
    s_mov_b32 m0, s22
    s_add_u32 s22, s22, 1024
    buffer_load_dwordx4 v1, s[4:7], s25 offen lds
    s_add_u32 s25, s25, 1024
    s_add_u32 s25, s25, 122880
    s_add_u32 s27, s27, 32768
    s_cmp_eq_u32 s27, 98304
    s_cselect_b32 s27, 0, s27
    v_add_u32 v3, s29, v1
    s_add_u32 s29, s29, 32768
    s_cmp_eq_u32 s29, 98304
    s_cselect_b32 s29, 0, s29
    ds_read_b128 v[96:99], v3 offset:0
    ds_read_b128 v[100:103], v3 offset:1024
    ds_read_b128 v[104:107], v3 offset:2048
    ds_read_b128 v[108:111], v3 offset:3072
    s_waitcnt lgkmcnt(3)
    v_mfma_f32_32x32x16_bf16 v[32:47], a[0:3], v[96:99], 0
    v_mfma_f32_32x32x16_bf16 v[48:63], a[4:7], v[96:99], 0
    ds_read_b128 v[96:99], v3 offset:4096
    s_waitcnt lgkmcnt(3)
    v_mfma_f32_32x32x16_bf16 v[32:47], a[8:11], v[100:103], v[32:47]
    v_mfma_f32_32x32x16_bf16 v[48:63], a[12:15], v[100:103], v[48:63]
    ds_read_b128 v[100:103], v3 offset:5120
    s_waitcnt lgkmcnt(3)
    v_mfma_f32_32x32x16_bf16 v[32:47], a[16:19], v[104:107], v[32:47]
    v_mfma_f32_32x32x16_bf16 v[48:63], a[20:23], v[104:107], v[48:63]
    ds_read_b128 v[104:107], v3 offset:6144
    s_waitcnt lgkmcnt(3)
    v_mfma_f32_32x32x16_bf16 v[32:47], a[24:27], v[108:111], v[32:47]
    v_mfma_f32_32x32x16_bf16 v[48:63], a[28:31], v[108:111], v[48:63]
    ds_read_b128 v[108:111], v3 offset:7168
    s_waitcnt lgkmcnt(3)
    v_mfma_f32_32x32x16_bf16 v[32:47], a[32:35], v[96:99], v[32:47]
    v_mfma_f32_32x32x16_bf16 v[48:63], a[36:39], v[96:99], v[48:63]
    ds_read_b128 v[96:99], v3 offset:8192
    s_waitcnt lgkmcnt(3)
    v_mfma_f32_32x32x16_bf16 v[32:47], a[40:43], v[100:103], v[32:47]
    v_mfma_f32_32x32x16_bf16 v[48:63], a[44:47], v[100:103], v[48:63]
    ds_read_b128 v[100:103], v3 offset:9216
    s_waitcnt lgkmcnt(3)
    v_mfma_f32_32x32x16_bf16 v[32:47], a[48:51], v[104:107], v[32:47]
    v_mfma_f32_32x32x16_bf16 v[48:63], a[52:55], v[104:107], v[48:63]
    ds_read_b128 v[104:107], v3 offset:10240
    s_waitcnt lgkmcnt(3)
    v_mfma_f32_32x32x16_bf16 v[32:47], a[56:59], v[108:111], v[32:47]
    v_mfma_f32_32x32x16_bf16 v[48:63], a[60:63], v[108:111], v[48:63]
    ds_read_b128 v[108:111], v3 offset:11264
    s_waitcnt lgkmcnt(3)
    v_mfma_f32_32x32x16_bf16 v[32:47], a[64:67], v[96:99], v[32:47]
    v_mfma_f32_32x32x16_bf16 v[48:63], a[68:71], v[96:99], v[48:63]
    ds_read_b128 v[96:99], v3 offset:12288
    s_waitcnt lgkmcnt(3)
    v_mfma_f32_32x32x16_bf16 v[32:47], a[72:75], v[100:103], v[32:47]
    v_mfma_f32_32x32x16_bf16 v[48:63], a[76:79], v[100:103], v[48:63]
    ds_read_b128 v[100:103], v3 offset:13312
    s_waitcnt lgkmcnt(3)
    v_mfma_f32_32x32x16_bf16 v[32:47], a[80:83], v[104:107], v[32:47]
    v_mfma_f32_32x32x16_bf16 v[48:63], a[84:87], v[104:107], v[48:63]
    ds_read_b128 v[104:107], v3 offset:14336
    s_waitcnt lgkmcnt(3)
    v_mfma_f32_32x32x16_bf16 v[32:47], a[88:91], v[108:111], v[32:47]
    v_mfma_f32_32x32x16_bf16 v[48:63], a[92:95], v[108:111], v[48:63]
    ds_read_b128 v[108:111], v3 offset:15360
    s_waitcnt lgkmcnt(3)
    v_mfma_f32_32x32x16_bf16 v[32:47], a[96:99], v[96:99], v[32:47]
    v_mfma_f32_32x32x16_bf16 v[48:63], a[100:103], v[96:99], v[48:63]
    ds_read_b128 v[96:99], v3 offset:16384
    s_waitcnt lgkmcnt(3)
    v_mfma_f32_32x32x16_bf16 v[32:47], a[104:107], v[100:103], v[32:47]
    v_mfma_f32_32x32x16_bf16 v[48:63], a[108:111], v[100:103], v[48:63]
    ds_read_b128 v[100:103], v3 offset:17408
    s_waitcnt lgkmcnt(3)
    v_mfma_f32_32x32x16_bf16 v[32:47], a[112:115], v[104:107], v[32:47]
    v_mfma_f32_32x32x16_bf16 v[48:63], a[116:119], v[104:107], v[48:63]
    ds_read_b128 v[104:107], v3 offset:18432
    s_waitcnt lgkmcnt(3)
    v_mfma_f32_32x32x16_bf16 v[32:47], a[120:123], v[108:111], v[32:47]
    v_mfma_f32_32x32x16_bf16 v[48:63], a[124:127], v[108:111], v[48:63]
    ds_read_b128 v[108:111], v3 offset:19456
    s_waitcnt lgkmcnt(3)
    v_mfma_f32_32x32x16_bf16 v[32:47], a[128:131], v[96:99], v[32:47]
    v_mfma_f32_32x32x16_bf16 v[48:63], a[132:135], v[96:99], v[48:63]
    ds_read_b128 v[96:99], v3 offset:20480
    s_waitcnt lgkmcnt(3)
    v_mfma_f32_32x32x16_bf16 v[32:47], a[136:139], v[100:103], v[32:47]
    v_mfma_f32_32x32x16_bf16 v[48:63], a[140:143], v[100:103], v[48:63]
    ds_read_b128 v[100:103], v3 offset:21504
    s_waitcnt lgkmcnt(3)
    v_mfma_f32_32x32x16_bf16 v[32:47], a[144:147], v[104:107], v[32:47]
    v_mfma_f32_32x32x16_bf16 v[48:63], a[148:151], v[104:107], v[48:63]
    ds_read_b128 v[104:107], v3 offset:22528
    s_waitcnt lgkmcnt(3)
    v_mfma_f32_32x32x16_bf16 v[32:47], a[152:155], v[108:111], v[32:47]
    v_mfma_f32_32x32x16_bf16 v[48:63], a[156:159], v[108:111], v[48:63]
    ds_read_b128 v[108:111], v3 offset:23552
    s_waitcnt lgkmcnt(3)
    v_mfma_f32_32x32x16_bf16 v[32:47], a[160:163], v[96:99], v[32:47]
    v_mfma_f32_32x32x16_bf16 v[48:63], a[164:167], v[96:99], v[48:63]
    ds_read_b128 v[96:99], v3 offset:24576
    s_waitcnt lgkmcnt(3)
    v_mfma_f32_32x32x16_bf16 v[32:47], a[168:171], v[100:103], v[32:47]
    v_mfma_f32_32x32x16_bf16 v[48:63], a[172:175], v[100:103], v[48:63]
    ds_read_b128 v[100:103], v3 offset:25600
    s_waitcnt lgkmcnt(3)
    v_mfma_f32_32x32x16_bf16 v[32:47], a[176:179], v[104:107], v[32:47]
    v_mfma_f32_32x32x16_bf16 v[48:63], a[180:183], v[104:107], v[48:63]
    ds_read_b128 v[104:107], v3 offset:26624
    s_waitcnt lgkmcnt(3)
    v_mfma_f32_32x32x16_bf16 v[32:47], a[184:187], v[108:111], v[32:47]
    v_mfma_f32_32x32x16_bf16 v[48:63], a[188:191], v[108:111], v[48:63]
    ds_read_b128 v[108:111], v3 offset:27648
    s_waitcnt lgkmcnt(3)
    v_mfma_f32_32x32x16_bf16 v[32:47], a[192:195], v[96:99], v[32:47]
    v_mfma_f32_32x32x16_bf16 v[48:63], a[196:199], v[96:99], v[48:63]
    ds_read_b128 v[96:99], v3 offset:28672
    s_waitcnt lgkmcnt(3)
    v_mfma_f32_32x32x16_bf16 v[32:47], a[200:203], v[100:103], v[32:47]
    v_mfma_f32_32x32x16_bf16 v[48:63], a[204:207], v[100:103], v[48:63]
    ds_read_b128 v[100:103], v3 offset:29696
    s_waitcnt lgkmcnt(3)
    v_mfma_f32_32x32x16_bf16 v[32:47], a[208:211], v[104:107], v[32:47]
    v_mfma_f32_32x32x16_bf16 v[48:63], a[212:215], v[104:107], v[48:63]
    ds_read_b128 v[104:107], v3 offset:30720
    s_waitcnt lgkmcnt(3)
    v_mfma_f32_32x32x16_bf16 v[32:47], a[216:219], v[108:111], v[32:47]
    v_mfma_f32_32x32x16_bf16 v[48:63], a[220:223], v[108:111], v[48:63]
    ds_read_b128 v[108:111], v3 offset:31744
    s_waitcnt lgkmcnt(3)
    v_mfma_f32_32x32x16_bf16 v[32:47], a[224:227], v[96:99], v[32:47]
    v_mfma_f32_32x32x16_bf16 v[48:63], a[228:231], v[96:99], v[48:63]
    s_waitcnt lgkmcnt(2)
    v_mfma_f32_32x32x16_bf16 v[32:47], a[232:235], v[100:103], v[32:47]
    v_mfma_f32_32x32x16_bf16 v[48:63], a[236:239], v[100:103], v[48:63]
    s_waitcnt lgkmcnt(1)
    v_mfma_f32_32x32x16_bf16 v[32:47], a[240:243], v[104:107], v[32:47]
    v_mfma_f32_32x32x16_bf16 v[48:63], a[244:247], v[104:107], v[48:63]
    s_waitcnt lgkmcnt(0)
    v_mfma_f32_32x32x16_bf16 v[32:47], a[248:251], v[108:111], v[32:47]
    v_mfma_f32_32x32x16_bf16 v[48:63], a[252:255], v[108:111], v[48:63]
    s_add_u32 s17, s17, 1
    s_waitcnt vmcnt(8)
    s_barrier
    s_sub_i32 s20, s17, 1
    s_max_i32 s20, s20, 0
    v_mov_b32 v6, s20
    buffer_store_dword v6, v5, s[4:7], s23 offen sc1
    s_add_u32 s22, s26, s27
    s_mov_b32 m0, s22
    s_add_u32 s22, s22, 1024
    buffer_load_dwordx4 v1, s[4:7], s25 offen lds
    s_add_u32 s25, s25, 1024
    s_mov_b32 m0, s22
    s_add_u32 s22, s22, 1024
    buffer_load_dwordx4 v1, s[4:7], s25 offen lds
    s_add_u32 s25, s25, 1024
    s_mov_b32 m0, s22
    s_add_u32 s22, s22, 1024
    buffer_load_dwordx4 v1, s[4:7], s25 offen lds
    s_add_u32 s25, s25, 1024
    s_mov_b32 m0, s22
    s_add_u32 s22, s22, 1024
    buffer_load_dwordx4 v1, s[4:7], s25 offen lds
    s_add_u32 s25, s25, 1024
    s_mov_b32 m0, s22
    s_add_u32 s22, s22, 1024
    buffer_load_dwordx4 v1, s[4:7], s25 offen lds
    s_add_u32 s25, s25, 1024
    s_mov_b32 m0, s22
    s_add_u32 s22, s22, 1024
    buffer_load_dwordx4 v1, s[4:7], s25 offen lds
    s_add_u32 s25, s25, 1024
    s_mov_b32 m0, s22
    s_add_u32 s22, s22, 1024
    buffer_load_dwordx4 v1, s[4:7], s25 offen lds
    s_add_u32 s25, s25, 1024
    s_mov_b32 m0, s22
    s_add_u32 s22, s22, 1024
    buffer_load_dwordx4 v1, s[4:7], s25 offen lds
    s_add_u32 s25, s25, 1024
    s_add_u32 s25, s25, 122880
    s_add_u32 s27, s27, 32768
    s_cmp_eq_u32 s27, 98304
    s_cselect_b32 s27, 0, s27
    v_add_u32 v3, s29, v1
    s_add_u32 s29, s29, 32768
    s_cmp_eq_u32 s29, 98304
    s_cselect_b32 s29, 0, s29
    s_add_u32 s28, s15, s24
    ds_read_b128 v[96:99], v3 offset:0
    ds_read_b128 v[100:103], v3 offset:1024
    ds_read_b128 v[104:107], v3 offset:2048
    ds_read_b128 v[108:111], v3 offset:3072
    s_waitcnt lgkmcnt(3)
    v_mfma_f32_32x32x16_bf16 v[64:79], a[0:3], v[96:99], 0
    v_mfma_f32_32x32x16_bf16 v[80:95], a[4:7], v[96:99], 0
    ds_read_b128 v[96:99], v3 offset:4096
    s_waitcnt lgkmcnt(3)
    v_mfma_f32_32x32x16_bf16 v[64:79], a[8:11], v[100:103], v[64:79]
    v_cvt_pk_bf16_f32 v112, v32, v33
    v_cvt_pk_bf16_f32 v113, v34, v35
    v_mfma_f32_32x32x16_bf16 v[80:95], a[12:15], v[100:103], v[80:95]
    v_cvt_pk_bf16_f32 v114, v40, v41
    v_cvt_pk_bf16_f32 v115, v42, v43
    ds_read_b128 v[100:103], v3 offset:5120
    s_waitcnt lgkmcnt(3)
    v_mfma_f32_32x32x16_bf16 v[64:79], a[16:19], v[104:107], v[64:79]
    buffer_store_dwordx4 v[112:115], v2, s[4:7], s15 offen offset:0 sc1
    v_cvt_pk_bf16_f32 v116, v36, v37
    v_mfma_f32_32x32x16_bf16 v[80:95], a[20:23], v[104:107], v[80:95]
    v_cvt_pk_bf16_f32 v117, v38, v39
    v_cvt_pk_bf16_f32 v118, v44, v45
    ds_read_b128 v[104:107], v3 offset:6144
    s_waitcnt lgkmcnt(3)
    v_mfma_f32_32x32x16_bf16 v[64:79], a[24:27], v[108:111], v[64:79]
    v_cvt_pk_bf16_f32 v119, v46, v47
    buffer_store_dwordx4 v[116:119], v2, s[4:7], s15 offen offset:512 sc1
    v_mfma_f32_32x32x16_bf16 v[80:95], a[28:31], v[108:111], v[80:95]
    v_cvt_pk_bf16_f32 v120, v48, v49
    v_cvt_pk_bf16_f32 v121, v50, v51
    ds_read_b128 v[108:111], v3 offset:7168
    s_waitcnt lgkmcnt(3)
    v_mfma_f32_32x32x16_bf16 v[64:79], a[32:35], v[96:99], v[64:79]
    v_cvt_pk_bf16_f32 v122, v56, v57
    v_cvt_pk_bf16_f32 v123, v58, v59
    v_mfma_f32_32x32x16_bf16 v[80:95], a[36:39], v[96:99], v[80:95]
    buffer_store_dwordx4 v[120:123], v2, s[4:7], s28 offen offset:0 sc1
    v_cvt_pk_bf16_f32 v124, v52, v53
    ds_read_b128 v[96:99], v3 offset:8192
    s_waitcnt lgkmcnt(3)
    v_mfma_f32_32x32x16_bf16 v[64:79], a[40:43], v[100:103], v[64:79]
    v_cvt_pk_bf16_f32 v125, v54, v55
    v_cvt_pk_bf16_f32 v126, v60, v61
    v_mfma_f32_32x32x16_bf16 v[80:95], a[44:47], v[100:103], v[80:95]
    v_cvt_pk_bf16_f32 v127, v62, v63
    buffer_store_dwordx4 v[124:127], v2, s[4:7], s28 offen offset:512 sc1
    ds_read_b128 v[100:103], v3 offset:9216
    s_waitcnt lgkmcnt(3)
    v_mfma_f32_32x32x16_bf16 v[64:79], a[48:51], v[104:107], v[64:79]
    v_mfma_f32_32x32x16_bf16 v[80:95], a[52:55], v[104:107], v[80:95]
    ds_read_b128 v[104:107], v3 offset:10240
    s_waitcnt lgkmcnt(3)
    v_mfma_f32_32x32x16_bf16 v[64:79], a[56:59], v[108:111], v[64:79]
    v_mfma_f32_32x32x16_bf16 v[80:95], a[60:63], v[108:111], v[80:95]
    ds_read_b128 v[108:111], v3 offset:11264
    s_waitcnt lgkmcnt(3)
    v_mfma_f32_32x32x16_bf16 v[64:79], a[64:67], v[96:99], v[64:79]
    v_mfma_f32_32x32x16_bf16 v[80:95], a[68:71], v[96:99], v[80:95]
    ds_read_b128 v[96:99], v3 offset:12288
    s_waitcnt lgkmcnt(3)
    v_mfma_f32_32x32x16_bf16 v[64:79], a[72:75], v[100:103], v[64:79]
    v_mfma_f32_32x32x16_bf16 v[80:95], a[76:79], v[100:103], v[80:95]
    ds_read_b128 v[100:103], v3 offset:13312
    s_waitcnt lgkmcnt(3)
    v_mfma_f32_32x32x16_bf16 v[64:79], a[80:83], v[104:107], v[64:79]
    v_mfma_f32_32x32x16_bf16 v[80:95], a[84:87], v[104:107], v[80:95]
    ds_read_b128 v[104:107], v3 offset:14336
    s_waitcnt lgkmcnt(3)
    v_mfma_f32_32x32x16_bf16 v[64:79], a[88:91], v[108:111], v[64:79]
    v_mfma_f32_32x32x16_bf16 v[80:95], a[92:95], v[108:111], v[80:95]
    ds_read_b128 v[108:111], v3 offset:15360
    s_waitcnt lgkmcnt(3)
    v_mfma_f32_32x32x16_bf16 v[64:79], a[96:99], v[96:99], v[64:79]
    v_mfma_f32_32x32x16_bf16 v[80:95], a[100:103], v[96:99], v[80:95]
    ds_read_b128 v[96:99], v3 offset:16384
    s_waitcnt lgkmcnt(3)
    v_mfma_f32_32x32x16_bf16 v[64:79], a[104:107], v[100:103], v[64:79]
    v_mfma_f32_32x32x16_bf16 v[80:95], a[108:111], v[100:103], v[80:95]
    ds_read_b128 v[100:103], v3 offset:17408
    s_waitcnt lgkmcnt(3)
    v_mfma_f32_32x32x16_bf16 v[64:79], a[112:115], v[104:107], v[64:79]
    v_mfma_f32_32x32x16_bf16 v[80:95], a[116:119], v[104:107], v[80:95]
    ds_read_b128 v[104:107], v3 offset:18432
    s_waitcnt lgkmcnt(3)
    v_mfma_f32_32x32x16_bf16 v[64:79], a[120:123], v[108:111], v[64:79]
    v_mfma_f32_32x32x16_bf16 v[80:95], a[124:127], v[108:111], v[80:95]
    ds_read_b128 v[108:111], v3 offset:19456
    s_waitcnt lgkmcnt(3)
    v_mfma_f32_32x32x16_bf16 v[64:79], a[128:131], v[96:99], v[64:79]
    v_mfma_f32_32x32x16_bf16 v[80:95], a[132:135], v[96:99], v[80:95]
    ds_read_b128 v[96:99], v3 offset:20480
    s_waitcnt lgkmcnt(3)
    v_mfma_f32_32x32x16_bf16 v[64:79], a[136:139], v[100:103], v[64:79]
    v_mfma_f32_32x32x16_bf16 v[80:95], a[140:143], v[100:103], v[80:95]
    ds_read_b128 v[100:103], v3 offset:21504
    s_waitcnt lgkmcnt(3)
    v_mfma_f32_32x32x16_bf16 v[64:79], a[144:147], v[104:107], v[64:79]
    v_mfma_f32_32x32x16_bf16 v[80:95], a[148:151], v[104:107], v[80:95]
    ds_read_b128 v[104:107], v3 offset:22528
    s_waitcnt lgkmcnt(3)
    v_mfma_f32_32x32x16_bf16 v[64:79], a[152:155], v[108:111], v[64:79]
    v_mfma_f32_32x32x16_bf16 v[80:95], a[156:159], v[108:111], v[80:95]
    ds_read_b128 v[108:111], v3 offset:23552
    s_waitcnt lgkmcnt(3)
    v_mfma_f32_32x32x16_bf16 v[64:79], a[160:163], v[96:99], v[64:79]
    v_mfma_f32_32x32x16_bf16 v[80:95], a[164:167], v[96:99], v[80:95]
    ds_read_b128 v[96:99], v3 offset:24576
    s_waitcnt lgkmcnt(3)
    v_mfma_f32_32x32x16_bf16 v[64:79], a[168:171], v[100:103], v[64:79]
    v_mfma_f32_32x32x16_bf16 v[80:95], a[172:175], v[100:103], v[80:95]
    ds_read_b128 v[100:103], v3 offset:25600
    s_waitcnt lgkmcnt(3)
    v_mfma_f32_32x32x16_bf16 v[64:79], a[176:179], v[104:107], v[64:79]
    v_mfma_f32_32x32x16_bf16 v[80:95], a[180:183], v[104:107], v[80:95]
    ds_read_b128 v[104:107], v3 offset:26624
    s_waitcnt lgkmcnt(3)
    v_mfma_f32_32x32x16_bf16 v[64:79], a[184:187], v[108:111], v[64:79]
    v_mfma_f32_32x32x16_bf16 v[80:95], a[188:191], v[108:111], v[80:95]
    ds_read_b128 v[108:111], v3 offset:27648
    s_waitcnt lgkmcnt(3)
    v_mfma_f32_32x32x16_bf16 v[64:79], a[192:195], v[96:99], v[64:79]
    v_mfma_f32_32x32x16_bf16 v[80:95], a[196:199], v[96:99], v[80:95]
    ds_read_b128 v[96:99], v3 offset:28672
    s_waitcnt lgkmcnt(3)
    v_mfma_f32_32x32x16_bf16 v[64:79], a[200:203], v[100:103], v[64:79]
    v_mfma_f32_32x32x16_bf16 v[80:95], a[204:207], v[100:103], v[80:95]
    ds_read_b128 v[100:103], v3 offset:29696
    s_waitcnt lgkmcnt(3)
    v_mfma_f32_32x32x16_bf16 v[64:79], a[208:211], v[104:107], v[64:79]
    v_mfma_f32_32x32x16_bf16 v[80:95], a[212:215], v[104:107], v[80:95]
    ds_read_b128 v[104:107], v3 offset:30720
    s_waitcnt lgkmcnt(3)
    v_mfma_f32_32x32x16_bf16 v[64:79], a[216:219], v[108:111], v[64:79]
    v_mfma_f32_32x32x16_bf16 v[80:95], a[220:223], v[108:111], v[80:95]
    ds_read_b128 v[108:111], v3 offset:31744
    s_waitcnt lgkmcnt(3)
    v_mfma_f32_32x32x16_bf16 v[64:79], a[224:227], v[96:99], v[64:79]
    v_mfma_f32_32x32x16_bf16 v[80:95], a[228:231], v[96:99], v[80:95]
    s_waitcnt lgkmcnt(2)
    v_mfma_f32_32x32x16_bf16 v[64:79], a[232:235], v[100:103], v[64:79]
    v_mfma_f32_32x32x16_bf16 v[80:95], a[236:239], v[100:103], v[80:95]
    s_waitcnt lgkmcnt(1)
    v_mfma_f32_32x32x16_bf16 v[64:79], a[240:243], v[104:107], v[64:79]
    v_mfma_f32_32x32x16_bf16 v[80:95], a[244:247], v[104:107], v[80:95]
    s_waitcnt lgkmcnt(0)
    v_mfma_f32_32x32x16_bf16 v[64:79], a[248:251], v[108:111], v[64:79]
    v_mfma_f32_32x32x16_bf16 v[80:95], a[252:255], v[108:111], v[80:95]
    s_add_u32 s15, s15, 1048576
    s_add_u32 s17, s17, 1
    s_waitcnt vmcnt(0)
    s_barrier
    s_cmp_eq_u32 s17, 6
    s_cbranch_scc0 L_QKV_NOBK1
    s_load_dwordx2 s[96:97], s[0:1], 96
    v_mov_b32 v6, 200
    s_mov_b32 s94, 0
    s_waitcnt lgkmcnt(0)
L_WDQLBK1:
    global_load_dword v7, v6, s[96:97] sc1
    s_waitcnt vmcnt(0)
    v_readfirstlane_b32 s95, v7
    s_add_u32 s94, s94, 1
    s_cmp_gt_u32 s94, 2000000
    s_cbranch_scc1 L_GBAIL
    s_cmp_ge_u32 s95, 32
    s_cbranch_scc1 L_WDOKQLBK1
    s_sleep 4
    s_branch L_WDQLBK1
L_WDOKQLBK1:
L_QKV_NOBK1:
    s_sub_i32 s20, s17, 1
    s_max_i32 s20, s20, 0
    v_mov_b32 v6, s20
    buffer_store_dword v6, v5, s[4:7], s23 offen sc1
    s_add_u32 s22, s26, s27
    s_mov_b32 m0, s22
    s_add_u32 s22, s22, 1024
    buffer_load_dwordx4 v1, s[4:7], s25 offen lds
    s_add_u32 s25, s25, 1024
    s_mov_b32 m0, s22
    s_add_u32 s22, s22, 1024
    buffer_load_dwordx4 v1, s[4:7], s25 offen lds
    s_add_u32 s25, s25, 1024
    s_mov_b32 m0, s22
    s_add_u32 s22, s22, 1024
    buffer_load_dwordx4 v1, s[4:7], s25 offen lds
    s_add_u32 s25, s25, 1024
    s_mov_b32 m0, s22
    s_add_u32 s22, s22, 1024
    buffer_load_dwordx4 v1, s[4:7], s25 offen lds
    s_add_u32 s25, s25, 1024
    s_mov_b32 m0, s22
    s_add_u32 s22, s22, 1024
    buffer_load_dwordx4 v1, s[4:7], s25 offen lds
    s_add_u32 s25, s25, 1024
    s_mov_b32 m0, s22
    s_add_u32 s22, s22, 1024
    buffer_load_dwordx4 v1, s[4:7], s25 offen lds
    s_add_u32 s25, s25, 1024
    s_mov_b32 m0, s22
    s_add_u32 s22, s22, 1024
    buffer_load_dwordx4 v1, s[4:7], s25 offen lds
    s_add_u32 s25, s25, 1024
    s_mov_b32 m0, s22
    s_add_u32 s22, s22, 1024
    buffer_load_dwordx4 v1, s[4:7], s25 offen lds
    s_add_u32 s25, s25, 1024
    s_add_u32 s25, s25, 122880
    s_add_u32 s27, s27, 32768
    s_cmp_eq_u32 s27, 98304
    s_cselect_b32 s27, 0, s27
    v_add_u32 v3, s29, v1
    s_add_u32 s29, s29, 32768
    s_cmp_eq_u32 s29, 98304
    s_cselect_b32 s29, 0, s29
    s_add_u32 s28, s15, s24
    ds_read_b128 v[96:99], v3 offset:0
    ds_read_b128 v[100:103], v3 offset:1024
    ds_read_b128 v[104:107], v3 offset:2048
    ds_read_b128 v[108:111], v3 offset:3072
    s_waitcnt lgkmcnt(3)
    v_mfma_f32_32x32x16_bf16 v[32:47], a[0:3], v[96:99], 0
    v_mfma_f32_32x32x16_bf16 v[48:63], a[4:7], v[96:99], 0
    ds_read_b128 v[96:99], v3 offset:4096
    s_waitcnt lgkmcnt(3)
    v_mfma_f32_32x32x16_bf16 v[32:47], a[8:11], v[100:103], v[32:47]
    v_cvt_pk_bf16_f32 v112, v64, v65
    v_cvt_pk_bf16_f32 v113, v66, v67
    v_mfma_f32_32x32x16_bf16 v[48:63], a[12:15], v[100:103], v[48:63]
    v_cvt_pk_bf16_f32 v114, v72, v73
    v_cvt_pk_bf16_f32 v115, v74, v75
    ds_read_b128 v[100:103], v3 offset:5120
    s_waitcnt lgkmcnt(3)
    v_mfma_f32_32x32x16_bf16 v[32:47], a[16:19], v[104:107], v[32:47]
    buffer_store_dwordx4 v[112:115], v2, s[4:7], s15 offen offset:0 sc1
    v_cvt_pk_bf16_f32 v116, v68, v69
    v_mfma_f32_32x32x16_bf16 v[48:63], a[20:23], v[104:107], v[48:63]
    v_cvt_pk_bf16_f32 v117, v70, v71
    v_cvt_pk_bf16_f32 v118, v76, v77
    ds_read_b128 v[104:107], v3 offset:6144
    s_waitcnt lgkmcnt(3)
    v_mfma_f32_32x32x16_bf16 v[32:47], a[24:27], v[108:111], v[32:47]
    v_cvt_pk_bf16_f32 v119, v78, v79
    buffer_store_dwordx4 v[116:119], v2, s[4:7], s15 offen offset:512 sc1
    v_mfma_f32_32x32x16_bf16 v[48:63], a[28:31], v[108:111], v[48:63]
    v_cvt_pk_bf16_f32 v120, v80, v81
    v_cvt_pk_bf16_f32 v121, v82, v83
    ds_read_b128 v[108:111], v3 offset:7168
    s_waitcnt lgkmcnt(3)
    v_mfma_f32_32x32x16_bf16 v[32:47], a[32:35], v[96:99], v[32:47]
    v_cvt_pk_bf16_f32 v122, v88, v89
    v_cvt_pk_bf16_f32 v123, v90, v91
    v_mfma_f32_32x32x16_bf16 v[48:63], a[36:39], v[96:99], v[48:63]
    buffer_store_dwordx4 v[120:123], v2, s[4:7], s28 offen offset:0 sc1
    v_cvt_pk_bf16_f32 v124, v84, v85
    ds_read_b128 v[96:99], v3 offset:8192
    s_waitcnt lgkmcnt(3)
    v_mfma_f32_32x32x16_bf16 v[32:47], a[40:43], v[100:103], v[32:47]
    v_cvt_pk_bf16_f32 v125, v86, v87
    v_cvt_pk_bf16_f32 v126, v92, v93
    v_mfma_f32_32x32x16_bf16 v[48:63], a[44:47], v[100:103], v[48:63]
    v_cvt_pk_bf16_f32 v127, v94, v95
    buffer_store_dwordx4 v[124:127], v2, s[4:7], s28 offen offset:512 sc1
    ds_read_b128 v[100:103], v3 offset:9216
    s_waitcnt lgkmcnt(3)
    v_mfma_f32_32x32x16_bf16 v[32:47], a[48:51], v[104:107], v[32:47]
    v_mfma_f32_32x32x16_bf16 v[48:63], a[52:55], v[104:107], v[48:63]
    ds_read_b128 v[104:107], v3 offset:10240
    s_waitcnt lgkmcnt(3)
    v_mfma_f32_32x32x16_bf16 v[32:47], a[56:59], v[108:111], v[32:47]
    v_mfma_f32_32x32x16_bf16 v[48:63], a[60:63], v[108:111], v[48:63]
    ds_read_b128 v[108:111], v3 offset:11264
    s_waitcnt lgkmcnt(3)
    v_mfma_f32_32x32x16_bf16 v[32:47], a[64:67], v[96:99], v[32:47]
    v_mfma_f32_32x32x16_bf16 v[48:63], a[68:71], v[96:99], v[48:63]
    ds_read_b128 v[96:99], v3 offset:12288
    s_waitcnt lgkmcnt(3)
    v_mfma_f32_32x32x16_bf16 v[32:47], a[72:75], v[100:103], v[32:47]
    v_mfma_f32_32x32x16_bf16 v[48:63], a[76:79], v[100:103], v[48:63]
    ds_read_b128 v[100:103], v3 offset:13312
    s_waitcnt lgkmcnt(3)
    v_mfma_f32_32x32x16_bf16 v[32:47], a[80:83], v[104:107], v[32:47]
    v_mfma_f32_32x32x16_bf16 v[48:63], a[84:87], v[104:107], v[48:63]
    ds_read_b128 v[104:107], v3 offset:14336
    s_waitcnt lgkmcnt(3)
    v_mfma_f32_32x32x16_bf16 v[32:47], a[88:91], v[108:111], v[32:47]
    v_mfma_f32_32x32x16_bf16 v[48:63], a[92:95], v[108:111], v[48:63]
    ds_read_b128 v[108:111], v3 offset:15360
    s_waitcnt lgkmcnt(3)
    v_mfma_f32_32x32x16_bf16 v[32:47], a[96:99], v[96:99], v[32:47]
    v_mfma_f32_32x32x16_bf16 v[48:63], a[100:103], v[96:99], v[48:63]
    ds_read_b128 v[96:99], v3 offset:16384
    s_waitcnt lgkmcnt(3)
    v_mfma_f32_32x32x16_bf16 v[32:47], a[104:107], v[100:103], v[32:47]
    v_mfma_f32_32x32x16_bf16 v[48:63], a[108:111], v[100:103], v[48:63]
    ds_read_b128 v[100:103], v3 offset:17408
    s_waitcnt lgkmcnt(3)
    v_mfma_f32_32x32x16_bf16 v[32:47], a[112:115], v[104:107], v[32:47]
    v_mfma_f32_32x32x16_bf16 v[48:63], a[116:119], v[104:107], v[48:63]
    ds_read_b128 v[104:107], v3 offset:18432
    s_waitcnt lgkmcnt(3)
    v_mfma_f32_32x32x16_bf16 v[32:47], a[120:123], v[108:111], v[32:47]
    v_mfma_f32_32x32x16_bf16 v[48:63], a[124:127], v[108:111], v[48:63]
    ds_read_b128 v[108:111], v3 offset:19456
    s_waitcnt lgkmcnt(3)
    v_mfma_f32_32x32x16_bf16 v[32:47], a[128:131], v[96:99], v[32:47]
    v_mfma_f32_32x32x16_bf16 v[48:63], a[132:135], v[96:99], v[48:63]
    ds_read_b128 v[96:99], v3 offset:20480
    s_waitcnt lgkmcnt(3)
    v_mfma_f32_32x32x16_bf16 v[32:47], a[136:139], v[100:103], v[32:47]
    v_mfma_f32_32x32x16_bf16 v[48:63], a[140:143], v[100:103], v[48:63]
    ds_read_b128 v[100:103], v3 offset:21504
    s_waitcnt lgkmcnt(3)
    v_mfma_f32_32x32x16_bf16 v[32:47], a[144:147], v[104:107], v[32:47]
    v_mfma_f32_32x32x16_bf16 v[48:63], a[148:151], v[104:107], v[48:63]
    ds_read_b128 v[104:107], v3 offset:22528
    s_waitcnt lgkmcnt(3)
    v_mfma_f32_32x32x16_bf16 v[32:47], a[152:155], v[108:111], v[32:47]
    v_mfma_f32_32x32x16_bf16 v[48:63], a[156:159], v[108:111], v[48:63]
    ds_read_b128 v[108:111], v3 offset:23552
    s_waitcnt lgkmcnt(3)
    v_mfma_f32_32x32x16_bf16 v[32:47], a[160:163], v[96:99], v[32:47]
    v_mfma_f32_32x32x16_bf16 v[48:63], a[164:167], v[96:99], v[48:63]
    ds_read_b128 v[96:99], v3 offset:24576
    s_waitcnt lgkmcnt(3)
    v_mfma_f32_32x32x16_bf16 v[32:47], a[168:171], v[100:103], v[32:47]
    v_mfma_f32_32x32x16_bf16 v[48:63], a[172:175], v[100:103], v[48:63]
    ds_read_b128 v[100:103], v3 offset:25600
    s_waitcnt lgkmcnt(3)
    v_mfma_f32_32x32x16_bf16 v[32:47], a[176:179], v[104:107], v[32:47]
    v_mfma_f32_32x32x16_bf16 v[48:63], a[180:183], v[104:107], v[48:63]
    ds_read_b128 v[104:107], v3 offset:26624
    s_waitcnt lgkmcnt(3)
    v_mfma_f32_32x32x16_bf16 v[32:47], a[184:187], v[108:111], v[32:47]
    v_mfma_f32_32x32x16_bf16 v[48:63], a[188:191], v[108:111], v[48:63]
    ds_read_b128 v[108:111], v3 offset:27648
    s_waitcnt lgkmcnt(3)
    v_mfma_f32_32x32x16_bf16 v[32:47], a[192:195], v[96:99], v[32:47]
    v_mfma_f32_32x32x16_bf16 v[48:63], a[196:199], v[96:99], v[48:63]
    ds_read_b128 v[96:99], v3 offset:28672
    s_waitcnt lgkmcnt(3)
    v_mfma_f32_32x32x16_bf16 v[32:47], a[200:203], v[100:103], v[32:47]
    v_mfma_f32_32x32x16_bf16 v[48:63], a[204:207], v[100:103], v[48:63]
    ds_read_b128 v[100:103], v3 offset:29696
    s_waitcnt lgkmcnt(3)
    v_mfma_f32_32x32x16_bf16 v[32:47], a[208:211], v[104:107], v[32:47]
    v_mfma_f32_32x32x16_bf16 v[48:63], a[212:215], v[104:107], v[48:63]
    ds_read_b128 v[104:107], v3 offset:30720
    s_waitcnt lgkmcnt(3)
    v_mfma_f32_32x32x16_bf16 v[32:47], a[216:219], v[108:111], v[32:47]
    v_mfma_f32_32x32x16_bf16 v[48:63], a[220:223], v[108:111], v[48:63]
    ds_read_b128 v[108:111], v3 offset:31744
    s_waitcnt lgkmcnt(3)
    v_mfma_f32_32x32x16_bf16 v[32:47], a[224:227], v[96:99], v[32:47]
    v_mfma_f32_32x32x16_bf16 v[48:63], a[228:231], v[96:99], v[48:63]
    s_waitcnt lgkmcnt(2)
    v_mfma_f32_32x32x16_bf16 v[32:47], a[232:235], v[100:103], v[32:47]
    v_mfma_f32_32x32x16_bf16 v[48:63], a[236:239], v[100:103], v[48:63]
    s_waitcnt lgkmcnt(1)
    v_mfma_f32_32x32x16_bf16 v[32:47], a[240:243], v[104:107], v[32:47]
    v_mfma_f32_32x32x16_bf16 v[48:63], a[244:247], v[104:107], v[48:63]
    s_waitcnt lgkmcnt(0)
    v_mfma_f32_32x32x16_bf16 v[32:47], a[248:251], v[108:111], v[32:47]
    v_mfma_f32_32x32x16_bf16 v[48:63], a[252:255], v[108:111], v[48:63]
    s_add_u32 s15, s15, 1048576
    s_add_u32 s17, s17, 1
L_QKV_LOOPK:
    s_waitcnt vmcnt(0)
    s_barrier
    s_cmp_eq_u32 s17, 6
    s_cbranch_scc0 L_QKV_NOBK2
    s_load_dwordx2 s[96:97], s[0:1], 96
    v_mov_b32 v6, 200
    s_mov_b32 s94, 0
    s_waitcnt lgkmcnt(0)
L_WDQLBK2:
    global_load_dword v7, v6, s[96:97] sc1
    s_waitcnt vmcnt(0)
    v_readfirstlane_b32 s95, v7
    s_add_u32 s94, s94, 1
    s_cmp_gt_u32 s94, 2000000
    s_cbranch_scc1 L_GBAIL
    s_cmp_ge_u32 s95, 32
    s_cbranch_scc1 L_WDOKQLBK2
    s_sleep 4
    s_branch L_WDQLBK2
L_WDOKQLBK2:
L_QKV_NOBK2:
    s_sub_i32 s20, s17, 1
    s_max_i32 s20, s20, 0
    v_mov_b32 v6, s20
    buffer_store_dword v6, v5, s[4:7], s23 offen sc1
    s_add_u32 s22, s26, s27
    s_mov_b32 m0, s22
    s_add_u32 s22, s22, 1024
    buffer_load_dwordx4 v1, s[4:7], s25 offen lds
    s_add_u32 s25, s25, 1024
    s_mov_b32 m0, s22
    s_add_u32 s22, s22, 1024
    buffer_load_dwordx4 v1, s[4:7], s25 offen lds
    s_add_u32 s25, s25, 1024
    s_mov_b32 m0, s22
    s_add_u32 s22, s22, 1024
    buffer_load_dwordx4 v1, s[4:7], s25 offen lds
    s_add_u32 s25, s25, 1024
    s_mov_b32 m0, s22
    s_add_u32 s22, s22, 1024
    buffer_load_dwordx4 v1, s[4:7], s25 offen lds
    s_add_u32 s25, s25, 1024
    s_mov_b32 m0, s22
    s_add_u32 s22, s22, 1024
    buffer_load_dwordx4 v1, s[4:7], s25 offen lds
    s_add_u32 s25, s25, 1024
    s_mov_b32 m0, s22
    s_add_u32 s22, s22, 1024
    buffer_load_dwordx4 v1, s[4:7], s25 offen lds
    s_add_u32 s25, s25, 1024
    s_mov_b32 m0, s22
    s_add_u32 s22, s22, 1024
    buffer_load_dwordx4 v1, s[4:7], s25 offen lds
    s_add_u32 s25, s25, 1024
    s_mov_b32 m0, s22
    s_add_u32 s22, s22, 1024
    buffer_load_dwordx4 v1, s[4:7], s25 offen lds
    s_add_u32 s25, s25, 1024
    s_add_u32 s25, s25, 122880
    s_add_u32 s27, s27, 32768
    s_cmp_eq_u32 s27, 98304
    s_cselect_b32 s27, 0, s27
    v_add_u32 v3, s29, v1
    s_add_u32 s29, s29, 32768
    s_cmp_eq_u32 s29, 98304
    s_cselect_b32 s29, 0, s29
    s_add_u32 s28, s15, s24
    ds_read_b128 v[96:99], v3 offset:0
    ds_read_b128 v[100:103], v3 offset:1024
    ds_read_b128 v[104:107], v3 offset:2048
    ds_read_b128 v[108:111], v3 offset:3072
    s_waitcnt lgkmcnt(3)
    v_mfma_f32_32x32x16_bf16 v[64:79], a[0:3], v[96:99], 0
    v_mfma_f32_32x32x16_bf16 v[80:95], a[4:7], v[96:99], 0
    ds_read_b128 v[96:99], v3 offset:4096
    s_waitcnt lgkmcnt(3)
    v_mfma_f32_32x32x16_bf16 v[64:79], a[8:11], v[100:103], v[64:79]
    v_cvt_pk_bf16_f32 v112, v32, v33
    v_cvt_pk_bf16_f32 v113, v34, v35
    v_mfma_f32_32x32x16_bf16 v[80:95], a[12:15], v[100:103], v[80:95]
    v_cvt_pk_bf16_f32 v114, v40, v41
    v_cvt_pk_bf16_f32 v115, v42, v43
    ds_read_b128 v[100:103], v3 offset:5120
    s_waitcnt lgkmcnt(3)
    v_mfma_f32_32x32x16_bf16 v[64:79], a[16:19], v[104:107], v[64:79]
    buffer_store_dwordx4 v[112:115], v2, s[4:7], s15 offen offset:0 sc1
    v_cvt_pk_bf16_f32 v116, v36, v37
    v_mfma_f32_32x32x16_bf16 v[80:95], a[20:23], v[104:107], v[80:95]
    v_cvt_pk_bf16_f32 v117, v38, v39
    v_cvt_pk_bf16_f32 v118, v44, v45
    ds_read_b128 v[104:107], v3 offset:6144
    s_waitcnt lgkmcnt(3)
    v_mfma_f32_32x32x16_bf16 v[64:79], a[24:27], v[108:111], v[64:79]
    v_cvt_pk_bf16_f32 v119, v46, v47
    buffer_store_dwordx4 v[116:119], v2, s[4:7], s15 offen offset:512 sc1
    v_mfma_f32_32x32x16_bf16 v[80:95], a[28:31], v[108:111], v[80:95]
    v_cvt_pk_bf16_f32 v120, v48, v49
    v_cvt_pk_bf16_f32 v121, v50, v51
    ds_read_b128 v[108:111], v3 offset:7168
    s_waitcnt lgkmcnt(3)
    v_mfma_f32_32x32x16_bf16 v[64:79], a[32:35], v[96:99], v[64:79]
    v_cvt_pk_bf16_f32 v122, v56, v57
    v_cvt_pk_bf16_f32 v123, v58, v59
    v_mfma_f32_32x32x16_bf16 v[80:95], a[36:39], v[96:99], v[80:95]
    buffer_store_dwordx4 v[120:123], v2, s[4:7], s28 offen offset:0 sc1
    v_cvt_pk_bf16_f32 v124, v52, v53
    ds_read_b128 v[96:99], v3 offset:8192
    s_waitcnt lgkmcnt(3)
    v_mfma_f32_32x32x16_bf16 v[64:79], a[40:43], v[100:103], v[64:79]
    v_cvt_pk_bf16_f32 v125, v54, v55
    v_cvt_pk_bf16_f32 v126, v60, v61
    v_mfma_f32_32x32x16_bf16 v[80:95], a[44:47], v[100:103], v[80:95]
    v_cvt_pk_bf16_f32 v127, v62, v63
    buffer_store_dwordx4 v[124:127], v2, s[4:7], s28 offen offset:512 sc1
    ds_read_b128 v[100:103], v3 offset:9216
    s_waitcnt lgkmcnt(3)
    v_mfma_f32_32x32x16_bf16 v[64:79], a[48:51], v[104:107], v[64:79]
    v_mfma_f32_32x32x16_bf16 v[80:95], a[52:55], v[104:107], v[80:95]
    ds_read_b128 v[104:107], v3 offset:10240
    s_waitcnt lgkmcnt(3)
    v_mfma_f32_32x32x16_bf16 v[64:79], a[56:59], v[108:111], v[64:79]
    v_mfma_f32_32x32x16_bf16 v[80:95], a[60:63], v[108:111], v[80:95]
    ds_read_b128 v[108:111], v3 offset:11264
    s_waitcnt lgkmcnt(3)
    v_mfma_f32_32x32x16_bf16 v[64:79], a[64:67], v[96:99], v[64:79]
    v_mfma_f32_32x32x16_bf16 v[80:95], a[68:71], v[96:99], v[80:95]
    ds_read_b128 v[96:99], v3 offset:12288
    s_waitcnt lgkmcnt(3)
    v_mfma_f32_32x32x16_bf16 v[64:79], a[72:75], v[100:103], v[64:79]
    v_mfma_f32_32x32x16_bf16 v[80:95], a[76:79], v[100:103], v[80:95]
    ds_read_b128 v[100:103], v3 offset:13312
    s_waitcnt lgkmcnt(3)
    v_mfma_f32_32x32x16_bf16 v[64:79], a[80:83], v[104:107], v[64:79]
    v_mfma_f32_32x32x16_bf16 v[80:95], a[84:87], v[104:107], v[80:95]
    ds_read_b128 v[104:107], v3 offset:14336
    s_waitcnt lgkmcnt(3)
    v_mfma_f32_32x32x16_bf16 v[64:79], a[88:91], v[108:111], v[64:79]
    v_mfma_f32_32x32x16_bf16 v[80:95], a[92:95], v[108:111], v[80:95]
    ds_read_b128 v[108:111], v3 offset:15360
    s_waitcnt lgkmcnt(3)
    v_mfma_f32_32x32x16_bf16 v[64:79], a[96:99], v[96:99], v[64:79]
    v_mfma_f32_32x32x16_bf16 v[80:95], a[100:103], v[96:99], v[80:95]
    ds_read_b128 v[96:99], v3 offset:16384
    s_waitcnt lgkmcnt(3)
    v_mfma_f32_32x32x16_bf16 v[64:79], a[104:107], v[100:103], v[64:79]
    v_mfma_f32_32x32x16_bf16 v[80:95], a[108:111], v[100:103], v[80:95]
    ds_read_b128 v[100:103], v3 offset:17408
    s_waitcnt lgkmcnt(3)
    v_mfma_f32_32x32x16_bf16 v[64:79], a[112:115], v[104:107], v[64:79]
    v_mfma_f32_32x32x16_bf16 v[80:95], a[116:119], v[104:107], v[80:95]
    ds_read_b128 v[104:107], v3 offset:18432
    s_waitcnt lgkmcnt(3)
    v_mfma_f32_32x32x16_bf16 v[64:79], a[120:123], v[108:111], v[64:79]
    v_mfma_f32_32x32x16_bf16 v[80:95], a[124:127], v[108:111], v[80:95]
    ds_read_b128 v[108:111], v3 offset:19456
    s_waitcnt lgkmcnt(3)
    v_mfma_f32_32x32x16_bf16 v[64:79], a[128:131], v[96:99], v[64:79]
    v_mfma_f32_32x32x16_bf16 v[80:95], a[132:135], v[96:99], v[80:95]
    ds_read_b128 v[96:99], v3 offset:20480
    s_waitcnt lgkmcnt(3)
    v_mfma_f32_32x32x16_bf16 v[64:79], a[136:139], v[100:103], v[64:79]
    v_mfma_f32_32x32x16_bf16 v[80:95], a[140:143], v[100:103], v[80:95]
    ds_read_b128 v[100:103], v3 offset:21504
    s_waitcnt lgkmcnt(3)
    v_mfma_f32_32x32x16_bf16 v[64:79], a[144:147], v[104:107], v[64:79]
    v_mfma_f32_32x32x16_bf16 v[80:95], a[148:151], v[104:107], v[80:95]
    ds_read_b128 v[104:107], v3 offset:22528
    s_waitcnt lgkmcnt(3)
    v_mfma_f32_32x32x16_bf16 v[64:79], a[152:155], v[108:111], v[64:79]
    v_mfma_f32_32x32x16_bf16 v[80:95], a[156:159], v[108:111], v[80:95]
    ds_read_b128 v[108:111], v3 offset:23552
    s_waitcnt lgkmcnt(3)
    v_mfma_f32_32x32x16_bf16 v[64:79], a[160:163], v[96:99], v[64:79]
    v_mfma_f32_32x32x16_bf16 v[80:95], a[164:167], v[96:99], v[80:95]
    ds_read_b128 v[96:99], v3 offset:24576
    s_waitcnt lgkmcnt(3)
    v_mfma_f32_32x32x16_bf16 v[64:79], a[168:171], v[100:103], v[64:79]
    v_mfma_f32_32x32x16_bf16 v[80:95], a[172:175], v[100:103], v[80:95]
    ds_read_b128 v[100:103], v3 offset:25600
    s_waitcnt lgkmcnt(3)
    v_mfma_f32_32x32x16_bf16 v[64:79], a[176:179], v[104:107], v[64:79]
    v_mfma_f32_32x32x16_bf16 v[80:95], a[180:183], v[104:107], v[80:95]
    ds_read_b128 v[104:107], v3 offset:26624
    s_waitcnt lgkmcnt(3)
    v_mfma_f32_32x32x16_bf16 v[64:79], a[184:187], v[108:111], v[64:79]
    v_mfma_f32_32x32x16_bf16 v[80:95], a[188:191], v[108:111], v[80:95]
    ds_read_b128 v[108:111], v3 offset:27648
    s_waitcnt lgkmcnt(3)
    v_mfma_f32_32x32x16_bf16 v[64:79], a[192:195], v[96:99], v[64:79]
    v_mfma_f32_32x32x16_bf16 v[80:95], a[196:199], v[96:99], v[80:95]
    ds_read_b128 v[96:99], v3 offset:28672
    s_waitcnt lgkmcnt(3)
    v_mfma_f32_32x32x16_bf16 v[64:79], a[200:203], v[100:103], v[64:79]
    v_mfma_f32_32x32x16_bf16 v[80:95], a[204:207], v[100:103], v[80:95]
    ds_read_b128 v[100:103], v3 offset:29696
    s_waitcnt lgkmcnt(3)
    v_mfma_f32_32x32x16_bf16 v[64:79], a[208:211], v[104:107], v[64:79]
    v_mfma_f32_32x32x16_bf16 v[80:95], a[212:215], v[104:107], v[80:95]
    ds_read_b128 v[104:107], v3 offset:30720
    s_waitcnt lgkmcnt(3)
    v_mfma_f32_32x32x16_bf16 v[64:79], a[216:219], v[108:111], v[64:79]
    v_mfma_f32_32x32x16_bf16 v[80:95], a[220:223], v[108:111], v[80:95]
    ds_read_b128 v[108:111], v3 offset:31744
    s_waitcnt lgkmcnt(3)
    v_mfma_f32_32x32x16_bf16 v[64:79], a[224:227], v[96:99], v[64:79]
    v_mfma_f32_32x32x16_bf16 v[80:95], a[228:231], v[96:99], v[80:95]
    s_waitcnt lgkmcnt(2)
    v_mfma_f32_32x32x16_bf16 v[64:79], a[232:235], v[100:103], v[64:79]
    v_mfma_f32_32x32x16_bf16 v[80:95], a[236:239], v[100:103], v[80:95]
    s_waitcnt lgkmcnt(1)
    v_mfma_f32_32x32x16_bf16 v[64:79], a[240:243], v[104:107], v[64:79]
    v_mfma_f32_32x32x16_bf16 v[80:95], a[244:247], v[104:107], v[80:95]
    s_waitcnt lgkmcnt(0)
    v_mfma_f32_32x32x16_bf16 v[64:79], a[248:251], v[108:111], v[64:79]
    v_mfma_f32_32x32x16_bf16 v[80:95], a[252:255], v[108:111], v[80:95]
    s_add_u32 s15, s15, 1048576
    s_add_u32 s17, s17, 1
    s_cmp_eq_u32 s17, 16
    s_cbranch_scc1 L_QKV_ENDK
    s_waitcnt vmcnt(0)
    s_barrier
    s_cmp_eq_u32 s17, 6
    s_cbranch_scc0 L_QKV_NOBK3
    s_load_dwordx2 s[96:97], s[0:1], 96
    v_mov_b32 v6, 200
    s_mov_b32 s94, 0
    s_waitcnt lgkmcnt(0)
L_WDQLBK3:
    global_load_dword v7, v6, s[96:97] sc1
    s_waitcnt vmcnt(0)
    v_readfirstlane_b32 s95, v7
    s_add_u32 s94, s94, 1
    s_cmp_gt_u32 s94, 2000000
    s_cbranch_scc1 L_GBAIL
    s_cmp_ge_u32 s95, 32
    s_cbranch_scc1 L_WDOKQLBK3
    s_sleep 4
    s_branch L_WDQLBK3
L_WDOKQLBK3:
L_QKV_NOBK3:
    s_sub_i32 s20, s17, 1
    s_max_i32 s20, s20, 0
    v_mov_b32 v6, s20
    buffer_store_dword v6, v5, s[4:7], s23 offen sc1
    s_add_u32 s22, s26, s27
    s_mov_b32 m0, s22
    s_add_u32 s22, s22, 1024
    buffer_load_dwordx4 v1, s[4:7], s25 offen lds
    s_add_u32 s25, s25, 1024
    s_mov_b32 m0, s22
    s_add_u32 s22, s22, 1024
    buffer_load_dwordx4 v1, s[4:7], s25 offen lds
    s_add_u32 s25, s25, 1024
    s_mov_b32 m0, s22
    s_add_u32 s22, s22, 1024
    buffer_load_dwordx4 v1, s[4:7], s25 offen lds
    s_add_u32 s25, s25, 1024
    s_mov_b32 m0, s22
    s_add_u32 s22, s22, 1024
    buffer_load_dwordx4 v1, s[4:7], s25 offen lds
    s_add_u32 s25, s25, 1024
    s_mov_b32 m0, s22
    s_add_u32 s22, s22, 1024
    buffer_load_dwordx4 v1, s[4:7], s25 offen lds
    s_add_u32 s25, s25, 1024
    s_mov_b32 m0, s22
    s_add_u32 s22, s22, 1024
    buffer_load_dwordx4 v1, s[4:7], s25 offen lds
    s_add_u32 s25, s25, 1024
    s_mov_b32 m0, s22
    s_add_u32 s22, s22, 1024
    buffer_load_dwordx4 v1, s[4:7], s25 offen lds
    s_add_u32 s25, s25, 1024
    s_mov_b32 m0, s22
    s_add_u32 s22, s22, 1024
    buffer_load_dwordx4 v1, s[4:7], s25 offen lds
    s_add_u32 s25, s25, 1024
    s_add_u32 s25, s25, 122880
    s_add_u32 s27, s27, 32768
    s_cmp_eq_u32 s27, 98304
    s_cselect_b32 s27, 0, s27
    v_add_u32 v3, s29, v1
    s_add_u32 s29, s29, 32768
    s_cmp_eq_u32 s29, 98304
    s_cselect_b32 s29, 0, s29
    s_add_u32 s28, s15, s24
    ds_read_b128 v[96:99], v3 offset:0
    ds_read_b128 v[100:103], v3 offset:1024
    ds_read_b128 v[104:107], v3 offset:2048
    ds_read_b128 v[108:111], v3 offset:3072
    s_waitcnt lgkmcnt(3)
    v_mfma_f32_32x32x16_bf16 v[32:47], a[0:3], v[96:99], 0
    v_mfma_f32_32x32x16_bf16 v[48:63], a[4:7], v[96:99], 0
    ds_read_b128 v[96:99], v3 offset:4096
    s_waitcnt lgkmcnt(3)
    v_mfma_f32_32x32x16_bf16 v[32:47], a[8:11], v[100:103], v[32:47]
    v_cvt_pk_bf16_f32 v112, v64, v65
    v_cvt_pk_bf16_f32 v113, v66, v67
    v_mfma_f32_32x32x16_bf16 v[48:63], a[12:15], v[100:103], v[48:63]
    v_cvt_pk_bf16_f32 v114, v72, v73
    v_cvt_pk_bf16_f32 v115, v74, v75
    ds_read_b128 v[100:103], v3 offset:5120
    s_waitcnt lgkmcnt(3)
    v_mfma_f32_32x32x16_bf16 v[32:47], a[16:19], v[104:107], v[32:47]
    buffer_store_dwordx4 v[112:115], v2, s[4:7], s15 offen offset:0 sc1
    v_cvt_pk_bf16_f32 v116, v68, v69
    v_mfma_f32_32x32x16_bf16 v[48:63], a[20:23], v[104:107], v[48:63]
    v_cvt_pk_bf16_f32 v117, v70, v71
    v_cvt_pk_bf16_f32 v118, v76, v77
    ds_read_b128 v[104:107], v3 offset:6144
    s_waitcnt lgkmcnt(3)
    v_mfma_f32_32x32x16_bf16 v[32:47], a[24:27], v[108:111], v[32:47]
    v_cvt_pk_bf16_f32 v119, v78, v79
    buffer_store_dwordx4 v[116:119], v2, s[4:7], s15 offen offset:512 sc1
    v_mfma_f32_32x32x16_bf16 v[48:63], a[28:31], v[108:111], v[48:63]
    v_cvt_pk_bf16_f32 v120, v80, v81
    v_cvt_pk_bf16_f32 v121, v82, v83
    ds_read_b128 v[108:111], v3 offset:7168
    s_waitcnt lgkmcnt(3)
    v_mfma_f32_32x32x16_bf16 v[32:47], a[32:35], v[96:99], v[32:47]
    v_cvt_pk_bf16_f32 v122, v88, v89
    v_cvt_pk_bf16_f32 v123, v90, v91
    v_mfma_f32_32x32x16_bf16 v[48:63], a[36:39], v[96:99], v[48:63]
    buffer_store_dwordx4 v[120:123], v2, s[4:7], s28 offen offset:0 sc1
    v_cvt_pk_bf16_f32 v124, v84, v85
    ds_read_b128 v[96:99], v3 offset:8192
    s_waitcnt lgkmcnt(3)
    v_mfma_f32_32x32x16_bf16 v[32:47], a[40:43], v[100:103], v[32:47]
    v_cvt_pk_bf16_f32 v125, v86, v87
    v_cvt_pk_bf16_f32 v126, v92, v93
    v_mfma_f32_32x32x16_bf16 v[48:63], a[44:47], v[100:103], v[48:63]
    v_cvt_pk_bf16_f32 v127, v94, v95
    buffer_store_dwordx4 v[124:127], v2, s[4:7], s28 offen offset:512 sc1
    ds_read_b128 v[100:103], v3 offset:9216
    s_waitcnt lgkmcnt(3)
    v_mfma_f32_32x32x16_bf16 v[32:47], a[48:51], v[104:107], v[32:47]
    v_mfma_f32_32x32x16_bf16 v[48:63], a[52:55], v[104:107], v[48:63]
    ds_read_b128 v[104:107], v3 offset:10240
    s_waitcnt lgkmcnt(3)
    v_mfma_f32_32x32x16_bf16 v[32:47], a[56:59], v[108:111], v[32:47]
    v_mfma_f32_32x32x16_bf16 v[48:63], a[60:63], v[108:111], v[48:63]
    ds_read_b128 v[108:111], v3 offset:11264
    s_waitcnt lgkmcnt(3)
    v_mfma_f32_32x32x16_bf16 v[32:47], a[64:67], v[96:99], v[32:47]
    v_mfma_f32_32x32x16_bf16 v[48:63], a[68:71], v[96:99], v[48:63]
    ds_read_b128 v[96:99], v3 offset:12288
    s_waitcnt lgkmcnt(3)
    v_mfma_f32_32x32x16_bf16 v[32:47], a[72:75], v[100:103], v[32:47]
    v_mfma_f32_32x32x16_bf16 v[48:63], a[76:79], v[100:103], v[48:63]
    ds_read_b128 v[100:103], v3 offset:13312
    s_waitcnt lgkmcnt(3)
    v_mfma_f32_32x32x16_bf16 v[32:47], a[80:83], v[104:107], v[32:47]
    v_mfma_f32_32x32x16_bf16 v[48:63], a[84:87], v[104:107], v[48:63]
    ds_read_b128 v[104:107], v3 offset:14336
    s_waitcnt lgkmcnt(3)
    v_mfma_f32_32x32x16_bf16 v[32:47], a[88:91], v[108:111], v[32:47]
    v_mfma_f32_32x32x16_bf16 v[48:63], a[92:95], v[108:111], v[48:63]
    ds_read_b128 v[108:111], v3 offset:15360
    s_waitcnt lgkmcnt(3)
    v_mfma_f32_32x32x16_bf16 v[32:47], a[96:99], v[96:99], v[32:47]
    v_mfma_f32_32x32x16_bf16 v[48:63], a[100:103], v[96:99], v[48:63]
    ds_read_b128 v[96:99], v3 offset:16384
    s_waitcnt lgkmcnt(3)
    v_mfma_f32_32x32x16_bf16 v[32:47], a[104:107], v[100:103], v[32:47]
    v_mfma_f32_32x32x16_bf16 v[48:63], a[108:111], v[100:103], v[48:63]
    ds_read_b128 v[100:103], v3 offset:17408
    s_waitcnt lgkmcnt(3)
    v_mfma_f32_32x32x16_bf16 v[32:47], a[112:115], v[104:107], v[32:47]
    v_mfma_f32_32x32x16_bf16 v[48:63], a[116:119], v[104:107], v[48:63]
    ds_read_b128 v[104:107], v3 offset:18432
    s_waitcnt lgkmcnt(3)
    v_mfma_f32_32x32x16_bf16 v[32:47], a[120:123], v[108:111], v[32:47]
    v_mfma_f32_32x32x16_bf16 v[48:63], a[124:127], v[108:111], v[48:63]
    ds_read_b128 v[108:111], v3 offset:19456
    s_waitcnt lgkmcnt(3)
    v_mfma_f32_32x32x16_bf16 v[32:47], a[128:131], v[96:99], v[32:47]
    v_mfma_f32_32x32x16_bf16 v[48:63], a[132:135], v[96:99], v[48:63]
    ds_read_b128 v[96:99], v3 offset:20480
    s_waitcnt lgkmcnt(3)
    v_mfma_f32_32x32x16_bf16 v[32:47], a[136:139], v[100:103], v[32:47]
    v_mfma_f32_32x32x16_bf16 v[48:63], a[140:143], v[100:103], v[48:63]
    ds_read_b128 v[100:103], v3 offset:21504
    s_waitcnt lgkmcnt(3)
    v_mfma_f32_32x32x16_bf16 v[32:47], a[144:147], v[104:107], v[32:47]
    v_mfma_f32_32x32x16_bf16 v[48:63], a[148:151], v[104:107], v[48:63]
    ds_read_b128 v[104:107], v3 offset:22528
    s_waitcnt lgkmcnt(3)
    v_mfma_f32_32x32x16_bf16 v[32:47], a[152:155], v[108:111], v[32:47]
    v_mfma_f32_32x32x16_bf16 v[48:63], a[156:159], v[108:111], v[48:63]
    ds_read_b128 v[108:111], v3 offset:23552
    s_waitcnt lgkmcnt(3)
    v_mfma_f32_32x32x16_bf16 v[32:47], a[160:163], v[96:99], v[32:47]
    v_mfma_f32_32x32x16_bf16 v[48:63], a[164:167], v[96:99], v[48:63]
    ds_read_b128 v[96:99], v3 offset:24576
    s_waitcnt lgkmcnt(3)
    v_mfma_f32_32x32x16_bf16 v[32:47], a[168:171], v[100:103], v[32:47]
    v_mfma_f32_32x32x16_bf16 v[48:63], a[172:175], v[100:103], v[48:63]
    ds_read_b128 v[100:103], v3 offset:25600
    s_waitcnt lgkmcnt(3)
    v_mfma_f32_32x32x16_bf16 v[32:47], a[176:179], v[104:107], v[32:47]
    v_mfma_f32_32x32x16_bf16 v[48:63], a[180:183], v[104:107], v[48:63]
    ds_read_b128 v[104:107], v3 offset:26624
    s_waitcnt lgkmcnt(3)
    v_mfma_f32_32x32x16_bf16 v[32:47], a[184:187], v[108:111], v[32:47]
    v_mfma_f32_32x32x16_bf16 v[48:63], a[188:191], v[108:111], v[48:63]
    ds_read_b128 v[108:111], v3 offset:27648
    s_waitcnt lgkmcnt(3)
    v_mfma_f32_32x32x16_bf16 v[32:47], a[192:195], v[96:99], v[32:47]
    v_mfma_f32_32x32x16_bf16 v[48:63], a[196:199], v[96:99], v[48:63]
    ds_read_b128 v[96:99], v3 offset:28672
    s_waitcnt lgkmcnt(3)
    v_mfma_f32_32x32x16_bf16 v[32:47], a[200:203], v[100:103], v[32:47]
    v_mfma_f32_32x32x16_bf16 v[48:63], a[204:207], v[100:103], v[48:63]
    ds_read_b128 v[100:103], v3 offset:29696
    s_waitcnt lgkmcnt(3)
    v_mfma_f32_32x32x16_bf16 v[32:47], a[208:211], v[104:107], v[32:47]
    v_mfma_f32_32x32x16_bf16 v[48:63], a[212:215], v[104:107], v[48:63]
    ds_read_b128 v[104:107], v3 offset:30720
    s_waitcnt lgkmcnt(3)
    v_mfma_f32_32x32x16_bf16 v[32:47], a[216:219], v[108:111], v[32:47]
    v_mfma_f32_32x32x16_bf16 v[48:63], a[220:223], v[108:111], v[48:63]
    ds_read_b128 v[108:111], v3 offset:31744
    s_waitcnt lgkmcnt(3)
    v_mfma_f32_32x32x16_bf16 v[32:47], a[224:227], v[96:99], v[32:47]
    v_mfma_f32_32x32x16_bf16 v[48:63], a[228:231], v[96:99], v[48:63]
    s_waitcnt lgkmcnt(2)
    v_mfma_f32_32x32x16_bf16 v[32:47], a[232:235], v[100:103], v[32:47]
    v_mfma_f32_32x32x16_bf16 v[48:63], a[236:239], v[100:103], v[48:63]
    s_waitcnt lgkmcnt(1)
    v_mfma_f32_32x32x16_bf16 v[32:47], a[240:243], v[104:107], v[32:47]
    v_mfma_f32_32x32x16_bf16 v[48:63], a[244:247], v[104:107], v[48:63]
    s_waitcnt lgkmcnt(0)
    v_mfma_f32_32x32x16_bf16 v[32:47], a[248:251], v[108:111], v[32:47]
    v_mfma_f32_32x32x16_bf16 v[48:63], a[252:255], v[108:111], v[48:63]
    s_add_u32 s15, s15, 1048576
    s_add_u32 s17, s17, 1
    s_branch L_QKV_LOOPK
L_QKV_ENDK:
    s_add_u32 s28, s15, s24
    s_nop 7
    v_cvt_pk_bf16_f32 v112, v64, v65
    v_cvt_pk_bf16_f32 v113, v66, v67
    v_cvt_pk_bf16_f32 v114, v72, v73
    v_cvt_pk_bf16_f32 v115, v74, v75
    buffer_store_dwordx4 v[112:115], v2, s[4:7], s15 offen offset:0 sc1
    v_cvt_pk_bf16_f32 v116, v68, v69
    v_cvt_pk_bf16_f32 v117, v70, v71
    v_cvt_pk_bf16_f32 v118, v76, v77
    v_cvt_pk_bf16_f32 v119, v78, v79
    buffer_store_dwordx4 v[116:119], v2, s[4:7], s15 offen offset:512 sc1
    v_cvt_pk_bf16_f32 v120, v80, v81
    v_cvt_pk_bf16_f32 v121, v82, v83
    v_cvt_pk_bf16_f32 v122, v88, v89
    v_cvt_pk_bf16_f32 v123, v90, v91
    buffer_store_dwordx4 v[120:123], v2, s[4:7], s28 offen offset:0 sc1
    v_cvt_pk_bf16_f32 v124, v84, v85
    v_cvt_pk_bf16_f32 v125, v86, v87
    v_cvt_pk_bf16_f32 v126, v92, v93
    v_cvt_pk_bf16_f32 v127, v94, v95
    buffer_store_dwordx4 v[124:127], v2, s[4:7], s28 offen offset:512 sc1
    s_waitcnt vmcnt(0)
    s_barrier
    v_mov_b32 v6, 16
    buffer_store_dword v6, v5, s[4:7], s23 offen sc1
    s_branch L_QKV_DONE
L_QKV_V:
    s_waitcnt vmcnt(8)
    s_barrier
    s_sub_i32 s20, s17, 1
    s_max_i32 s20, s20, 0
    v_mov_b32 v6, s20
    buffer_store_dword v6, v5, s[4:7], s23 offen sc1
    s_add_u32 s22, s26, s27
    s_mov_b32 m0, s22
    s_add_u32 s22, s22, 1024
    buffer_load_dwordx4 v1, s[4:7], s25 offen lds
    s_add_u32 s25, s25, 1024
    s_mov_b32 m0, s22
    s_add_u32 s22, s22, 1024
    buffer_load_dwordx4 v1, s[4:7], s25 offen lds
    s_add_u32 s25, s25, 1024
    s_mov_b32 m0, s22
    s_add_u32 s22, s22, 1024
    buffer_load_dwordx4 v1, s[4:7], s25 offen lds
    s_add_u32 s25, s25, 1024
    s_mov_b32 m0, s22
    s_add_u32 s22, s22, 1024
    buffer_load_dwordx4 v1, s[4:7], s25 offen lds
    s_add_u32 s25, s25, 1024
    s_mov_b32 m0, s22
    s_add_u32 s22, s22, 1024
    buffer_load_dwordx4 v1, s[4:7], s25 offen lds
    s_add_u32 s25, s25, 1024
    s_mov_b32 m0, s22
    s_add_u32 s22, s22, 1024
    buffer_load_dwordx4 v1, s[4:7], s25 offen lds
    s_add_u32 s25, s25, 1024
    s_mov_b32 m0, s22
    s_add_u32 s22, s22, 1024
    buffer_load_dwordx4 v1, s[4:7], s25 offen lds
    s_add_u32 s25, s25, 1024
    s_mov_b32 m0, s22
    s_add_u32 s22, s22, 1024
    buffer_load_dwordx4 v1, s[4:7], s25 offen lds
    s_add_u32 s25, s25, 1024
    s_add_u32 s25, s25, 122880
    s_add_u32 s27, s27, 32768
    s_cmp_eq_u32 s27, 98304
    s_cselect_b32 s27, 0, s27
    v_add_u32 v3, s29, v1
    s_add_u32 s29, s29, 32768
    s_cmp_eq_u32 s29, 98304
    s_cselect_b32 s29, 0, s29
    ds_read_b128 v[96:99], v3 offset:0
    ds_read_b128 v[100:103], v3 offset:1024
    ds_read_b128 v[104:107], v3 offset:2048
    ds_read_b128 v[108:111], v3 offset:3072
    s_waitcnt lgkmcnt(3)
    v_mfma_f32_32x32x16_bf16 v[32:47], v[96:99], a[0:3], 0
    v_mfma_f32_32x32x16_bf16 v[48:63], v[96:99], a[4:7], 0
    ds_read_b128 v[96:99], v3 offset:4096
    s_waitcnt lgkmcnt(3)
    v_mfma_f32_32x32x16_bf16 v[32:47], v[100:103], a[8:11], v[32:47]
    v_mfma_f32_32x32x16_bf16 v[48:63], v[100:103], a[12:15], v[48:63]
    ds_read_b128 v[100:103], v3 offset:5120
    s_waitcnt lgkmcnt(3)
    v_mfma_f32_32x32x16_bf16 v[32:47], v[104:107], a[16:19], v[32:47]
    v_mfma_f32_32x32x16_bf16 v[48:63], v[104:107], a[20:23], v[48:63]
    ds_read_b128 v[104:107], v3 offset:6144
    s_waitcnt lgkmcnt(3)
    v_mfma_f32_32x32x16_bf16 v[32:47], v[108:111], a[24:27], v[32:47]
    v_mfma_f32_32x32x16_bf16 v[48:63], v[108:111], a[28:31], v[48:63]
    ds_read_b128 v[108:111], v3 offset:7168
    s_waitcnt lgkmcnt(3)
    v_mfma_f32_32x32x16_bf16 v[32:47], v[96:99], a[32:35], v[32:47]
    v_mfma_f32_32x32x16_bf16 v[48:63], v[96:99], a[36:39], v[48:63]
    ds_read_b128 v[96:99], v3 offset:8192
    s_waitcnt lgkmcnt(3)
    v_mfma_f32_32x32x16_bf16 v[32:47], v[100:103], a[40:43], v[32:47]
    v_mfma_f32_32x32x16_bf16 v[48:63], v[100:103], a[44:47], v[48:63]
    ds_read_b128 v[100:103], v3 offset:9216
    s_waitcnt lgkmcnt(3)
    v_mfma_f32_32x32x16_bf16 v[32:47], v[104:107], a[48:51], v[32:47]
    v_mfma_f32_32x32x16_bf16 v[48:63], v[104:107], a[52:55], v[48:63]
    ds_read_b128 v[104:107], v3 offset:10240
    s_waitcnt lgkmcnt(3)
    v_mfma_f32_32x32x16_bf16 v[32:47], v[108:111], a[56:59], v[32:47]
    v_mfma_f32_32x32x16_bf16 v[48:63], v[108:111], a[60:63], v[48:63]
    ds_read_b128 v[108:111], v3 offset:11264
    s_waitcnt lgkmcnt(3)
    v_mfma_f32_32x32x16_bf16 v[32:47], v[96:99], a[64:67], v[32:47]
    v_mfma_f32_32x32x16_bf16 v[48:63], v[96:99], a[68:71], v[48:63]
    ds_read_b128 v[96:99], v3 offset:12288
    s_waitcnt lgkmcnt(3)
    v_mfma_f32_32x32x16_bf16 v[32:47], v[100:103], a[72:75], v[32:47]
    v_mfma_f32_32x32x16_bf16 v[48:63], v[100:103], a[76:79], v[48:63]
    ds_read_b128 v[100:103], v3 offset:13312
    s_waitcnt lgkmcnt(3)
    v_mfma_f32_32x32x16_bf16 v[32:47], v[104:107], a[80:83], v[32:47]
    v_mfma_f32_32x32x16_bf16 v[48:63], v[104:107], a[84:87], v[48:63]
    ds_read_b128 v[104:107], v3 offset:14336
    s_waitcnt lgkmcnt(3)
    v_mfma_f32_32x32x16_bf16 v[32:47], v[108:111], a[88:91], v[32:47]
    v_mfma_f32_32x32x16_bf16 v[48:63], v[108:111], a[92:95], v[48:63]
    ds_read_b128 v[108:111], v3 offset:15360
    s_waitcnt lgkmcnt(3)
    v_mfma_f32_32x32x16_bf16 v[32:47], v[96:99], a[96:99], v[32:47]
    v_mfma_f32_32x32x16_bf16 v[48:63], v[96:99], a[100:103], v[48:63]
    ds_read_b128 v[96:99], v3 offset:16384
    s_waitcnt lgkmcnt(3)
    v_mfma_f32_32x32x16_bf16 v[32:47], v[100:103], a[104:107], v[32:47]
    v_mfma_f32_32x32x16_bf16 v[48:63], v[100:103], a[108:111], v[48:63]
    ds_read_b128 v[100:103], v3 offset:17408
    s_waitcnt lgkmcnt(3)
    v_mfma_f32_32x32x16_bf16 v[32:47], v[104:107], a[112:115], v[32:47]
    v_mfma_f32_32x32x16_bf16 v[48:63], v[104:107], a[116:119], v[48:63]
    ds_read_b128 v[104:107], v3 offset:18432
    s_waitcnt lgkmcnt(3)
    v_mfma_f32_32x32x16_bf16 v[32:47], v[108:111], a[120:123], v[32:47]
    v_mfma_f32_32x32x16_bf16 v[48:63], v[108:111], a[124:127], v[48:63]
    ds_read_b128 v[108:111], v3 offset:19456
    s_waitcnt lgkmcnt(3)
    v_mfma_f32_32x32x16_bf16 v[32:47], v[96:99], a[128:131], v[32:47]
    v_mfma_f32_32x32x16_bf16 v[48:63], v[96:99], a[132:135], v[48:63]
    ds_read_b128 v[96:99], v3 offset:20480
    s_waitcnt lgkmcnt(3)
    v_mfma_f32_32x32x16_bf16 v[32:47], v[100:103], a[136:139], v[32:47]
    v_mfma_f32_32x32x16_bf16 v[48:63], v[100:103], a[140:143], v[48:63]
    ds_read_b128 v[100:103], v3 offset:21504
    s_waitcnt lgkmcnt(3)
    v_mfma_f32_32x32x16_bf16 v[32:47], v[104:107], a[144:147], v[32:47]
    v_mfma_f32_32x32x16_bf16 v[48:63], v[104:107], a[148:151], v[48:63]
    ds_read_b128 v[104:107], v3 offset:22528
    s_waitcnt lgkmcnt(3)
    v_mfma_f32_32x32x16_bf16 v[32:47], v[108:111], a[152:155], v[32:47]
    v_mfma_f32_32x32x16_bf16 v[48:63], v[108:111], a[156:159], v[48:63]
    ds_read_b128 v[108:111], v3 offset:23552
    s_waitcnt lgkmcnt(3)
    v_mfma_f32_32x32x16_bf16 v[32:47], v[96:99], a[160:163], v[32:47]
    v_mfma_f32_32x32x16_bf16 v[48:63], v[96:99], a[164:167], v[48:63]
    ds_read_b128 v[96:99], v3 offset:24576
    s_waitcnt lgkmcnt(3)
    v_mfma_f32_32x32x16_bf16 v[32:47], v[100:103], a[168:171], v[32:47]
    v_mfma_f32_32x32x16_bf16 v[48:63], v[100:103], a[172:175], v[48:63]
    ds_read_b128 v[100:103], v3 offset:25600
    s_waitcnt lgkmcnt(3)
    v_mfma_f32_32x32x16_bf16 v[32:47], v[104:107], a[176:179], v[32:47]
    v_mfma_f32_32x32x16_bf16 v[48:63], v[104:107], a[180:183], v[48:63]
    ds_read_b128 v[104:107], v3 offset:26624
    s_waitcnt lgkmcnt(3)
    v_mfma_f32_32x32x16_bf16 v[32:47], v[108:111], a[184:187], v[32:47]
    v_mfma_f32_32x32x16_bf16 v[48:63], v[108:111], a[188:191], v[48:63]
    ds_read_b128 v[108:111], v3 offset:27648
    s_waitcnt lgkmcnt(3)
    v_mfma_f32_32x32x16_bf16 v[32:47], v[96:99], a[192:195], v[32:47]
    v_mfma_f32_32x32x16_bf16 v[48:63], v[96:99], a[196:199], v[48:63]
    ds_read_b128 v[96:99], v3 offset:28672
    s_waitcnt lgkmcnt(3)
    v_mfma_f32_32x32x16_bf16 v[32:47], v[100:103], a[200:203], v[32:47]
    v_mfma_f32_32x32x16_bf16 v[48:63], v[100:103], a[204:207], v[48:63]
    ds_read_b128 v[100:103], v3 offset:29696
    s_waitcnt lgkmcnt(3)
    v_mfma_f32_32x32x16_bf16 v[32:47], v[104:107], a[208:211], v[32:47]
    v_mfma_f32_32x32x16_bf16 v[48:63], v[104:107], a[212:215], v[48:63]
    ds_read_b128 v[104:107], v3 offset:30720
    s_waitcnt lgkmcnt(3)
    v_mfma_f32_32x32x16_bf16 v[32:47], v[108:111], a[216:219], v[32:47]
    v_mfma_f32_32x32x16_bf16 v[48:63], v[108:111], a[220:223], v[48:63]
    ds_read_b128 v[108:111], v3 offset:31744
    s_waitcnt lgkmcnt(3)
    v_mfma_f32_32x32x16_bf16 v[32:47], v[96:99], a[224:227], v[32:47]
    v_mfma_f32_32x32x16_bf16 v[48:63], v[96:99], a[228:231], v[48:63]
    s_waitcnt lgkmcnt(2)
    v_mfma_f32_32x32x16_bf16 v[32:47], v[100:103], a[232:235], v[32:47]
    v_mfma_f32_32x32x16_bf16 v[48:63], v[100:103], a[236:239], v[48:63]
    s_waitcnt lgkmcnt(1)
    v_mfma_f32_32x32x16_bf16 v[32:47], v[104:107], a[240:243], v[32:47]
    v_mfma_f32_32x32x16_bf16 v[48:63], v[104:107], a[244:247], v[48:63]
    s_waitcnt lgkmcnt(0)
    v_mfma_f32_32x32x16_bf16 v[32:47], v[108:111], a[248:251], v[32:47]
    v_mfma_f32_32x32x16_bf16 v[48:63], v[108:111], a[252:255], v[48:63]
    s_add_u32 s17, s17, 1
    s_waitcnt vmcnt(8)
    s_barrier
    s_sub_i32 s20, s17, 1
    s_max_i32 s20, s20, 0
    v_mov_b32 v6, s20
    buffer_store_dword v6, v5, s[4:7], s23 offen sc1
    s_add_u32 s22, s26, s27
    s_mov_b32 m0, s22
    s_add_u32 s22, s22, 1024
    buffer_load_dwordx4 v1, s[4:7], s25 offen lds
    s_add_u32 s25, s25, 1024
    s_mov_b32 m0, s22
    s_add_u32 s22, s22, 1024
    buffer_load_dwordx4 v1, s[4:7], s25 offen lds
    s_add_u32 s25, s25, 1024
    s_mov_b32 m0, s22
    s_add_u32 s22, s22, 1024
    buffer_load_dwordx4 v1, s[4:7], s25 offen lds
    s_add_u32 s25, s25, 1024
    s_mov_b32 m0, s22
    s_add_u32 s22, s22, 1024
    buffer_load_dwordx4 v1, s[4:7], s25 offen lds
    s_add_u32 s25, s25, 1024
    s_mov_b32 m0, s22
    s_add_u32 s22, s22, 1024
    buffer_load_dwordx4 v1, s[4:7], s25 offen lds
    s_add_u32 s25, s25, 1024
    s_mov_b32 m0, s22
    s_add_u32 s22, s22, 1024
    buffer_load_dwordx4 v1, s[4:7], s25 offen lds
    s_add_u32 s25, s25, 1024
    s_mov_b32 m0, s22
    s_add_u32 s22, s22, 1024
    buffer_load_dwordx4 v1, s[4:7], s25 offen lds
    s_add_u32 s25, s25, 1024
    s_mov_b32 m0, s22
    s_add_u32 s22, s22, 1024
    buffer_load_dwordx4 v1, s[4:7], s25 offen lds
    s_add_u32 s25, s25, 1024
    s_add_u32 s25, s25, 122880
    s_add_u32 s27, s27, 32768
    s_cmp_eq_u32 s27, 98304
    s_cselect_b32 s27, 0, s27
    v_add_u32 v3, s29, v1
    s_add_u32 s29, s29, 32768
    s_cmp_eq_u32 s29, 98304
    s_cselect_b32 s29, 0, s29
    s_add_u32 s28, s15, s24
    ds_read_b128 v[96:99], v3 offset:0
    ds_read_b128 v[100:103], v3 offset:1024
    ds_read_b128 v[104:107], v3 offset:2048
    ds_read_b128 v[108:111], v3 offset:3072
    s_waitcnt lgkmcnt(3)
    v_mfma_f32_32x32x16_bf16 v[64:79], v[96:99], a[0:3], 0
    v_mfma_f32_32x32x16_bf16 v[80:95], v[96:99], a[4:7], 0
    ds_read_b128 v[96:99], v3 offset:4096
    s_waitcnt lgkmcnt(3)
    v_mfma_f32_32x32x16_bf16 v[64:79], v[100:103], a[8:11], v[64:79]
    v_cvt_pk_bf16_f32 v112, v32, v33
    v_cvt_pk_bf16_f32 v113, v34, v35
    v_mfma_f32_32x32x16_bf16 v[80:95], v[100:103], a[12:15], v[80:95]
    v_cvt_pk_bf16_f32 v114, v40, v41
    v_cvt_pk_bf16_f32 v115, v42, v43
    ds_read_b128 v[100:103], v3 offset:5120
    s_waitcnt lgkmcnt(3)
    v_mfma_f32_32x32x16_bf16 v[64:79], v[104:107], a[16:19], v[64:79]
    buffer_store_dwordx4 v[112:115], v2, s[4:7], s15 offen offset:0 sc1
    v_cvt_pk_bf16_f32 v116, v36, v37
    v_mfma_f32_32x32x16_bf16 v[80:95], v[104:107], a[20:23], v[80:95]
    v_cvt_pk_bf16_f32 v117, v38, v39
    v_cvt_pk_bf16_f32 v118, v44, v45
    ds_read_b128 v[104:107], v3 offset:6144
    s_waitcnt lgkmcnt(3)
    v_mfma_f32_32x32x16_bf16 v[64:79], v[108:111], a[24:27], v[64:79]
    v_cvt_pk_bf16_f32 v119, v46, v47
    buffer_store_dwordx4 v[116:119], v2, s[4:7], s15 offen offset:512 sc1
    v_mfma_f32_32x32x16_bf16 v[80:95], v[108:111], a[28:31], v[80:95]
    v_cvt_pk_bf16_f32 v120, v48, v49
    v_cvt_pk_bf16_f32 v121, v50, v51
    ds_read_b128 v[108:111], v3 offset:7168
    s_waitcnt lgkmcnt(3)
    v_mfma_f32_32x32x16_bf16 v[64:79], v[96:99], a[32:35], v[64:79]
    v_cvt_pk_bf16_f32 v122, v56, v57
    v_cvt_pk_bf16_f32 v123, v58, v59
    v_mfma_f32_32x32x16_bf16 v[80:95], v[96:99], a[36:39], v[80:95]
    buffer_store_dwordx4 v[120:123], v2, s[4:7], s28 offen offset:0 sc1
    v_cvt_pk_bf16_f32 v124, v52, v53
    ds_read_b128 v[96:99], v3 offset:8192
    s_waitcnt lgkmcnt(3)
    v_mfma_f32_32x32x16_bf16 v[64:79], v[100:103], a[40:43], v[64:79]
    v_cvt_pk_bf16_f32 v125, v54, v55
    v_cvt_pk_bf16_f32 v126, v60, v61
    v_mfma_f32_32x32x16_bf16 v[80:95], v[100:103], a[44:47], v[80:95]
    v_cvt_pk_bf16_f32 v127, v62, v63
    buffer_store_dwordx4 v[124:127], v2, s[4:7], s28 offen offset:512 sc1
    ds_read_b128 v[100:103], v3 offset:9216
    s_waitcnt lgkmcnt(3)
    v_mfma_f32_32x32x16_bf16 v[64:79], v[104:107], a[48:51], v[64:79]
    v_mfma_f32_32x32x16_bf16 v[80:95], v[104:107], a[52:55], v[80:95]
    ds_read_b128 v[104:107], v3 offset:10240
    s_waitcnt lgkmcnt(3)
    v_mfma_f32_32x32x16_bf16 v[64:79], v[108:111], a[56:59], v[64:79]
    v_mfma_f32_32x32x16_bf16 v[80:95], v[108:111], a[60:63], v[80:95]
    ds_read_b128 v[108:111], v3 offset:11264
    s_waitcnt lgkmcnt(3)
    v_mfma_f32_32x32x16_bf16 v[64:79], v[96:99], a[64:67], v[64:79]
    v_mfma_f32_32x32x16_bf16 v[80:95], v[96:99], a[68:71], v[80:95]
    ds_read_b128 v[96:99], v3 offset:12288
    s_waitcnt lgkmcnt(3)
    v_mfma_f32_32x32x16_bf16 v[64:79], v[100:103], a[72:75], v[64:79]
    v_mfma_f32_32x32x16_bf16 v[80:95], v[100:103], a[76:79], v[80:95]
    ds_read_b128 v[100:103], v3 offset:13312
    s_waitcnt lgkmcnt(3)
    v_mfma_f32_32x32x16_bf16 v[64:79], v[104:107], a[80:83], v[64:79]
    v_mfma_f32_32x32x16_bf16 v[80:95], v[104:107], a[84:87], v[80:95]
    ds_read_b128 v[104:107], v3 offset:14336
    s_waitcnt lgkmcnt(3)
    v_mfma_f32_32x32x16_bf16 v[64:79], v[108:111], a[88:91], v[64:79]
    v_mfma_f32_32x32x16_bf16 v[80:95], v[108:111], a[92:95], v[80:95]
    ds_read_b128 v[108:111], v3 offset:15360
    s_waitcnt lgkmcnt(3)
    v_mfma_f32_32x32x16_bf16 v[64:79], v[96:99], a[96:99], v[64:79]
    v_mfma_f32_32x32x16_bf16 v[80:95], v[96:99], a[100:103], v[80:95]
    ds_read_b128 v[96:99], v3 offset:16384
    s_waitcnt lgkmcnt(3)
    v_mfma_f32_32x32x16_bf16 v[64:79], v[100:103], a[104:107], v[64:79]
    v_mfma_f32_32x32x16_bf16 v[80:95], v[100:103], a[108:111], v[80:95]
    ds_read_b128 v[100:103], v3 offset:17408
    s_waitcnt lgkmcnt(3)
    v_mfma_f32_32x32x16_bf16 v[64:79], v[104:107], a[112:115], v[64:79]
    v_mfma_f32_32x32x16_bf16 v[80:95], v[104:107], a[116:119], v[80:95]
    ds_read_b128 v[104:107], v3 offset:18432
    s_waitcnt lgkmcnt(3)
    v_mfma_f32_32x32x16_bf16 v[64:79], v[108:111], a[120:123], v[64:79]
    v_mfma_f32_32x32x16_bf16 v[80:95], v[108:111], a[124:127], v[80:95]
    ds_read_b128 v[108:111], v3 offset:19456
    s_waitcnt lgkmcnt(3)
    v_mfma_f32_32x32x16_bf16 v[64:79], v[96:99], a[128:131], v[64:79]
    v_mfma_f32_32x32x16_bf16 v[80:95], v[96:99], a[132:135], v[80:95]
    ds_read_b128 v[96:99], v3 offset:20480
    s_waitcnt lgkmcnt(3)
    v_mfma_f32_32x32x16_bf16 v[64:79], v[100:103], a[136:139], v[64:79]
    v_mfma_f32_32x32x16_bf16 v[80:95], v[100:103], a[140:143], v[80:95]
    ds_read_b128 v[100:103], v3 offset:21504
    s_waitcnt lgkmcnt(3)
    v_mfma_f32_32x32x16_bf16 v[64:79], v[104:107], a[144:147], v[64:79]
    v_mfma_f32_32x32x16_bf16 v[80:95], v[104:107], a[148:151], v[80:95]
    ds_read_b128 v[104:107], v3 offset:22528
    s_waitcnt lgkmcnt(3)
    v_mfma_f32_32x32x16_bf16 v[64:79], v[108:111], a[152:155], v[64:79]
    v_mfma_f32_32x32x16_bf16 v[80:95], v[108:111], a[156:159], v[80:95]
    ds_read_b128 v[108:111], v3 offset:23552
    s_waitcnt lgkmcnt(3)
    v_mfma_f32_32x32x16_bf16 v[64:79], v[96:99], a[160:163], v[64:79]
    v_mfma_f32_32x32x16_bf16 v[80:95], v[96:99], a[164:167], v[80:95]
    ds_read_b128 v[96:99], v3 offset:24576
    s_waitcnt lgkmcnt(3)
    v_mfma_f32_32x32x16_bf16 v[64:79], v[100:103], a[168:171], v[64:79]
    v_mfma_f32_32x32x16_bf16 v[80:95], v[100:103], a[172:175], v[80:95]
    ds_read_b128 v[100:103], v3 offset:25600
    s_waitcnt lgkmcnt(3)
    v_mfma_f32_32x32x16_bf16 v[64:79], v[104:107], a[176:179], v[64:79]
    v_mfma_f32_32x32x16_bf16 v[80:95], v[104:107], a[180:183], v[80:95]
    ds_read_b128 v[104:107], v3 offset:26624
    s_waitcnt lgkmcnt(3)
    v_mfma_f32_32x32x16_bf16 v[64:79], v[108:111], a[184:187], v[64:79]
    v_mfma_f32_32x32x16_bf16 v[80:95], v[108:111], a[188:191], v[80:95]
    ds_read_b128 v[108:111], v3 offset:27648
    s_waitcnt lgkmcnt(3)
    v_mfma_f32_32x32x16_bf16 v[64:79], v[96:99], a[192:195], v[64:79]
    v_mfma_f32_32x32x16_bf16 v[80:95], v[96:99], a[196:199], v[80:95]
    ds_read_b128 v[96:99], v3 offset:28672
    s_waitcnt lgkmcnt(3)
    v_mfma_f32_32x32x16_bf16 v[64:79], v[100:103], a[200:203], v[64:79]
    v_mfma_f32_32x32x16_bf16 v[80:95], v[100:103], a[204:207], v[80:95]
    ds_read_b128 v[100:103], v3 offset:29696
    s_waitcnt lgkmcnt(3)
    v_mfma_f32_32x32x16_bf16 v[64:79], v[104:107], a[208:211], v[64:79]
    v_mfma_f32_32x32x16_bf16 v[80:95], v[104:107], a[212:215], v[80:95]
    ds_read_b128 v[104:107], v3 offset:30720
    s_waitcnt lgkmcnt(3)
    v_mfma_f32_32x32x16_bf16 v[64:79], v[108:111], a[216:219], v[64:79]
    v_mfma_f32_32x32x16_bf16 v[80:95], v[108:111], a[220:223], v[80:95]
    ds_read_b128 v[108:111], v3 offset:31744
    s_waitcnt lgkmcnt(3)
    v_mfma_f32_32x32x16_bf16 v[64:79], v[96:99], a[224:227], v[64:79]
    v_mfma_f32_32x32x16_bf16 v[80:95], v[96:99], a[228:231], v[80:95]
    s_waitcnt lgkmcnt(2)
    v_mfma_f32_32x32x16_bf16 v[64:79], v[100:103], a[232:235], v[64:79]
    v_mfma_f32_32x32x16_bf16 v[80:95], v[100:103], a[236:239], v[80:95]
    s_waitcnt lgkmcnt(1)
    v_mfma_f32_32x32x16_bf16 v[64:79], v[104:107], a[240:243], v[64:79]
    v_mfma_f32_32x32x16_bf16 v[80:95], v[104:107], a[244:247], v[80:95]
    s_waitcnt lgkmcnt(0)
    v_mfma_f32_32x32x16_bf16 v[64:79], v[108:111], a[248:251], v[64:79]
    v_mfma_f32_32x32x16_bf16 v[80:95], v[108:111], a[252:255], v[80:95]
    s_add_u32 s15, s15, 1048576
    s_add_u32 s17, s17, 1
    s_waitcnt vmcnt(0)
    s_barrier
    s_cmp_eq_u32 s17, 6
    s_cbranch_scc0 L_QKV_NOBV4
    s_load_dwordx2 s[96:97], s[0:1], 96
    v_mov_b32 v6, 200
    s_mov_b32 s94, 0
    s_waitcnt lgkmcnt(0)
L_WDQLBV4:
    global_load_dword v7, v6, s[96:97] sc1
    s_waitcnt vmcnt(0)
    v_readfirstlane_b32 s95, v7
    s_add_u32 s94, s94, 1
    s_cmp_gt_u32 s94, 2000000
    s_cbranch_scc1 L_GBAIL
    s_cmp_ge_u32 s95, 32
    s_cbranch_scc1 L_WDOKQLBV4
    s_sleep 4
    s_branch L_WDQLBV4
L_WDOKQLBV4:
L_QKV_NOBV4:
    s_sub_i32 s20, s17, 1
    s_max_i32 s20, s20, 0
    v_mov_b32 v6, s20
    buffer_store_dword v6, v5, s[4:7], s23 offen sc1
    s_add_u32 s22, s26, s27
    s_mov_b32 m0, s22
    s_add_u32 s22, s22, 1024
    buffer_load_dwordx4 v1, s[4:7], s25 offen lds
    s_add_u32 s25, s25, 1024
    s_mov_b32 m0, s22
    s_add_u32 s22, s22, 1024
    buffer_load_dwordx4 v1, s[4:7], s25 offen lds
    s_add_u32 s25, s25, 1024
    s_mov_b32 m0, s22
    s_add_u32 s22, s22, 1024
    buffer_load_dwordx4 v1, s[4:7], s25 offen lds
    s_add_u32 s25, s25, 1024
    s_mov_b32 m0, s22
    s_add_u32 s22, s22, 1024
    buffer_load_dwordx4 v1, s[4:7], s25 offen lds
    s_add_u32 s25, s25, 1024
    s_mov_b32 m0, s22
    s_add_u32 s22, s22, 1024
    buffer_load_dwordx4 v1, s[4:7], s25 offen lds
    s_add_u32 s25, s25, 1024
    s_mov_b32 m0, s22
    s_add_u32 s22, s22, 1024
    buffer_load_dwordx4 v1, s[4:7], s25 offen lds
    s_add_u32 s25, s25, 1024
    s_mov_b32 m0, s22
    s_add_u32 s22, s22, 1024
    buffer_load_dwordx4 v1, s[4:7], s25 offen lds
    s_add_u32 s25, s25, 1024
    s_mov_b32 m0, s22
    s_add_u32 s22, s22, 1024
    buffer_load_dwordx4 v1, s[4:7], s25 offen lds
    s_add_u32 s25, s25, 1024
    s_add_u32 s25, s25, 122880
    s_add_u32 s27, s27, 32768
    s_cmp_eq_u32 s27, 98304
    s_cselect_b32 s27, 0, s27
    v_add_u32 v3, s29, v1
    s_add_u32 s29, s29, 32768
    s_cmp_eq_u32 s29, 98304
    s_cselect_b32 s29, 0, s29
    s_add_u32 s28, s15, s24
    ds_read_b128 v[96:99], v3 offset:0
    ds_read_b128 v[100:103], v3 offset:1024
    ds_read_b128 v[104:107], v3 offset:2048
    ds_read_b128 v[108:111], v3 offset:3072
    s_waitcnt lgkmcnt(3)
    v_mfma_f32_32x32x16_bf16 v[32:47], v[96:99], a[0:3], 0
    v_mfma_f32_32x32x16_bf16 v[48:63], v[96:99], a[4:7], 0
    ds_read_b128 v[96:99], v3 offset:4096
    s_waitcnt lgkmcnt(3)
    v_mfma_f32_32x32x16_bf16 v[32:47], v[100:103], a[8:11], v[32:47]
    v_cvt_pk_bf16_f32 v112, v64, v65
    v_cvt_pk_bf16_f32 v113, v66, v67
    v_mfma_f32_32x32x16_bf16 v[48:63], v[100:103], a[12:15], v[48:63]
    v_cvt_pk_bf16_f32 v114, v72, v73
    v_cvt_pk_bf16_f32 v115, v74, v75
    ds_read_b128 v[100:103], v3 offset:5120
    s_waitcnt lgkmcnt(3)
    v_mfma_f32_32x32x16_bf16 v[32:47], v[104:107], a[16:19], v[32:47]
    buffer_store_dwordx4 v[112:115], v2, s[4:7], s15 offen offset:0 sc1
    v_cvt_pk_bf16_f32 v116, v68, v69
    v_mfma_f32_32x32x16_bf16 v[48:63], v[104:107], a[20:23], v[48:63]
    v_cvt_pk_bf16_f32 v117, v70, v71
    v_cvt_pk_bf16_f32 v118, v76, v77
    ds_read_b128 v[104:107], v3 offset:6144
    s_waitcnt lgkmcnt(3)
    v_mfma_f32_32x32x16_bf16 v[32:47], v[108:111], a[24:27], v[32:47]
    v_cvt_pk_bf16_f32 v119, v78, v79
    buffer_store_dwordx4 v[116:119], v2, s[4:7], s15 offen offset:512 sc1
    v_mfma_f32_32x32x16_bf16 v[48:63], v[108:111], a[28:31], v[48:63]
    v_cvt_pk_bf16_f32 v120, v80, v81
    v_cvt_pk_bf16_f32 v121, v82, v83
    ds_read_b128 v[108:111], v3 offset:7168
    s_waitcnt lgkmcnt(3)
    v_mfma_f32_32x32x16_bf16 v[32:47], v[96:99], a[32:35], v[32:47]
    v_cvt_pk_bf16_f32 v122, v88, v89
    v_cvt_pk_bf16_f32 v123, v90, v91
    v_mfma_f32_32x32x16_bf16 v[48:63], v[96:99], a[36:39], v[48:63]
    buffer_store_dwordx4 v[120:123], v2, s[4:7], s28 offen offset:0 sc1
    v_cvt_pk_bf16_f32 v124, v84, v85
    ds_read_b128 v[96:99], v3 offset:8192
    s_waitcnt lgkmcnt(3)
    v_mfma_f32_32x32x16_bf16 v[32:47], v[100:103], a[40:43], v[32:47]
    v_cvt_pk_bf16_f32 v125, v86, v87
    v_cvt_pk_bf16_f32 v126, v92, v93
    v_mfma_f32_32x32x16_bf16 v[48:63], v[100:103], a[44:47], v[48:63]
    v_cvt_pk_bf16_f32 v127, v94, v95
    buffer_store_dwordx4 v[124:127], v2, s[4:7], s28 offen offset:512 sc1
    ds_read_b128 v[100:103], v3 offset:9216
    s_waitcnt lgkmcnt(3)
    v_mfma_f32_32x32x16_bf16 v[32:47], v[104:107], a[48:51], v[32:47]
    v_mfma_f32_32x32x16_bf16 v[48:63], v[104:107], a[52:55], v[48:63]
    ds_read_b128 v[104:107], v3 offset:10240
    s_waitcnt lgkmcnt(3)
    v_mfma_f32_32x32x16_bf16 v[32:47], v[108:111], a[56:59], v[32:47]
    v_mfma_f32_32x32x16_bf16 v[48:63], v[108:111], a[60:63], v[48:63]
    ds_read_b128 v[108:111], v3 offset:11264
    s_waitcnt lgkmcnt(3)
    v_mfma_f32_32x32x16_bf16 v[32:47], v[96:99], a[64:67], v[32:47]
    v_mfma_f32_32x32x16_bf16 v[48:63], v[96:99], a[68:71], v[48:63]
    ds_read_b128 v[96:99], v3 offset:12288
    s_waitcnt lgkmcnt(3)
    v_mfma_f32_32x32x16_bf16 v[32:47], v[100:103], a[72:75], v[32:47]
    v_mfma_f32_32x32x16_bf16 v[48:63], v[100:103], a[76:79], v[48:63]
    ds_read_b128 v[100:103], v3 offset:13312
    s_waitcnt lgkmcnt(3)
    v_mfma_f32_32x32x16_bf16 v[32:47], v[104:107], a[80:83], v[32:47]
    v_mfma_f32_32x32x16_bf16 v[48:63], v[104:107], a[84:87], v[48:63]
    ds_read_b128 v[104:107], v3 offset:14336
    s_waitcnt lgkmcnt(3)
    v_mfma_f32_32x32x16_bf16 v[32:47], v[108:111], a[88:91], v[32:47]
    v_mfma_f32_32x32x16_bf16 v[48:63], v[108:111], a[92:95], v[48:63]
    ds_read_b128 v[108:111], v3 offset:15360
    s_waitcnt lgkmcnt(3)
    v_mfma_f32_32x32x16_bf16 v[32:47], v[96:99], a[96:99], v[32:47]
    v_mfma_f32_32x32x16_bf16 v[48:63], v[96:99], a[100:103], v[48:63]
    ds_read_b128 v[96:99], v3 offset:16384
    s_waitcnt lgkmcnt(3)
    v_mfma_f32_32x32x16_bf16 v[32:47], v[100:103], a[104:107], v[32:47]
    v_mfma_f32_32x32x16_bf16 v[48:63], v[100:103], a[108:111], v[48:63]
    ds_read_b128 v[100:103], v3 offset:17408
    s_waitcnt lgkmcnt(3)
    v_mfma_f32_32x32x16_bf16 v[32:47], v[104:107], a[112:115], v[32:47]
    v_mfma_f32_32x32x16_bf16 v[48:63], v[104:107], a[116:119], v[48:63]
    ds_read_b128 v[104:107], v3 offset:18432
    s_waitcnt lgkmcnt(3)
    v_mfma_f32_32x32x16_bf16 v[32:47], v[108:111], a[120:123], v[32:47]
    v_mfma_f32_32x32x16_bf16 v[48:63], v[108:111], a[124:127], v[48:63]
    ds_read_b128 v[108:111], v3 offset:19456
    s_waitcnt lgkmcnt(3)
    v_mfma_f32_32x32x16_bf16 v[32:47], v[96:99], a[128:131], v[32:47]
    v_mfma_f32_32x32x16_bf16 v[48:63], v[96:99], a[132:135], v[48:63]
    ds_read_b128 v[96:99], v3 offset:20480
    s_waitcnt lgkmcnt(3)
    v_mfma_f32_32x32x16_bf16 v[32:47], v[100:103], a[136:139], v[32:47]
    v_mfma_f32_32x32x16_bf16 v[48:63], v[100:103], a[140:143], v[48:63]
    ds_read_b128 v[100:103], v3 offset:21504
    s_waitcnt lgkmcnt(3)
    v_mfma_f32_32x32x16_bf16 v[32:47], v[104:107], a[144:147], v[32:47]
    v_mfma_f32_32x32x16_bf16 v[48:63], v[104:107], a[148:151], v[48:63]
    ds_read_b128 v[104:107], v3 offset:22528
    s_waitcnt lgkmcnt(3)
    v_mfma_f32_32x32x16_bf16 v[32:47], v[108:111], a[152:155], v[32:47]
    v_mfma_f32_32x32x16_bf16 v[48:63], v[108:111], a[156:159], v[48:63]
    ds_read_b128 v[108:111], v3 offset:23552
    s_waitcnt lgkmcnt(3)
    v_mfma_f32_32x32x16_bf16 v[32:47], v[96:99], a[160:163], v[32:47]
    v_mfma_f32_32x32x16_bf16 v[48:63], v[96:99], a[164:167], v[48:63]
    ds_read_b128 v[96:99], v3 offset:24576
    s_waitcnt lgkmcnt(3)
    v_mfma_f32_32x32x16_bf16 v[32:47], v[100:103], a[168:171], v[32:47]
    v_mfma_f32_32x32x16_bf16 v[48:63], v[100:103], a[172:175], v[48:63]
    ds_read_b128 v[100:103], v3 offset:25600
    s_waitcnt lgkmcnt(3)
    v_mfma_f32_32x32x16_bf16 v[32:47], v[104:107], a[176:179], v[32:47]
    v_mfma_f32_32x32x16_bf16 v[48:63], v[104:107], a[180:183], v[48:63]
    ds_read_b128 v[104:107], v3 offset:26624
    s_waitcnt lgkmcnt(3)
    v_mfma_f32_32x32x16_bf16 v[32:47], v[108:111], a[184:187], v[32:47]
    v_mfma_f32_32x32x16_bf16 v[48:63], v[108:111], a[188:191], v[48:63]
    ds_read_b128 v[108:111], v3 offset:27648
    s_waitcnt lgkmcnt(3)
    v_mfma_f32_32x32x16_bf16 v[32:47], v[96:99], a[192:195], v[32:47]
    v_mfma_f32_32x32x16_bf16 v[48:63], v[96:99], a[196:199], v[48:63]
    ds_read_b128 v[96:99], v3 offset:28672
    s_waitcnt lgkmcnt(3)
    v_mfma_f32_32x32x16_bf16 v[32:47], v[100:103], a[200:203], v[32:47]
    v_mfma_f32_32x32x16_bf16 v[48:63], v[100:103], a[204:207], v[48:63]
    ds_read_b128 v[100:103], v3 offset:29696
    s_waitcnt lgkmcnt(3)
    v_mfma_f32_32x32x16_bf16 v[32:47], v[104:107], a[208:211], v[32:47]
    v_mfma_f32_32x32x16_bf16 v[48:63], v[104:107], a[212:215], v[48:63]
    ds_read_b128 v[104:107], v3 offset:30720
    s_waitcnt lgkmcnt(3)
    v_mfma_f32_32x32x16_bf16 v[32:47], v[108:111], a[216:219], v[32:47]
    v_mfma_f32_32x32x16_bf16 v[48:63], v[108:111], a[220:223], v[48:63]
    ds_read_b128 v[108:111], v3 offset:31744
    s_waitcnt lgkmcnt(3)
    v_mfma_f32_32x32x16_bf16 v[32:47], v[96:99], a[224:227], v[32:47]
    v_mfma_f32_32x32x16_bf16 v[48:63], v[96:99], a[228:231], v[48:63]
    s_waitcnt lgkmcnt(2)
    v_mfma_f32_32x32x16_bf16 v[32:47], v[100:103], a[232:235], v[32:47]
    v_mfma_f32_32x32x16_bf16 v[48:63], v[100:103], a[236:239], v[48:63]
    s_waitcnt lgkmcnt(1)
    v_mfma_f32_32x32x16_bf16 v[32:47], v[104:107], a[240:243], v[32:47]
    v_mfma_f32_32x32x16_bf16 v[48:63], v[104:107], a[244:247], v[48:63]
    s_waitcnt lgkmcnt(0)
    v_mfma_f32_32x32x16_bf16 v[32:47], v[108:111], a[248:251], v[32:47]
    v_mfma_f32_32x32x16_bf16 v[48:63], v[108:111], a[252:255], v[48:63]
    s_add_u32 s15, s15, 1048576
    s_add_u32 s17, s17, 1
L_QKV_LOOPV:
    s_waitcnt vmcnt(0)
    s_barrier
    s_cmp_eq_u32 s17, 6
    s_cbranch_scc0 L_QKV_NOBV5
    s_load_dwordx2 s[96:97], s[0:1], 96
    v_mov_b32 v6, 200
    s_mov_b32 s94, 0
    s_waitcnt lgkmcnt(0)
L_WDQLBV5:
    global_load_dword v7, v6, s[96:97] sc1
    s_waitcnt vmcnt(0)
    v_readfirstlane_b32 s95, v7
    s_add_u32 s94, s94, 1
    s_cmp_gt_u32 s94, 2000000
    s_cbranch_scc1 L_GBAIL
    s_cmp_ge_u32 s95, 32
    s_cbranch_scc1 L_WDOKQLBV5
    s_sleep 4
    s_branch L_WDQLBV5
L_WDOKQLBV5:
L_QKV_NOBV5:
    s_sub_i32 s20, s17, 1
    s_max_i32 s20, s20, 0
    v_mov_b32 v6, s20
    buffer_store_dword v6, v5, s[4:7], s23 offen sc1
    s_add_u32 s22, s26, s27
    s_mov_b32 m0, s22
    s_add_u32 s22, s22, 1024
    buffer_load_dwordx4 v1, s[4:7], s25 offen lds
    s_add_u32 s25, s25, 1024
    s_mov_b32 m0, s22
    s_add_u32 s22, s22, 1024
    buffer_load_dwordx4 v1, s[4:7], s25 offen lds
    s_add_u32 s25, s25, 1024
    s_mov_b32 m0, s22
    s_add_u32 s22, s22, 1024
    buffer_load_dwordx4 v1, s[4:7], s25 offen lds
    s_add_u32 s25, s25, 1024
    s_mov_b32 m0, s22
    s_add_u32 s22, s22, 1024
    buffer_load_dwordx4 v1, s[4:7], s25 offen lds
    s_add_u32 s25, s25, 1024
    s_mov_b32 m0, s22
    s_add_u32 s22, s22, 1024
    buffer_load_dwordx4 v1, s[4:7], s25 offen lds
    s_add_u32 s25, s25, 1024
    s_mov_b32 m0, s22
    s_add_u32 s22, s22, 1024
    buffer_load_dwordx4 v1, s[4:7], s25 offen lds
    s_add_u32 s25, s25, 1024
    s_mov_b32 m0, s22
    s_add_u32 s22, s22, 1024
    buffer_load_dwordx4 v1, s[4:7], s25 offen lds
    s_add_u32 s25, s25, 1024
    s_mov_b32 m0, s22
    s_add_u32 s22, s22, 1024
    buffer_load_dwordx4 v1, s[4:7], s25 offen lds
    s_add_u32 s25, s25, 1024
    s_add_u32 s25, s25, 122880
    s_add_u32 s27, s27, 32768
    s_cmp_eq_u32 s27, 98304
    s_cselect_b32 s27, 0, s27
    v_add_u32 v3, s29, v1
    s_add_u32 s29, s29, 32768
    s_cmp_eq_u32 s29, 98304
    s_cselect_b32 s29, 0, s29
    s_add_u32 s28, s15, s24
    ds_read_b128 v[96:99], v3 offset:0
    ds_read_b128 v[100:103], v3 offset:1024
    ds_read_b128 v[104:107], v3 offset:2048
    ds_read_b128 v[108:111], v3 offset:3072
    s_waitcnt lgkmcnt(3)
    v_mfma_f32_32x32x16_bf16 v[64:79], v[96:99], a[0:3], 0
    v_mfma_f32_32x32x16_bf16 v[80:95], v[96:99], a[4:7], 0
    ds_read_b128 v[96:99], v3 offset:4096
    s_waitcnt lgkmcnt(3)
    v_mfma_f32_32x32x16_bf16 v[64:79], v[100:103], a[8:11], v[64:79]
    v_cvt_pk_bf16_f32 v112, v32, v33
    v_cvt_pk_bf16_f32 v113, v34, v35
    v_mfma_f32_32x32x16_bf16 v[80:95], v[100:103], a[12:15], v[80:95]
    v_cvt_pk_bf16_f32 v114, v40, v41
    v_cvt_pk_bf16_f32 v115, v42, v43
    ds_read_b128 v[100:103], v3 offset:5120
    s_waitcnt lgkmcnt(3)
    v_mfma_f32_32x32x16_bf16 v[64:79], v[104:107], a[16:19], v[64:79]
    buffer_store_dwordx4 v[112:115], v2, s[4:7], s15 offen offset:0 sc1
    v_cvt_pk_bf16_f32 v116, v36, v37
    v_mfma_f32_32x32x16_bf16 v[80:95], v[104:107], a[20:23], v[80:95]
    v_cvt_pk_bf16_f32 v117, v38, v39
    v_cvt_pk_bf16_f32 v118, v44, v45
    ds_read_b128 v[104:107], v3 offset:6144
    s_waitcnt lgkmcnt(3)
    v_mfma_f32_32x32x16_bf16 v[64:79], v[108:111], a[24:27], v[64:79]
    v_cvt_pk_bf16_f32 v119, v46, v47
    buffer_store_dwordx4 v[116:119], v2, s[4:7], s15 offen offset:512 sc1
    v_mfma_f32_32x32x16_bf16 v[80:95], v[108:111], a[28:31], v[80:95]
    v_cvt_pk_bf16_f32 v120, v48, v49
    v_cvt_pk_bf16_f32 v121, v50, v51
    ds_read_b128 v[108:111], v3 offset:7168
    s_waitcnt lgkmcnt(3)
    v_mfma_f32_32x32x16_bf16 v[64:79], v[96:99], a[32:35], v[64:79]
    v_cvt_pk_bf16_f32 v122, v56, v57
    v_cvt_pk_bf16_f32 v123, v58, v59
    v_mfma_f32_32x32x16_bf16 v[80:95], v[96:99], a[36:39], v[80:95]
    buffer_store_dwordx4 v[120:123], v2, s[4:7], s28 offen offset:0 sc1
    v_cvt_pk_bf16_f32 v124, v52, v53
    ds_read_b128 v[96:99], v3 offset:8192
    s_waitcnt lgkmcnt(3)
    v_mfma_f32_32x32x16_bf16 v[64:79], v[100:103], a[40:43], v[64:79]
    v_cvt_pk_bf16_f32 v125, v54, v55
    v_cvt_pk_bf16_f32 v126, v60, v61
    v_mfma_f32_32x32x16_bf16 v[80:95], v[100:103], a[44:47], v[80:95]
    v_cvt_pk_bf16_f32 v127, v62, v63
    buffer_store_dwordx4 v[124:127], v2, s[4:7], s28 offen offset:512 sc1
    ds_read_b128 v[100:103], v3 offset:9216
    s_waitcnt lgkmcnt(3)
    v_mfma_f32_32x32x16_bf16 v[64:79], v[104:107], a[48:51], v[64:79]
    v_mfma_f32_32x32x16_bf16 v[80:95], v[104:107], a[52:55], v[80:95]
    ds_read_b128 v[104:107], v3 offset:10240
    s_waitcnt lgkmcnt(3)
    v_mfma_f32_32x32x16_bf16 v[64:79], v[108:111], a[56:59], v[64:79]
    v_mfma_f32_32x32x16_bf16 v[80:95], v[108:111], a[60:63], v[80:95]
    ds_read_b128 v[108:111], v3 offset:11264
    s_waitcnt lgkmcnt(3)
    v_mfma_f32_32x32x16_bf16 v[64:79], v[96:99], a[64:67], v[64:79]
    v_mfma_f32_32x32x16_bf16 v[80:95], v[96:99], a[68:71], v[80:95]
    ds_read_b128 v[96:99], v3 offset:12288
    s_waitcnt lgkmcnt(3)
    v_mfma_f32_32x32x16_bf16 v[64:79], v[100:103], a[72:75], v[64:79]
    v_mfma_f32_32x32x16_bf16 v[80:95], v[100:103], a[76:79], v[80:95]
    ds_read_b128 v[100:103], v3 offset:13312
    s_waitcnt lgkmcnt(3)
    v_mfma_f32_32x32x16_bf16 v[64:79], v[104:107], a[80:83], v[64:79]
    v_mfma_f32_32x32x16_bf16 v[80:95], v[104:107], a[84:87], v[80:95]
    ds_read_b128 v[104:107], v3 offset:14336
    s_waitcnt lgkmcnt(3)
    v_mfma_f32_32x32x16_bf16 v[64:79], v[108:111], a[88:91], v[64:79]
    v_mfma_f32_32x32x16_bf16 v[80:95], v[108:111], a[92:95], v[80:95]
    ds_read_b128 v[108:111], v3 offset:15360
    s_waitcnt lgkmcnt(3)
    v_mfma_f32_32x32x16_bf16 v[64:79], v[96:99], a[96:99], v[64:79]
    v_mfma_f32_32x32x16_bf16 v[80:95], v[96:99], a[100:103], v[80:95]
    ds_read_b128 v[96:99], v3 offset:16384
    s_waitcnt lgkmcnt(3)
    v_mfma_f32_32x32x16_bf16 v[64:79], v[100:103], a[104:107], v[64:79]
    v_mfma_f32_32x32x16_bf16 v[80:95], v[100:103], a[108:111], v[80:95]
    ds_read_b128 v[100:103], v3 offset:17408
    s_waitcnt lgkmcnt(3)
    v_mfma_f32_32x32x16_bf16 v[64:79], v[104:107], a[112:115], v[64:79]
    v_mfma_f32_32x32x16_bf16 v[80:95], v[104:107], a[116:119], v[80:95]
    ds_read_b128 v[104:107], v3 offset:18432
    s_waitcnt lgkmcnt(3)
    v_mfma_f32_32x32x16_bf16 v[64:79], v[108:111], a[120:123], v[64:79]
    v_mfma_f32_32x32x16_bf16 v[80:95], v[108:111], a[124:127], v[80:95]
    ds_read_b128 v[108:111], v3 offset:19456
    s_waitcnt lgkmcnt(3)
    v_mfma_f32_32x32x16_bf16 v[64:79], v[96:99], a[128:131], v[64:79]
    v_mfma_f32_32x32x16_bf16 v[80:95], v[96:99], a[132:135], v[80:95]
    ds_read_b128 v[96:99], v3 offset:20480
    s_waitcnt lgkmcnt(3)
    v_mfma_f32_32x32x16_bf16 v[64:79], v[100:103], a[136:139], v[64:79]
    v_mfma_f32_32x32x16_bf16 v[80:95], v[100:103], a[140:143], v[80:95]
    ds_read_b128 v[100:103], v3 offset:21504
    s_waitcnt lgkmcnt(3)
    v_mfma_f32_32x32x16_bf16 v[64:79], v[104:107], a[144:147], v[64:79]
    v_mfma_f32_32x32x16_bf16 v[80:95], v[104:107], a[148:151], v[80:95]
    ds_read_b128 v[104:107], v3 offset:22528
    s_waitcnt lgkmcnt(3)
    v_mfma_f32_32x32x16_bf16 v[64:79], v[108:111], a[152:155], v[64:79]
    v_mfma_f32_32x32x16_bf16 v[80:95], v[108:111], a[156:159], v[80:95]
    ds_read_b128 v[108:111], v3 offset:23552
    s_waitcnt lgkmcnt(3)
    v_mfma_f32_32x32x16_bf16 v[64:79], v[96:99], a[160:163], v[64:79]
    v_mfma_f32_32x32x16_bf16 v[80:95], v[96:99], a[164:167], v[80:95]
    ds_read_b128 v[96:99], v3 offset:24576
    s_waitcnt lgkmcnt(3)
    v_mfma_f32_32x32x16_bf16 v[64:79], v[100:103], a[168:171], v[64:79]
    v_mfma_f32_32x32x16_bf16 v[80:95], v[100:103], a[172:175], v[80:95]
    ds_read_b128 v[100:103], v3 offset:25600
    s_waitcnt lgkmcnt(3)
    v_mfma_f32_32x32x16_bf16 v[64:79], v[104:107], a[176:179], v[64:79]
    v_mfma_f32_32x32x16_bf16 v[80:95], v[104:107], a[180:183], v[80:95]
    ds_read_b128 v[104:107], v3 offset:26624
    s_waitcnt lgkmcnt(3)
    v_mfma_f32_32x32x16_bf16 v[64:79], v[108:111], a[184:187], v[64:79]
    v_mfma_f32_32x32x16_bf16 v[80:95], v[108:111], a[188:191], v[80:95]
    ds_read_b128 v[108:111], v3 offset:27648
    s_waitcnt lgkmcnt(3)
    v_mfma_f32_32x32x16_bf16 v[64:79], v[96:99], a[192:195], v[64:79]
    v_mfma_f32_32x32x16_bf16 v[80:95], v[96:99], a[196:199], v[80:95]
    ds_read_b128 v[96:99], v3 offset:28672
    s_waitcnt lgkmcnt(3)
    v_mfma_f32_32x32x16_bf16 v[64:79], v[100:103], a[200:203], v[64:79]
    v_mfma_f32_32x32x16_bf16 v[80:95], v[100:103], a[204:207], v[80:95]
    ds_read_b128 v[100:103], v3 offset:29696
    s_waitcnt lgkmcnt(3)
    v_mfma_f32_32x32x16_bf16 v[64:79], v[104:107], a[208:211], v[64:79]
    v_mfma_f32_32x32x16_bf16 v[80:95], v[104:107], a[212:215], v[80:95]
    ds_read_b128 v[104:107], v3 offset:30720
    s_waitcnt lgkmcnt(3)
    v_mfma_f32_32x32x16_bf16 v[64:79], v[108:111], a[216:219], v[64:79]
    v_mfma_f32_32x32x16_bf16 v[80:95], v[108:111], a[220:223], v[80:95]
    ds_read_b128 v[108:111], v3 offset:31744
    s_waitcnt lgkmcnt(3)
    v_mfma_f32_32x32x16_bf16 v[64:79], v[96:99], a[224:227], v[64:79]
    v_mfma_f32_32x32x16_bf16 v[80:95], v[96:99], a[228:231], v[80:95]
    s_waitcnt lgkmcnt(2)
    v_mfma_f32_32x32x16_bf16 v[64:79], v[100:103], a[232:235], v[64:79]
    v_mfma_f32_32x32x16_bf16 v[80:95], v[100:103], a[236:239], v[80:95]
    s_waitcnt lgkmcnt(1)
    v_mfma_f32_32x32x16_bf16 v[64:79], v[104:107], a[240:243], v[64:79]
    v_mfma_f32_32x32x16_bf16 v[80:95], v[104:107], a[244:247], v[80:95]
    s_waitcnt lgkmcnt(0)
    v_mfma_f32_32x32x16_bf16 v[64:79], v[108:111], a[248:251], v[64:79]
    v_mfma_f32_32x32x16_bf16 v[80:95], v[108:111], a[252:255], v[80:95]
    s_add_u32 s15, s15, 1048576
    s_add_u32 s17, s17, 1
    s_cmp_eq_u32 s17, 16
    s_cbranch_scc1 L_QKV_ENDV
    s_waitcnt vmcnt(0)
    s_barrier
    s_cmp_eq_u32 s17, 6
    s_cbranch_scc0 L_QKV_NOBV6
    s_load_dwordx2 s[96:97], s[0:1], 96
    v_mov_b32 v6, 200
    s_mov_b32 s94, 0
    s_waitcnt lgkmcnt(0)
L_WDQLBV6:
    global_load_dword v7, v6, s[96:97] sc1
    s_waitcnt vmcnt(0)
    v_readfirstlane_b32 s95, v7
    s_add_u32 s94, s94, 1
    s_cmp_gt_u32 s94, 2000000
    s_cbranch_scc1 L_GBAIL
    s_cmp_ge_u32 s95, 32
    s_cbranch_scc1 L_WDOKQLBV6
    s_sleep 4
    s_branch L_WDQLBV6
L_WDOKQLBV6:
L_QKV_NOBV6:
    s_sub_i32 s20, s17, 1
    s_max_i32 s20, s20, 0
    v_mov_b32 v6, s20
    buffer_store_dword v6, v5, s[4:7], s23 offen sc1
    s_add_u32 s22, s26, s27
    s_mov_b32 m0, s22
    s_add_u32 s22, s22, 1024
    buffer_load_dwordx4 v1, s[4:7], s25 offen lds
    s_add_u32 s25, s25, 1024
    s_mov_b32 m0, s22
    s_add_u32 s22, s22, 1024
    buffer_load_dwordx4 v1, s[4:7], s25 offen lds
    s_add_u32 s25, s25, 1024
    s_mov_b32 m0, s22
    s_add_u32 s22, s22, 1024
    buffer_load_dwordx4 v1, s[4:7], s25 offen lds
    s_add_u32 s25, s25, 1024
    s_mov_b32 m0, s22
    s_add_u32 s22, s22, 1024
    buffer_load_dwordx4 v1, s[4:7], s25 offen lds
    s_add_u32 s25, s25, 1024
    s_mov_b32 m0, s22
    s_add_u32 s22, s22, 1024
    buffer_load_dwordx4 v1, s[4:7], s25 offen lds
    s_add_u32 s25, s25, 1024
    s_mov_b32 m0, s22
    s_add_u32 s22, s22, 1024
    buffer_load_dwordx4 v1, s[4:7], s25 offen lds
    s_add_u32 s25, s25, 1024
    s_mov_b32 m0, s22
    s_add_u32 s22, s22, 1024
    buffer_load_dwordx4 v1, s[4:7], s25 offen lds
    s_add_u32 s25, s25, 1024
    s_mov_b32 m0, s22
    s_add_u32 s22, s22, 1024
    buffer_load_dwordx4 v1, s[4:7], s25 offen lds
    s_add_u32 s25, s25, 1024
    s_add_u32 s25, s25, 122880
    s_add_u32 s27, s27, 32768
    s_cmp_eq_u32 s27, 98304
    s_cselect_b32 s27, 0, s27
    v_add_u32 v3, s29, v1
    s_add_u32 s29, s29, 32768
    s_cmp_eq_u32 s29, 98304
    s_cselect_b32 s29, 0, s29
    s_add_u32 s28, s15, s24
    ds_read_b128 v[96:99], v3 offset:0
    ds_read_b128 v[100:103], v3 offset:1024
    ds_read_b128 v[104:107], v3 offset:2048
    ds_read_b128 v[108:111], v3 offset:3072
    s_waitcnt lgkmcnt(3)
    v_mfma_f32_32x32x16_bf16 v[32:47], v[96:99], a[0:3], 0
    v_mfma_f32_32x32x16_bf16 v[48:63], v[96:99], a[4:7], 0
    ds_read_b128 v[96:99], v3 offset:4096
    s_waitcnt lgkmcnt(3)
    v_mfma_f32_32x32x16_bf16 v[32:47], v[100:103], a[8:11], v[32:47]
    v_cvt_pk_bf16_f32 v112, v64, v65
    v_cvt_pk_bf16_f32 v113, v66, v67
    v_mfma_f32_32x32x16_bf16 v[48:63], v[100:103], a[12:15], v[48:63]
    v_cvt_pk_bf16_f32 v114, v72, v73
    v_cvt_pk_bf16_f32 v115, v74, v75
    ds_read_b128 v[100:103], v3 offset:5120
    s_waitcnt lgkmcnt(3)
    v_mfma_f32_32x32x16_bf16 v[32:47], v[104:107], a[16:19], v[32:47]
    buffer_store_dwordx4 v[112:115], v2, s[4:7], s15 offen offset:0 sc1
    v_cvt_pk_bf16_f32 v116, v68, v69
    v_mfma_f32_32x32x16_bf16 v[48:63], v[104:107], a[20:23], v[48:63]
    v_cvt_pk_bf16_f32 v117, v70, v71
    v_cvt_pk_bf16_f32 v118, v76, v77
    ds_read_b128 v[104:107], v3 offset:6144
    s_waitcnt lgkmcnt(3)
    v_mfma_f32_32x32x16_bf16 v[32:47], v[108:111], a[24:27], v[32:47]
    v_cvt_pk_bf16_f32 v119, v78, v79
    buffer_store_dwordx4 v[116:119], v2, s[4:7], s15 offen offset:512 sc1
    v_mfma_f32_32x32x16_bf16 v[48:63], v[108:111], a[28:31], v[48:63]
    v_cvt_pk_bf16_f32 v120, v80, v81
    v_cvt_pk_bf16_f32 v121, v82, v83
    ds_read_b128 v[108:111], v3 offset:7168
    s_waitcnt lgkmcnt(3)
    v_mfma_f32_32x32x16_bf16 v[32:47], v[96:99], a[32:35], v[32:47]
    v_cvt_pk_bf16_f32 v122, v88, v89
    v_cvt_pk_bf16_f32 v123, v90, v91
    v_mfma_f32_32x32x16_bf16 v[48:63], v[96:99], a[36:39], v[48:63]
    buffer_store_dwordx4 v[120:123], v2, s[4:7], s28 offen offset:0 sc1
    v_cvt_pk_bf16_f32 v124, v84, v85
    ds_read_b128 v[96:99], v3 offset:8192
    s_waitcnt lgkmcnt(3)
    v_mfma_f32_32x32x16_bf16 v[32:47], v[100:103], a[40:43], v[32:47]
    v_cvt_pk_bf16_f32 v125, v86, v87
    v_cvt_pk_bf16_f32 v126, v92, v93
    v_mfma_f32_32x32x16_bf16 v[48:63], v[100:103], a[44:47], v[48:63]
    v_cvt_pk_bf16_f32 v127, v94, v95
    buffer_store_dwordx4 v[124:127], v2, s[4:7], s28 offen offset:512 sc1
    ds_read_b128 v[100:103], v3 offset:9216
    s_waitcnt lgkmcnt(3)
    v_mfma_f32_32x32x16_bf16 v[32:47], v[104:107], a[48:51], v[32:47]
    v_mfma_f32_32x32x16_bf16 v[48:63], v[104:107], a[52:55], v[48:63]
    ds_read_b128 v[104:107], v3 offset:10240
    s_waitcnt lgkmcnt(3)
    v_mfma_f32_32x32x16_bf16 v[32:47], v[108:111], a[56:59], v[32:47]
    v_mfma_f32_32x32x16_bf16 v[48:63], v[108:111], a[60:63], v[48:63]
    ds_read_b128 v[108:111], v3 offset:11264
    s_waitcnt lgkmcnt(3)
    v_mfma_f32_32x32x16_bf16 v[32:47], v[96:99], a[64:67], v[32:47]
    v_mfma_f32_32x32x16_bf16 v[48:63], v[96:99], a[68:71], v[48:63]
    ds_read_b128 v[96:99], v3 offset:12288
    s_waitcnt lgkmcnt(3)
    v_mfma_f32_32x32x16_bf16 v[32:47], v[100:103], a[72:75], v[32:47]
    v_mfma_f32_32x32x16_bf16 v[48:63], v[100:103], a[76:79], v[48:63]
    ds_read_b128 v[100:103], v3 offset:13312
    s_waitcnt lgkmcnt(3)
    v_mfma_f32_32x32x16_bf16 v[32:47], v[104:107], a[80:83], v[32:47]
    v_mfma_f32_32x32x16_bf16 v[48:63], v[104:107], a[84:87], v[48:63]
    ds_read_b128 v[104:107], v3 offset:14336
    s_waitcnt lgkmcnt(3)
    v_mfma_f32_32x32x16_bf16 v[32:47], v[108:111], a[88:91], v[32:47]
    v_mfma_f32_32x32x16_bf16 v[48:63], v[108:111], a[92:95], v[48:63]
    ds_read_b128 v[108:111], v3 offset:15360
    s_waitcnt lgkmcnt(3)
    v_mfma_f32_32x32x16_bf16 v[32:47], v[96:99], a[96:99], v[32:47]
    v_mfma_f32_32x32x16_bf16 v[48:63], v[96:99], a[100:103], v[48:63]
    ds_read_b128 v[96:99], v3 offset:16384
    s_waitcnt lgkmcnt(3)
    v_mfma_f32_32x32x16_bf16 v[32:47], v[100:103], a[104:107], v[32:47]
    v_mfma_f32_32x32x16_bf16 v[48:63], v[100:103], a[108:111], v[48:63]
    ds_read_b128 v[100:103], v3 offset:17408
    s_waitcnt lgkmcnt(3)
    v_mfma_f32_32x32x16_bf16 v[32:47], v[104:107], a[112:115], v[32:47]
    v_mfma_f32_32x32x16_bf16 v[48:63], v[104:107], a[116:119], v[48:63]
    ds_read_b128 v[104:107], v3 offset:18432
    s_waitcnt lgkmcnt(3)
    v_mfma_f32_32x32x16_bf16 v[32:47], v[108:111], a[120:123], v[32:47]
    v_mfma_f32_32x32x16_bf16 v[48:63], v[108:111], a[124:127], v[48:63]
    ds_read_b128 v[108:111], v3 offset:19456
    s_waitcnt lgkmcnt(3)
    v_mfma_f32_32x32x16_bf16 v[32:47], v[96:99], a[128:131], v[32:47]
    v_mfma_f32_32x32x16_bf16 v[48:63], v[96:99], a[132:135], v[48:63]
    ds_read_b128 v[96:99], v3 offset:20480
    s_waitcnt lgkmcnt(3)
    v_mfma_f32_32x32x16_bf16 v[32:47], v[100:103], a[136:139], v[32:47]
    v_mfma_f32_32x32x16_bf16 v[48:63], v[100:103], a[140:143], v[48:63]
    ds_read_b128 v[100:103], v3 offset:21504
    s_waitcnt lgkmcnt(3)
    v_mfma_f32_32x32x16_bf16 v[32:47], v[104:107], a[144:147], v[32:47]
    v_mfma_f32_32x32x16_bf16 v[48:63], v[104:107], a[148:151], v[48:63]
    ds_read_b128 v[104:107], v3 offset:22528
    s_waitcnt lgkmcnt(3)
    v_mfma_f32_32x32x16_bf16 v[32:47], v[108:111], a[152:155], v[32:47]
    v_mfma_f32_32x32x16_bf16 v[48:63], v[108:111], a[156:159], v[48:63]
    ds_read_b128 v[108:111], v3 offset:23552
    s_waitcnt lgkmcnt(3)
    v_mfma_f32_32x32x16_bf16 v[32:47], v[96:99], a[160:163], v[32:47]
    v_mfma_f32_32x32x16_bf16 v[48:63], v[96:99], a[164:167], v[48:63]
    ds_read_b128 v[96:99], v3 offset:24576
    s_waitcnt lgkmcnt(3)
    v_mfma_f32_32x32x16_bf16 v[32:47], v[100:103], a[168:171], v[32:47]
    v_mfma_f32_32x32x16_bf16 v[48:63], v[100:103], a[172:175], v[48:63]
    ds_read_b128 v[100:103], v3 offset:25600
    s_waitcnt lgkmcnt(3)
    v_mfma_f32_32x32x16_bf16 v[32:47], v[104:107], a[176:179], v[32:47]
    v_mfma_f32_32x32x16_bf16 v[48:63], v[104:107], a[180:183], v[48:63]
    ds_read_b128 v[104:107], v3 offset:26624
    s_waitcnt lgkmcnt(3)
    v_mfma_f32_32x32x16_bf16 v[32:47], v[108:111], a[184:187], v[32:47]
    v_mfma_f32_32x32x16_bf16 v[48:63], v[108:111], a[188:191], v[48:63]
    ds_read_b128 v[108:111], v3 offset:27648
    s_waitcnt lgkmcnt(3)
    v_mfma_f32_32x32x16_bf16 v[32:47], v[96:99], a[192:195], v[32:47]
    v_mfma_f32_32x32x16_bf16 v[48:63], v[96:99], a[196:199], v[48:63]
    ds_read_b128 v[96:99], v3 offset:28672
    s_waitcnt lgkmcnt(3)
    v_mfma_f32_32x32x16_bf16 v[32:47], v[100:103], a[200:203], v[32:47]
    v_mfma_f32_32x32x16_bf16 v[48:63], v[100:103], a[204:207], v[48:63]
    ds_read_b128 v[100:103], v3 offset:29696
    s_waitcnt lgkmcnt(3)
    v_mfma_f32_32x32x16_bf16 v[32:47], v[104:107], a[208:211], v[32:47]
    v_mfma_f32_32x32x16_bf16 v[48:63], v[104:107], a[212:215], v[48:63]
    ds_read_b128 v[104:107], v3 offset:30720
    s_waitcnt lgkmcnt(3)
    v_mfma_f32_32x32x16_bf16 v[32:47], v[108:111], a[216:219], v[32:47]
    v_mfma_f32_32x32x16_bf16 v[48:63], v[108:111], a[220:223], v[48:63]
    ds_read_b128 v[108:111], v3 offset:31744
    s_waitcnt lgkmcnt(3)
    v_mfma_f32_32x32x16_bf16 v[32:47], v[96:99], a[224:227], v[32:47]
    v_mfma_f32_32x32x16_bf16 v[48:63], v[96:99], a[228:231], v[48:63]
    s_waitcnt lgkmcnt(2)
    v_mfma_f32_32x32x16_bf16 v[32:47], v[100:103], a[232:235], v[32:47]
    v_mfma_f32_32x32x16_bf16 v[48:63], v[100:103], a[236:239], v[48:63]
    s_waitcnt lgkmcnt(1)
    v_mfma_f32_32x32x16_bf16 v[32:47], v[104:107], a[240:243], v[32:47]
    v_mfma_f32_32x32x16_bf16 v[48:63], v[104:107], a[244:247], v[48:63]
    s_waitcnt lgkmcnt(0)
    v_mfma_f32_32x32x16_bf16 v[32:47], v[108:111], a[248:251], v[32:47]
    v_mfma_f32_32x32x16_bf16 v[48:63], v[108:111], a[252:255], v[48:63]
    s_add_u32 s15, s15, 1048576
    s_add_u32 s17, s17, 1
    s_branch L_QKV_LOOPV
L_QKV_ENDV:
    s_add_u32 s28, s15, s24
    s_nop 7
    v_cvt_pk_bf16_f32 v112, v64, v65
    v_cvt_pk_bf16_f32 v113, v66, v67
    v_cvt_pk_bf16_f32 v114, v72, v73
    v_cvt_pk_bf16_f32 v115, v74, v75
    buffer_store_dwordx4 v[112:115], v2, s[4:7], s15 offen offset:0 sc1
    v_cvt_pk_bf16_f32 v116, v68, v69
    v_cvt_pk_bf16_f32 v117, v70, v71
    v_cvt_pk_bf16_f32 v118, v76, v77
    v_cvt_pk_bf16_f32 v119, v78, v79
    buffer_store_dwordx4 v[116:119], v2, s[4:7], s15 offen offset:512 sc1
    v_cvt_pk_bf16_f32 v120, v80, v81
    v_cvt_pk_bf16_f32 v121, v82, v83
    v_cvt_pk_bf16_f32 v122, v88, v89
    v_cvt_pk_bf16_f32 v123, v90, v91
    buffer_store_dwordx4 v[120:123], v2, s[4:7], s28 offen offset:0 sc1
    v_cvt_pk_bf16_f32 v124, v84, v85
    v_cvt_pk_bf16_f32 v125, v86, v87
    v_cvt_pk_bf16_f32 v126, v92, v93
    v_cvt_pk_bf16_f32 v127, v94, v95
    buffer_store_dwordx4 v[124:127], v2, s[4:7], s28 offen offset:512 sc1
    s_waitcnt vmcnt(0)
    s_barrier
    v_mov_b32 v6, 16
    buffer_store_dword v6, v5, s[4:7], s23 offen sc1
L_QKV_DONE:
    s_branch L_P2
L_LN:
    s_waitcnt vmcnt(0)
    s_barrier
    s_load_dwordx2 s[96:97], s[0:1], 96
    v_mov_b32 v120, 192
    v_mov_b32 v121, 1
    v_or_b32 v122, s3, v0
    s_waitcnt lgkmcnt(0)
    v_cmp_eq_u32 vcc, 0, v122
    s_and_saveexec_b64 s[98:99], vcc
    s_cbranch_execz L_ADL
    global_atomic_add v120, v121, s[96:97]
L_ADL:
    s_mov_b64 exec, s[98:99]
    s_load_dwordx2 s[8:9], s[0:1], 0
    s_mov_b32 s10, 0x200000
    s_mov_b32 s11, 0x20000
    s_waitcnt lgkmcnt(0)
    s_mov_b32 s12, s81
    v_lshlrev_b32 v1, 4, v0
    s_lshl_b32 s20, s12, 5
    s_lshl_b32 s21, s3, 3
    s_add_u32 s20, s20, s21
    s_lshl_b32 s20, s20, 10
    s_mul_i32 s21, s21, 1088
    s_mov_b32 m0, s21
    s_add_u32 s21, s21, 1088
    buffer_load_dwordx4 v1, s[8:11], s20 offen lds
    s_add_u32 s20, s20, 1024
    s_mov_b32 m0, s21
    s_add_u32 s21, s21, 1088
    buffer_load_dwordx4 v1, s[8:11], s20 offen lds
    s_add_u32 s20, s20, 1024
    s_mov_b32 m0, s21
    s_add_u32 s21, s21, 1088
    buffer_load_dwordx4 v1, s[8:11], s20 offen lds
    s_add_u32 s20, s20, 1024
    s_mov_b32 m0, s21
    s_add_u32 s21, s21, 1088
    buffer_load_dwordx4 v1, s[8:11], s20 offen lds
    s_add_u32 s20, s20, 1024
    s_mov_b32 m0, s21
    s_add_u32 s21, s21, 1088
    buffer_load_dwordx4 v1, s[8:11], s20 offen lds
    s_add_u32 s20, s20, 1024
    s_mov_b32 m0, s21
    s_add_u32 s21, s21, 1088
    buffer_load_dwordx4 v1, s[8:11], s20 offen lds
    s_add_u32 s20, s20, 1024
    s_mov_b32 m0, s21
    s_add_u32 s21, s21, 1088
    buffer_load_dwordx4 v1, s[8:11], s20 offen lds
    s_add_u32 s20, s20, 1024
    s_mov_b32 m0, s21
    s_add_u32 s21, s21, 1088
    buffer_load_dwordx4 v1, s[8:11], s20 offen lds
    s_add_u32 s20, s20, 1024
    s_add_u32 s13, s81, 32
    v_lshlrev_b32 v1, 4, v0
    s_lshl_b32 s20, s13, 5
    s_lshl_b32 s21, s3, 3
    s_add_u32 s20, s20, s21
    s_lshl_b32 s20, s20, 10
    s_mul_i32 s21, s21, 1088
    s_add_u32 s21, s21, 34816
    s_mov_b32 m0, s21
    s_add_u32 s21, s21, 1088
    buffer_load_dwordx4 v1, s[8:11], s20 offen lds
    s_add_u32 s20, s20, 1024
    s_mov_b32 m0, s21
    s_add_u32 s21, s21, 1088
    buffer_load_dwordx4 v1, s[8:11], s20 offen lds
    s_add_u32 s20, s20, 1024
    s_mov_b32 m0, s21
    s_add_u32 s21, s21, 1088
    buffer_load_dwordx4 v1, s[8:11], s20 offen lds
    s_add_u32 s20, s20, 1024
    s_mov_b32 m0, s21
    s_add_u32 s21, s21, 1088
    buffer_load_dwordx4 v1, s[8:11], s20 offen lds
    s_add_u32 s20, s20, 1024
    s_mov_b32 m0, s21
    s_add_u32 s21, s21, 1088
    buffer_load_dwordx4 v1, s[8:11], s20 offen lds
    s_add_u32 s20, s20, 1024
    s_mov_b32 m0, s21
    s_add_u32 s21, s21, 1088
    buffer_load_dwordx4 v1, s[8:11], s20 offen lds
    s_add_u32 s20, s20, 1024
    s_mov_b32 m0, s21
    s_add_u32 s21, s21, 1088
    buffer_load_dwordx4 v1, s[8:11], s20 offen lds
    s_add_u32 s20, s20, 1024
    s_mov_b32 m0, s21
    s_add_u32 s21, s21, 1088
    buffer_load_dwordx4 v1, s[8:11], s20 offen lds
    s_add_u32 s20, s20, 1024
    v_and_b32 v2, 7, v0
    s_lshl_b32 s21, s3, 3
    v_add_u32 v2, s21, v2
    v_mul_u32_u24 v3, 1088, v2
    v_lshrrev_b32 v4, 3, v0
    v_lshl_add_u32 v3, v4, 4, v3
    s_waitcnt vmcnt(8)
    ds_read_b128 v[8:11], v3 offset:0
    ds_read_b128 v[12:15], v3 offset:128
    ds_read_b128 v[16:19], v3 offset:256
    ds_read_b128 v[20:23], v3 offset:384
    ds_read_b128 v[24:27], v3 offset:512
    ds_read_b128 v[28:31], v3 offset:640
    ds_read_b128 v[32:35], v3 offset:768
    ds_read_b128 v[36:39], v3 offset:896
    s_waitcnt lgkmcnt(7)
    v_lshlrev_b32 v48, 16, v8
    v_and_b32 v49, 0xffff0000, v8
    v_lshlrev_b32 v50, 16, v9
    v_and_b32 v51, 0xffff0000, v9
    v_lshlrev_b32 v52, 16, v10
    v_and_b32 v53, 0xffff0000, v10
    v_lshlrev_b32 v54, 16, v11
    v_and_b32 v55, 0xffff0000, v11
    s_waitcnt lgkmcnt(6)
    v_lshlrev_b32 v56, 16, v12
    v_and_b32 v57, 0xffff0000, v12
    v_lshlrev_b32 v58, 16, v13
    v_and_b32 v59, 0xffff0000, v13
    v_lshlrev_b32 v60, 16, v14
    v_and_b32 v61, 0xffff0000, v14
    v_lshlrev_b32 v62, 16, v15
    v_and_b32 v63, 0xffff0000, v15
    s_waitcnt lgkmcnt(5)
    v_lshlrev_b32 v64, 16, v16
    v_and_b32 v65, 0xffff0000, v16
    v_lshlrev_b32 v66, 16, v17
    v_and_b32 v67, 0xffff0000, v17
    v_lshlrev_b32 v68, 16, v18
    v_and_b32 v69, 0xffff0000, v18
    v_lshlrev_b32 v70, 16, v19
    v_and_b32 v71, 0xffff0000, v19
    s_waitcnt lgkmcnt(4)
    v_lshlrev_b32 v72, 16, v20
    v_and_b32 v73, 0xffff0000, v20
    v_lshlrev_b32 v74, 16, v21
    v_and_b32 v75, 0xffff0000, v21
    v_lshlrev_b32 v76, 16, v22
    v_and_b32 v77, 0xffff0000, v22
    v_lshlrev_b32 v78, 16, v23
    v_and_b32 v79, 0xffff0000, v23
    s_waitcnt lgkmcnt(3)
    v_lshlrev_b32 v80, 16, v24
    v_and_b32 v81, 0xffff0000, v24
    v_lshlrev_b32 v82, 16, v25
    v_and_b32 v83, 0xffff0000, v25
    v_lshlrev_b32 v84, 16, v26
    v_and_b32 v85, 0xffff0000, v26
    v_lshlrev_b32 v86, 16, v27
    v_and_b32 v87, 0xffff0000, v27
    s_waitcnt lgkmcnt(2)
    v_lshlrev_b32 v88, 16, v28
    v_and_b32 v89, 0xffff0000, v28
    v_lshlrev_b32 v90, 16, v29
    v_and_b32 v91, 0xffff0000, v29
    v_lshlrev_b32 v92, 16, v30
    v_and_b32 v93, 0xffff0000, v30
    v_lshlrev_b32 v94, 16, v31
    v_and_b32 v95, 0xffff0000, v31
    s_waitcnt lgkmcnt(1)
    v_lshlrev_b32 v96, 16, v32
    v_and_b32 v97, 0xffff0000, v32
    v_lshlrev_b32 v98, 16, v33
    v_and_b32 v99, 0xffff0000, v33
    v_lshlrev_b32 v100, 16, v34
    v_and_b32 v101, 0xffff0000, v34
    v_lshlrev_b32 v102, 16, v35
    v_and_b32 v103, 0xffff0000, v35
    s_waitcnt lgkmcnt(0)
    v_lshlrev_b32 v104, 16, v36
    v_and_b32 v105, 0xffff0000, v36
    v_lshlrev_b32 v106, 16, v37
    v_and_b32 v107, 0xffff0000, v37
    v_lshlrev_b32 v108, 16, v38
    v_and_b32 v109, 0xffff0000, v38
    v_lshlrev_b32 v110, 16, v39
    v_and_b32 v111, 0xffff0000, v39
    v_pk_add_f32 v[6:7], v[48:49], v[50:51]
    v_pk_add_f32 v[6:7], v[6:7], v[52:53]
    v_pk_add_f32 v[6:7], v[6:7], v[54:55]
    v_pk_add_f32 v[6:7], v[6:7], v[56:57]
    v_pk_add_f32 v[6:7], v[6:7], v[58:59]
    v_pk_add_f32 v[6:7], v[6:7], v[60:61]
    v_pk_add_f32 v[6:7], v[6:7], v[62:63]
    v_pk_add_f32 v[6:7], v[6:7], v[64:65]
    v_pk_add_f32 v[6:7], v[6:7], v[66:67]
    v_pk_add_f32 v[6:7], v[6:7], v[68:69]
    v_pk_add_f32 v[6:7], v[6:7], v[70:71]
    v_pk_add_f32 v[6:7], v[6:7], v[72:73]
    v_pk_add_f32 v[6:7], v[6:7], v[74:75]
    v_pk_add_f32 v[6:7], v[6:7], v[76:77]
    v_pk_add_f32 v[6:7], v[6:7], v[78:79]
    v_pk_add_f32 v[6:7], v[6:7], v[80:81]
    v_pk_add_f32 v[6:7], v[6:7], v[82:83]
    v_pk_add_f32 v[6:7], v[6:7], v[84:85]
    v_pk_add_f32 v[6:7], v[6:7], v[86:87]
    v_pk_add_f32 v[6:7], v[6:7], v[88:89]
    v_pk_add_f32 v[6:7], v[6:7], v[90:91]
    v_pk_add_f32 v[6:7], v[6:7], v[92:93]
    v_pk_add_f32 v[6:7], v[6:7], v[94:95]
    v_pk_add_f32 v[6:7], v[6:7], v[96:97]
    v_pk_add_f32 v[6:7], v[6:7], v[98:99]
    v_pk_add_f32 v[6:7], v[6:7], v[100:101]
    v_pk_add_f32 v[6:7], v[6:7], v[102:103]
    v_pk_add_f32 v[6:7], v[6:7], v[104:105]
    v_pk_add_f32 v[6:7], v[6:7], v[106:107]
    v_pk_add_f32 v[6:7], v[6:7], v[108:109]
    v_pk_add_f32 v[6:7], v[6:7], v[110:111]
    v_add_f32 v6, v6, v7
    s_nop 1
    v_add_f32_dpp v6, v6, v6 row_ror:8 row_mask:0xf bank_mask:0xf
    v_mov_b32 v5, v6
    s_nop 1
    v_permlane16_swap_b32 v5, v6
    v_add_f32 v6, v6, v5
    v_mov_b32 v5, v6
    s_nop 1
    v_permlane32_swap_b32 v5, v6
    v_add_f32 v6, v6, v5
    v_mul_f32 v6, 0x3b000000, v6
    v_pk_add_f32 v[48:49], v[48:49], v[6:7] op_sel_hi:[1,0] neg_lo:[0,1] neg_hi:[0,1]
    v_pk_add_f32 v[50:51], v[50:51], v[6:7] op_sel_hi:[1,0] neg_lo:[0,1] neg_hi:[0,1]
    v_pk_add_f32 v[52:53], v[52:53], v[6:7] op_sel_hi:[1,0] neg_lo:[0,1] neg_hi:[0,1]
    v_pk_add_f32 v[54:55], v[54:55], v[6:7] op_sel_hi:[1,0] neg_lo:[0,1] neg_hi:[0,1]
    v_pk_add_f32 v[56:57], v[56:57], v[6:7] op_sel_hi:[1,0] neg_lo:[0,1] neg_hi:[0,1]
    v_pk_add_f32 v[58:59], v[58:59], v[6:7] op_sel_hi:[1,0] neg_lo:[0,1] neg_hi:[0,1]
    v_pk_add_f32 v[60:61], v[60:61], v[6:7] op_sel_hi:[1,0] neg_lo:[0,1] neg_hi:[0,1]
    v_pk_add_f32 v[62:63], v[62:63], v[6:7] op_sel_hi:[1,0] neg_lo:[0,1] neg_hi:[0,1]
    v_pk_add_f32 v[64:65], v[64:65], v[6:7] op_sel_hi:[1,0] neg_lo:[0,1] neg_hi:[0,1]
    v_pk_add_f32 v[66:67], v[66:67], v[6:7] op_sel_hi:[1,0] neg_lo:[0,1] neg_hi:[0,1]
    v_pk_add_f32 v[68:69], v[68:69], v[6:7] op_sel_hi:[1,0] neg_lo:[0,1] neg_hi:[0,1]
    v_pk_add_f32 v[70:71], v[70:71], v[6:7] op_sel_hi:[1,0] neg_lo:[0,1] neg_hi:[0,1]
    v_pk_add_f32 v[72:73], v[72:73], v[6:7] op_sel_hi:[1,0] neg_lo:[0,1] neg_hi:[0,1]
    v_pk_add_f32 v[74:75], v[74:75], v[6:7] op_sel_hi:[1,0] neg_lo:[0,1] neg_hi:[0,1]
    v_pk_add_f32 v[76:77], v[76:77], v[6:7] op_sel_hi:[1,0] neg_lo:[0,1] neg_hi:[0,1]
    v_pk_add_f32 v[78:79], v[78:79], v[6:7] op_sel_hi:[1,0] neg_lo:[0,1] neg_hi:[0,1]
    v_pk_add_f32 v[80:81], v[80:81], v[6:7] op_sel_hi:[1,0] neg_lo:[0,1] neg_hi:[0,1]
    v_pk_add_f32 v[82:83], v[82:83], v[6:7] op_sel_hi:[1,0] neg_lo:[0,1] neg_hi:[0,1]
    v_pk_add_f32 v[84:85], v[84:85], v[6:7] op_sel_hi:[1,0] neg_lo:[0,1] neg_hi:[0,1]
    v_pk_add_f32 v[86:87], v[86:87], v[6:7] op_sel_hi:[1,0] neg_lo:[0,1] neg_hi:[0,1]
    v_pk_add_f32 v[88:89], v[88:89], v[6:7] op_sel_hi:[1,0] neg_lo:[0,1] neg_hi:[0,1]
    v_pk_add_f32 v[90:91], v[90:91], v[6:7] op_sel_hi:[1,0] neg_lo:[0,1] neg_hi:[0,1]
    v_pk_add_f32 v[92:93], v[92:93], v[6:7] op_sel_hi:[1,0] neg_lo:[0,1] neg_hi:[0,1]
    v_pk_add_f32 v[94:95], v[94:95], v[6:7] op_sel_hi:[1,0] neg_lo:[0,1] neg_hi:[0,1]
    v_pk_add_f32 v[96:97], v[96:97], v[6:7] op_sel_hi:[1,0] neg_lo:[0,1] neg_hi:[0,1]
    v_pk_add_f32 v[98:99], v[98:99], v[6:7] op_sel_hi:[1,0] neg_lo:[0,1] neg_hi:[0,1]
    v_pk_add_f32 v[100:101], v[100:101], v[6:7] op_sel_hi:[1,0] neg_lo:[0,1] neg_hi:[0,1]
    v_pk_add_f32 v[102:103], v[102:103], v[6:7] op_sel_hi:[1,0] neg_lo:[0,1] neg_hi:[0,1]
    v_pk_add_f32 v[104:105], v[104:105], v[6:7] op_sel_hi:[1,0] neg_lo:[0,1] neg_hi:[0,1]
    v_pk_add_f32 v[106:107], v[106:107], v[6:7] op_sel_hi:[1,0] neg_lo:[0,1] neg_hi:[0,1]
    v_pk_add_f32 v[108:109], v[108:109], v[6:7] op_sel_hi:[1,0] neg_lo:[0,1] neg_hi:[0,1]
    v_pk_add_f32 v[110:111], v[110:111], v[6:7] op_sel_hi:[1,0] neg_lo:[0,1] neg_hi:[0,1]
    v_pk_mul_f32 v[6:7], v[48:49], v[48:49]
    v_pk_fma_f32 v[6:7], v[50:51], v[50:51], v[6:7]
    v_pk_fma_f32 v[6:7], v[52:53], v[52:53], v[6:7]
    v_pk_fma_f32 v[6:7], v[54:55], v[54:55], v[6:7]
    v_pk_fma_f32 v[6:7], v[56:57], v[56:57], v[6:7]
    v_pk_fma_f32 v[6:7], v[58:59], v[58:59], v[6:7]
    v_pk_fma_f32 v[6:7], v[60:61], v[60:61], v[6:7]
    v_pk_fma_f32 v[6:7], v[62:63], v[62:63], v[6:7]
    v_pk_fma_f32 v[6:7], v[64:65], v[64:65], v[6:7]
    v_pk_fma_f32 v[6:7], v[66:67], v[66:67], v[6:7]
    v_pk_fma_f32 v[6:7], v[68:69], v[68:69], v[6:7]
    v_pk_fma_f32 v[6:7], v[70:71], v[70:71], v[6:7]
    v_pk_fma_f32 v[6:7], v[72:73], v[72:73], v[6:7]
    v_pk_fma_f32 v[6:7], v[74:75], v[74:75], v[6:7]
    v_pk_fma_f32 v[6:7], v[76:77], v[76:77], v[6:7]
    v_pk_fma_f32 v[6:7], v[78:79], v[78:79], v[6:7]
    v_pk_fma_f32 v[6:7], v[80:81], v[80:81], v[6:7]
    v_pk_fma_f32 v[6:7], v[82:83], v[82:83], v[6:7]
    v_pk_fma_f32 v[6:7], v[84:85], v[84:85], v[6:7]
    v_pk_fma_f32 v[6:7], v[86:87], v[86:87], v[6:7]
    v_pk_fma_f32 v[6:7], v[88:89], v[88:89], v[6:7]
    v_pk_fma_f32 v[6:7], v[90:91], v[90:91], v[6:7]
    v_pk_fma_f32 v[6:7], v[92:93], v[92:93], v[6:7]
    v_pk_fma_f32 v[6:7], v[94:95], v[94:95], v[6:7]
    v_pk_fma_f32 v[6:7], v[96:97], v[96:97], v[6:7]
    v_pk_fma_f32 v[6:7], v[98:99], v[98:99], v[6:7]
    v_pk_fma_f32 v[6:7], v[100:101], v[100:101], v[6:7]
    v_pk_fma_f32 v[6:7], v[102:103], v[102:103], v[6:7]
    v_pk_fma_f32 v[6:7], v[104:105], v[104:105], v[6:7]
    v_pk_fma_f32 v[6:7], v[106:107], v[106:107], v[6:7]
    v_pk_fma_f32 v[6:7], v[108:109], v[108:109], v[6:7]
    v_pk_fma_f32 v[6:7], v[110:111], v[110:111], v[6:7]
    v_add_f32 v6, v6, v7
    s_nop 1
    v_add_f32_dpp v6, v6, v6 row_ror:8 row_mask:0xf bank_mask:0xf
    v_mov_b32 v5, v6
    s_nop 1
    v_permlane16_swap_b32 v5, v6
    v_add_f32 v6, v6, v5
    v_mov_b32 v5, v6
    s_nop 1
    v_permlane32_swap_b32 v5, v6
    v_add_f32 v6, v6, v5
    v_mov_b32 v7, 0x3727c5ac
    v_fmac_f32 v7, 0x3b000000, v6
    v_rsq_f32 v6, v7
    s_nop 0
    v_pk_mul_f32 v[48:49], v[48:49], v[6:7] op_sel_hi:[1,0]
    v_pk_mul_f32 v[50:51], v[50:51], v[6:7] op_sel_hi:[1,0]
    v_pk_mul_f32 v[52:53], v[52:53], v[6:7] op_sel_hi:[1,0]
    v_pk_mul_f32 v[54:55], v[54:55], v[6:7] op_sel_hi:[1,0]
    v_pk_mul_f32 v[56:57], v[56:57], v[6:7] op_sel_hi:[1,0]
    v_pk_mul_f32 v[58:59], v[58:59], v[6:7] op_sel_hi:[1,0]
    v_pk_mul_f32 v[60:61], v[60:61], v[6:7] op_sel_hi:[1,0]
    v_pk_mul_f32 v[62:63], v[62:63], v[6:7] op_sel_hi:[1,0]
    v_pk_mul_f32 v[64:65], v[64:65], v[6:7] op_sel_hi:[1,0]
    v_pk_mul_f32 v[66:67], v[66:67], v[6:7] op_sel_hi:[1,0]
    v_pk_mul_f32 v[68:69], v[68:69], v[6:7] op_sel_hi:[1,0]
    v_pk_mul_f32 v[70:71], v[70:71], v[6:7] op_sel_hi:[1,0]
    v_pk_mul_f32 v[72:73], v[72:73], v[6:7] op_sel_hi:[1,0]
    v_pk_mul_f32 v[74:75], v[74:75], v[6:7] op_sel_hi:[1,0]
    v_pk_mul_f32 v[76:77], v[76:77], v[6:7] op_sel_hi:[1,0]
    v_pk_mul_f32 v[78:79], v[78:79], v[6:7] op_sel_hi:[1,0]
    v_pk_mul_f32 v[80:81], v[80:81], v[6:7] op_sel_hi:[1,0]
    v_pk_mul_f32 v[82:83], v[82:83], v[6:7] op_sel_hi:[1,0]
    v_pk_mul_f32 v[84:85], v[84:85], v[6:7] op_sel_hi:[1,0]
    v_pk_mul_f32 v[86:87], v[86:87], v[6:7] op_sel_hi:[1,0]
    v_pk_mul_f32 v[88:89], v[88:89], v[6:7] op_sel_hi:[1,0]
    v_pk_mul_f32 v[90:91], v[90:91], v[6:7] op_sel_hi:[1,0]
    v_pk_mul_f32 v[92:93], v[92:93], v[6:7] op_sel_hi:[1,0]
    v_pk_mul_f32 v[94:95], v[94:95], v[6:7] op_sel_hi:[1,0]
    v_pk_mul_f32 v[96:97], v[96:97], v[6:7] op_sel_hi:[1,0]
    v_pk_mul_f32 v[98:99], v[98:99], v[6:7] op_sel_hi:[1,0]
    v_pk_mul_f32 v[100:101], v[100:101], v[6:7] op_sel_hi:[1,0]
    v_pk_mul_f32 v[102:103], v[102:103], v[6:7] op_sel_hi:[1,0]
    v_pk_mul_f32 v[104:105], v[104:105], v[6:7] op_sel_hi:[1,0]
    v_pk_mul_f32 v[106:107], v[106:107], v[6:7] op_sel_hi:[1,0]
    v_pk_mul_f32 v[108:109], v[108:109], v[6:7] op_sel_hi:[1,0]
    v_pk_mul_f32 v[110:111], v[110:111], v[6:7] op_sel_hi:[1,0]
    v_cvt_pk_bf16_f32 v8, v48, v49
    v_cvt_pk_bf16_f32 v9, v50, v51
    v_cvt_pk_bf16_f32 v10, v52, v53
    v_cvt_pk_bf16_f32 v11, v54, v55
    v_cvt_pk_bf16_f32 v12, v56, v57
    v_cvt_pk_bf16_f32 v13, v58, v59
    v_cvt_pk_bf16_f32 v14, v60, v61
    v_cvt_pk_bf16_f32 v15, v62, v63
    v_cvt_pk_bf16_f32 v16, v64, v65
    v_cvt_pk_bf16_f32 v17, v66, v67
    v_cvt_pk_bf16_f32 v18, v68, v69
    v_cvt_pk_bf16_f32 v19, v70, v71
    v_cvt_pk_bf16_f32 v20, v72, v73
    v_cvt_pk_bf16_f32 v21, v74, v75
    v_cvt_pk_bf16_f32 v22, v76, v77
    v_cvt_pk_bf16_f32 v23, v78, v79
    v_cvt_pk_bf16_f32 v24, v80, v81
    v_cvt_pk_bf16_f32 v25, v82, v83
    v_cvt_pk_bf16_f32 v26, v84, v85
    v_cvt_pk_bf16_f32 v27, v86, v87
    v_cvt_pk_bf16_f32 v28, v88, v89
    v_cvt_pk_bf16_f32 v29, v90, v91
    v_cvt_pk_bf16_f32 v30, v92, v93
    v_cvt_pk_bf16_f32 v31, v94, v95
    v_cvt_pk_bf16_f32 v32, v96, v97
    v_cvt_pk_bf16_f32 v33, v98, v99
    v_cvt_pk_bf16_f32 v34, v100, v101
    v_cvt_pk_bf16_f32 v35, v102, v103
    v_cvt_pk_bf16_f32 v36, v104, v105
    v_cvt_pk_bf16_f32 v37, v106, v107
    v_cvt_pk_bf16_f32 v38, v108, v109
    v_cvt_pk_bf16_f32 v39, v110, v111
    v_lshrrev_b32 v5, 1, v4
    v_lshlrev_b32 v5, 10, v5
    v_and_b32 v4, 1, v4
    v_lshl_add_u32 v5, v4, 9, v5
    v_lshl_add_u32 v5, v2, 4, v5
    s_lshl_b32 s20, s12, 15
    s_add_u32 s20, s20, 0x3000000
    buffer_store_dwordx4 v[8:11], v5, s[4:7], s20 offen sc1
    s_add_u32 s20, s20, 4096
    buffer_store_dwordx4 v[12:15], v5, s[4:7], s20 offen sc1
    s_add_u32 s20, s20, 4096
    buffer_store_dwordx4 v[16:19], v5, s[4:7], s20 offen sc1
    s_add_u32 s20, s20, 4096
    buffer_store_dwordx4 v[20:23], v5, s[4:7], s20 offen sc1
    s_add_u32 s20, s20, 4096
    buffer_store_dwordx4 v[24:27], v5, s[4:7], s20 offen sc1
    s_add_u32 s20, s20, 4096
    buffer_store_dwordx4 v[28:31], v5, s[4:7], s20 offen sc1
    s_add_u32 s20, s20, 4096
    buffer_store_dwordx4 v[32:35], v5, s[4:7], s20 offen sc1
    s_add_u32 s20, s20, 4096
    buffer_store_dwordx4 v[36:39], v5, s[4:7], s20 offen sc1
    v_and_b32 v2, 7, v0
    s_lshl_b32 s21, s3, 3
    v_add_u32 v2, s21, v2
    v_mul_u32_u24 v3, 1088, v2
    v_lshrrev_b32 v4, 3, v0
    v_lshl_add_u32 v3, v4, 4, v3
    v_add_u32 v3, 34816, v3
    s_waitcnt vmcnt(8)
    ds_read_b128 v[8:11], v3 offset:0
    ds_read_b128 v[12:15], v3 offset:128
    ds_read_b128 v[16:19], v3 offset:256
    ds_read_b128 v[20:23], v3 offset:384
    ds_read_b128 v[24:27], v3 offset:512
    ds_read_b128 v[28:31], v3 offset:640
    ds_read_b128 v[32:35], v3 offset:768
    ds_read_b128 v[36:39], v3 offset:896
    s_waitcnt lgkmcnt(7)
    v_lshlrev_b32 v48, 16, v8
    v_and_b32 v49, 0xffff0000, v8
    v_lshlrev_b32 v50, 16, v9
    v_and_b32 v51, 0xffff0000, v9
    v_lshlrev_b32 v52, 16, v10
    v_and_b32 v53, 0xffff0000, v10
    v_lshlrev_b32 v54, 16, v11
    v_and_b32 v55, 0xffff0000, v11
    s_waitcnt lgkmcnt(6)
    v_lshlrev_b32 v56, 16, v12
    v_and_b32 v57, 0xffff0000, v12
    v_lshlrev_b32 v58, 16, v13
    v_and_b32 v59, 0xffff0000, v13
    v_lshlrev_b32 v60, 16, v14
    v_and_b32 v61, 0xffff0000, v14
    v_lshlrev_b32 v62, 16, v15
    v_and_b32 v63, 0xffff0000, v15
    s_waitcnt lgkmcnt(5)
    v_lshlrev_b32 v64, 16, v16
    v_and_b32 v65, 0xffff0000, v16
    v_lshlrev_b32 v66, 16, v17
    v_and_b32 v67, 0xffff0000, v17
    v_lshlrev_b32 v68, 16, v18
    v_and_b32 v69, 0xffff0000, v18
    v_lshlrev_b32 v70, 16, v19
    v_and_b32 v71, 0xffff0000, v19
    s_waitcnt lgkmcnt(4)
    v_lshlrev_b32 v72, 16, v20
    v_and_b32 v73, 0xffff0000, v20
    v_lshlrev_b32 v74, 16, v21
    v_and_b32 v75, 0xffff0000, v21
    v_lshlrev_b32 v76, 16, v22
    v_and_b32 v77, 0xffff0000, v22
    v_lshlrev_b32 v78, 16, v23
    v_and_b32 v79, 0xffff0000, v23
    s_waitcnt lgkmcnt(3)
    v_lshlrev_b32 v80, 16, v24
    v_and_b32 v81, 0xffff0000, v24
    v_lshlrev_b32 v82, 16, v25
    v_and_b32 v83, 0xffff0000, v25
    v_lshlrev_b32 v84, 16, v26
    v_and_b32 v85, 0xffff0000, v26
    v_lshlrev_b32 v86, 16, v27
    v_and_b32 v87, 0xffff0000, v27
    s_waitcnt lgkmcnt(2)
    v_lshlrev_b32 v88, 16, v28
    v_and_b32 v89, 0xffff0000, v28
    v_lshlrev_b32 v90, 16, v29
    v_and_b32 v91, 0xffff0000, v29
    v_lshlrev_b32 v92, 16, v30
    v_and_b32 v93, 0xffff0000, v30
    v_lshlrev_b32 v94, 16, v31
    v_and_b32 v95, 0xffff0000, v31
    s_waitcnt lgkmcnt(1)
    v_lshlrev_b32 v96, 16, v32
    v_and_b32 v97, 0xffff0000, v32
    v_lshlrev_b32 v98, 16, v33
    v_and_b32 v99, 0xffff0000, v33
    v_lshlrev_b32 v100, 16, v34
    v_and_b32 v101, 0xffff0000, v34
    v_lshlrev_b32 v102, 16, v35
    v_and_b32 v103, 0xffff0000, v35
    s_waitcnt lgkmcnt(0)
    v_lshlrev_b32 v104, 16, v36
    v_and_b32 v105, 0xffff0000, v36
    v_lshlrev_b32 v106, 16, v37
    v_and_b32 v107, 0xffff0000, v37
    v_lshlrev_b32 v108, 16, v38
    v_and_b32 v109, 0xffff0000, v38
    v_lshlrev_b32 v110, 16, v39
    v_and_b32 v111, 0xffff0000, v39
    v_pk_add_f32 v[6:7], v[48:49], v[50:51]
    v_pk_add_f32 v[6:7], v[6:7], v[52:53]
    v_pk_add_f32 v[6:7], v[6:7], v[54:55]
    v_pk_add_f32 v[6:7], v[6:7], v[56:57]
    v_pk_add_f32 v[6:7], v[6:7], v[58:59]
    v_pk_add_f32 v[6:7], v[6:7], v[60:61]
    v_pk_add_f32 v[6:7], v[6:7], v[62:63]
    v_pk_add_f32 v[6:7], v[6:7], v[64:65]
    v_pk_add_f32 v[6:7], v[6:7], v[66:67]
    v_pk_add_f32 v[6:7], v[6:7], v[68:69]
    v_pk_add_f32 v[6:7], v[6:7], v[70:71]
    v_pk_add_f32 v[6:7], v[6:7], v[72:73]
    v_pk_add_f32 v[6:7], v[6:7], v[74:75]
    v_pk_add_f32 v[6:7], v[6:7], v[76:77]
    v_pk_add_f32 v[6:7], v[6:7], v[78:79]
    v_pk_add_f32 v[6:7], v[6:7], v[80:81]
    v_pk_add_f32 v[6:7], v[6:7], v[82:83]
    v_pk_add_f32 v[6:7], v[6:7], v[84:85]
    v_pk_add_f32 v[6:7], v[6:7], v[86:87]
    v_pk_add_f32 v[6:7], v[6:7], v[88:89]
    v_pk_add_f32 v[6:7], v[6:7], v[90:91]
    v_pk_add_f32 v[6:7], v[6:7], v[92:93]
    v_pk_add_f32 v[6:7], v[6:7], v[94:95]
    v_pk_add_f32 v[6:7], v[6:7], v[96:97]
    v_pk_add_f32 v[6:7], v[6:7], v[98:99]
    v_pk_add_f32 v[6:7], v[6:7], v[100:101]
    v_pk_add_f32 v[6:7], v[6:7], v[102:103]
    v_pk_add_f32 v[6:7], v[6:7], v[104:105]
    v_pk_add_f32 v[6:7], v[6:7], v[106:107]
    v_pk_add_f32 v[6:7], v[6:7], v[108:109]
    v_pk_add_f32 v[6:7], v[6:7], v[110:111]
    v_add_f32 v6, v6, v7
    s_nop 1
    v_add_f32_dpp v6, v6, v6 row_ror:8 row_mask:0xf bank_mask:0xf
    v_mov_b32 v5, v6
    s_nop 1
    v_permlane16_swap_b32 v5, v6
    v_add_f32 v6, v6, v5
    v_mov_b32 v5, v6
    s_nop 1
    v_permlane32_swap_b32 v5, v6
    v_add_f32 v6, v6, v5
    v_mul_f32 v6, 0x3b000000, v6
    v_pk_add_f32 v[48:49], v[48:49], v[6:7] op_sel_hi:[1,0] neg_lo:[0,1] neg_hi:[0,1]
    v_pk_add_f32 v[50:51], v[50:51], v[6:7] op_sel_hi:[1,0] neg_lo:[0,1] neg_hi:[0,1]
    v_pk_add_f32 v[52:53], v[52:53], v[6:7] op_sel_hi:[1,0] neg_lo:[0,1] neg_hi:[0,1]
    v_pk_add_f32 v[54:55], v[54:55], v[6:7] op_sel_hi:[1,0] neg_lo:[0,1] neg_hi:[0,1]
    v_pk_add_f32 v[56:57], v[56:57], v[6:7] op_sel_hi:[1,0] neg_lo:[0,1] neg_hi:[0,1]
    v_pk_add_f32 v[58:59], v[58:59], v[6:7] op_sel_hi:[1,0] neg_lo:[0,1] neg_hi:[0,1]
    v_pk_add_f32 v[60:61], v[60:61], v[6:7] op_sel_hi:[1,0] neg_lo:[0,1] neg_hi:[0,1]
    v_pk_add_f32 v[62:63], v[62:63], v[6:7] op_sel_hi:[1,0] neg_lo:[0,1] neg_hi:[0,1]
    v_pk_add_f32 v[64:65], v[64:65], v[6:7] op_sel_hi:[1,0] neg_lo:[0,1] neg_hi:[0,1]
    v_pk_add_f32 v[66:67], v[66:67], v[6:7] op_sel_hi:[1,0] neg_lo:[0,1] neg_hi:[0,1]
    v_pk_add_f32 v[68:69], v[68:69], v[6:7] op_sel_hi:[1,0] neg_lo:[0,1] neg_hi:[0,1]
    v_pk_add_f32 v[70:71], v[70:71], v[6:7] op_sel_hi:[1,0] neg_lo:[0,1] neg_hi:[0,1]
    v_pk_add_f32 v[72:73], v[72:73], v[6:7] op_sel_hi:[1,0] neg_lo:[0,1] neg_hi:[0,1]
    v_pk_add_f32 v[74:75], v[74:75], v[6:7] op_sel_hi:[1,0] neg_lo:[0,1] neg_hi:[0,1]
    v_pk_add_f32 v[76:77], v[76:77], v[6:7] op_sel_hi:[1,0] neg_lo:[0,1] neg_hi:[0,1]
    v_pk_add_f32 v[78:79], v[78:79], v[6:7] op_sel_hi:[1,0] neg_lo:[0,1] neg_hi:[0,1]
    v_pk_add_f32 v[80:81], v[80:81], v[6:7] op_sel_hi:[1,0] neg_lo:[0,1] neg_hi:[0,1]
    v_pk_add_f32 v[82:83], v[82:83], v[6:7] op_sel_hi:[1,0] neg_lo:[0,1] neg_hi:[0,1]
    v_pk_add_f32 v[84:85], v[84:85], v[6:7] op_sel_hi:[1,0] neg_lo:[0,1] neg_hi:[0,1]
    v_pk_add_f32 v[86:87], v[86:87], v[6:7] op_sel_hi:[1,0] neg_lo:[0,1] neg_hi:[0,1]
    v_pk_add_f32 v[88:89], v[88:89], v[6:7] op_sel_hi:[1,0] neg_lo:[0,1] neg_hi:[0,1]
    v_pk_add_f32 v[90:91], v[90:91], v[6:7] op_sel_hi:[1,0] neg_lo:[0,1] neg_hi:[0,1]
    v_pk_add_f32 v[92:93], v[92:93], v[6:7] op_sel_hi:[1,0] neg_lo:[0,1] neg_hi:[0,1]
    v_pk_add_f32 v[94:95], v[94:95], v[6:7] op_sel_hi:[1,0] neg_lo:[0,1] neg_hi:[0,1]
    v_pk_add_f32 v[96:97], v[96:97], v[6:7] op_sel_hi:[1,0] neg_lo:[0,1] neg_hi:[0,1]
    v_pk_add_f32 v[98:99], v[98:99], v[6:7] op_sel_hi:[1,0] neg_lo:[0,1] neg_hi:[0,1]
    v_pk_add_f32 v[100:101], v[100:101], v[6:7] op_sel_hi:[1,0] neg_lo:[0,1] neg_hi:[0,1]
    v_pk_add_f32 v[102:103], v[102:103], v[6:7] op_sel_hi:[1,0] neg_lo:[0,1] neg_hi:[0,1]
    v_pk_add_f32 v[104:105], v[104:105], v[6:7] op_sel_hi:[1,0] neg_lo:[0,1] neg_hi:[0,1]
    v_pk_add_f32 v[106:107], v[106:107], v[6:7] op_sel_hi:[1,0] neg_lo:[0,1] neg_hi:[0,1]
    v_pk_add_f32 v[108:109], v[108:109], v[6:7] op_sel_hi:[1,0] neg_lo:[0,1] neg_hi:[0,1]
    v_pk_add_f32 v[110:111], v[110:111], v[6:7] op_sel_hi:[1,0] neg_lo:[0,1] neg_hi:[0,1]
    v_pk_mul_f32 v[6:7], v[48:49], v[48:49]
    v_pk_fma_f32 v[6:7], v[50:51], v[50:51], v[6:7]
    v_pk_fma_f32 v[6:7], v[52:53], v[52:53], v[6:7]
    v_pk_fma_f32 v[6:7], v[54:55], v[54:55], v[6:7]
    v_pk_fma_f32 v[6:7], v[56:57], v[56:57], v[6:7]
    v_pk_fma_f32 v[6:7], v[58:59], v[58:59], v[6:7]
    v_pk_fma_f32 v[6:7], v[60:61], v[60:61], v[6:7]
    v_pk_fma_f32 v[6:7], v[62:63], v[62:63], v[6:7]
    v_pk_fma_f32 v[6:7], v[64:65], v[64:65], v[6:7]
    v_pk_fma_f32 v[6:7], v[66:67], v[66:67], v[6:7]
    v_pk_fma_f32 v[6:7], v[68:69], v[68:69], v[6:7]
    v_pk_fma_f32 v[6:7], v[70:71], v[70:71], v[6:7]
    v_pk_fma_f32 v[6:7], v[72:73], v[72:73], v[6:7]
    v_pk_fma_f32 v[6:7], v[74:75], v[74:75], v[6:7]
    v_pk_fma_f32 v[6:7], v[76:77], v[76:77], v[6:7]
    v_pk_fma_f32 v[6:7], v[78:79], v[78:79], v[6:7]
    v_pk_fma_f32 v[6:7], v[80:81], v[80:81], v[6:7]
    v_pk_fma_f32 v[6:7], v[82:83], v[82:83], v[6:7]
    v_pk_fma_f32 v[6:7], v[84:85], v[84:85], v[6:7]
    v_pk_fma_f32 v[6:7], v[86:87], v[86:87], v[6:7]
    v_pk_fma_f32 v[6:7], v[88:89], v[88:89], v[6:7]
    v_pk_fma_f32 v[6:7], v[90:91], v[90:91], v[6:7]
    v_pk_fma_f32 v[6:7], v[92:93], v[92:93], v[6:7]
    v_pk_fma_f32 v[6:7], v[94:95], v[94:95], v[6:7]
    v_pk_fma_f32 v[6:7], v[96:97], v[96:97], v[6:7]
    v_pk_fma_f32 v[6:7], v[98:99], v[98:99], v[6:7]
    v_pk_fma_f32 v[6:7], v[100:101], v[100:101], v[6:7]
    v_pk_fma_f32 v[6:7], v[102:103], v[102:103], v[6:7]
    v_pk_fma_f32 v[6:7], v[104:105], v[104:105], v[6:7]
    v_pk_fma_f32 v[6:7], v[106:107], v[106:107], v[6:7]
    v_pk_fma_f32 v[6:7], v[108:109], v[108:109], v[6:7]
    v_pk_fma_f32 v[6:7], v[110:111], v[110:111], v[6:7]
    v_add_f32 v6, v6, v7
    s_nop 1
    v_add_f32_dpp v6, v6, v6 row_ror:8 row_mask:0xf bank_mask:0xf
    v_mov_b32 v5, v6
    s_nop 1
    v_permlane16_swap_b32 v5, v6
    v_add_f32 v6, v6, v5
    v_mov_b32 v5, v6
    s_nop 1
    v_permlane32_swap_b32 v5, v6
    v_add_f32 v6, v6, v5
    v_mov_b32 v7, 0x3727c5ac
    v_fmac_f32 v7, 0x3b000000, v6
    v_rsq_f32 v6, v7
    s_nop 0
    v_pk_mul_f32 v[48:49], v[48:49], v[6:7] op_sel_hi:[1,0]
    v_pk_mul_f32 v[50:51], v[50:51], v[6:7] op_sel_hi:[1,0]
    v_pk_mul_f32 v[52:53], v[52:53], v[6:7] op_sel_hi:[1,0]
    v_pk_mul_f32 v[54:55], v[54:55], v[6:7] op_sel_hi:[1,0]
    v_pk_mul_f32 v[56:57], v[56:57], v[6:7] op_sel_hi:[1,0]
    v_pk_mul_f32 v[58:59], v[58:59], v[6:7] op_sel_hi:[1,0]
    v_pk_mul_f32 v[60:61], v[60:61], v[6:7] op_sel_hi:[1,0]
    v_pk_mul_f32 v[62:63], v[62:63], v[6:7] op_sel_hi:[1,0]
    v_pk_mul_f32 v[64:65], v[64:65], v[6:7] op_sel_hi:[1,0]
    v_pk_mul_f32 v[66:67], v[66:67], v[6:7] op_sel_hi:[1,0]
    v_pk_mul_f32 v[68:69], v[68:69], v[6:7] op_sel_hi:[1,0]
    v_pk_mul_f32 v[70:71], v[70:71], v[6:7] op_sel_hi:[1,0]
    v_pk_mul_f32 v[72:73], v[72:73], v[6:7] op_sel_hi:[1,0]
    v_pk_mul_f32 v[74:75], v[74:75], v[6:7] op_sel_hi:[1,0]
    v_pk_mul_f32 v[76:77], v[76:77], v[6:7] op_sel_hi:[1,0]
    v_pk_mul_f32 v[78:79], v[78:79], v[6:7] op_sel_hi:[1,0]
    v_pk_mul_f32 v[80:81], v[80:81], v[6:7] op_sel_hi:[1,0]
    v_pk_mul_f32 v[82:83], v[82:83], v[6:7] op_sel_hi:[1,0]
    v_pk_mul_f32 v[84:85], v[84:85], v[6:7] op_sel_hi:[1,0]
    v_pk_mul_f32 v[86:87], v[86:87], v[6:7] op_sel_hi:[1,0]
    v_pk_mul_f32 v[88:89], v[88:89], v[6:7] op_sel_hi:[1,0]
    v_pk_mul_f32 v[90:91], v[90:91], v[6:7] op_sel_hi:[1,0]
    v_pk_mul_f32 v[92:93], v[92:93], v[6:7] op_sel_hi:[1,0]
    v_pk_mul_f32 v[94:95], v[94:95], v[6:7] op_sel_hi:[1,0]
    v_pk_mul_f32 v[96:97], v[96:97], v[6:7] op_sel_hi:[1,0]
    v_pk_mul_f32 v[98:99], v[98:99], v[6:7] op_sel_hi:[1,0]
    v_pk_mul_f32 v[100:101], v[100:101], v[6:7] op_sel_hi:[1,0]
    v_pk_mul_f32 v[102:103], v[102:103], v[6:7] op_sel_hi:[1,0]
    v_pk_mul_f32 v[104:105], v[104:105], v[6:7] op_sel_hi:[1,0]
    v_pk_mul_f32 v[106:107], v[106:107], v[6:7] op_sel_hi:[1,0]
    v_pk_mul_f32 v[108:109], v[108:109], v[6:7] op_sel_hi:[1,0]
    v_pk_mul_f32 v[110:111], v[110:111], v[6:7] op_sel_hi:[1,0]
    v_cvt_pk_bf16_f32 v8, v48, v49
    v_cvt_pk_bf16_f32 v9, v50, v51
    v_cvt_pk_bf16_f32 v10, v52, v53
    v_cvt_pk_bf16_f32 v11, v54, v55
    v_cvt_pk_bf16_f32 v12, v56, v57
    v_cvt_pk_bf16_f32 v13, v58, v59
    v_cvt_pk_bf16_f32 v14, v60, v61
    v_cvt_pk_bf16_f32 v15, v62, v63
    v_cvt_pk_bf16_f32 v16, v64, v65
    v_cvt_pk_bf16_f32 v17, v66, v67
    v_cvt_pk_bf16_f32 v18, v68, v69
    v_cvt_pk_bf16_f32 v19, v70, v71
    v_cvt_pk_bf16_f32 v20, v72, v73
    v_cvt_pk_bf16_f32 v21, v74, v75
    v_cvt_pk_bf16_f32 v22, v76, v77
    v_cvt_pk_bf16_f32 v23, v78, v79
    v_cvt_pk_bf16_f32 v24, v80, v81
    v_cvt_pk_bf16_f32 v25, v82, v83
    v_cvt_pk_bf16_f32 v26, v84, v85
    v_cvt_pk_bf16_f32 v27, v86, v87
    v_cvt_pk_bf16_f32 v28, v88, v89
    v_cvt_pk_bf16_f32 v29, v90, v91
    v_cvt_pk_bf16_f32 v30, v92, v93
    v_cvt_pk_bf16_f32 v31, v94, v95
    v_cvt_pk_bf16_f32 v32, v96, v97
    v_cvt_pk_bf16_f32 v33, v98, v99
    v_cvt_pk_bf16_f32 v34, v100, v101
    v_cvt_pk_bf16_f32 v35, v102, v103
    v_cvt_pk_bf16_f32 v36, v104, v105
    v_cvt_pk_bf16_f32 v37, v106, v107
    v_cvt_pk_bf16_f32 v38, v108, v109
    v_cvt_pk_bf16_f32 v39, v110, v111
    v_lshrrev_b32 v5, 1, v4
    v_lshlrev_b32 v5, 10, v5
    v_and_b32 v4, 1, v4
    v_lshl_add_u32 v5, v4, 9, v5
    v_lshl_add_u32 v5, v2, 4, v5
    s_lshl_b32 s20, s13, 15
    s_add_u32 s20, s20, 0x3000000
    buffer_store_dwordx4 v[8:11], v5, s[4:7], s20 offen sc1
    s_add_u32 s20, s20, 4096
    buffer_store_dwordx4 v[12:15], v5, s[4:7], s20 offen sc1
    s_add_u32 s20, s20, 4096
    buffer_store_dwordx4 v[16:19], v5, s[4:7], s20 offen sc1
    s_add_u32 s20, s20, 4096
    buffer_store_dwordx4 v[20:23], v5, s[4:7], s20 offen sc1
    s_add_u32 s20, s20, 4096
    buffer_store_dwordx4 v[24:27], v5, s[4:7], s20 offen sc1
    s_add_u32 s20, s20, 4096
    buffer_store_dwordx4 v[28:31], v5, s[4:7], s20 offen sc1
    s_add_u32 s20, s20, 4096
    buffer_store_dwordx4 v[32:35], v5, s[4:7], s20 offen sc1
    s_add_u32 s20, s20, 4096
    buffer_store_dwordx4 v[36:39], v5, s[4:7], s20 offen sc1
    s_waitcnt vmcnt(8)
    s_barrier
    s_load_dwordx2 s[96:97], s[0:1], 96
    v_mov_b32 v120, 196
    v_mov_b32 v121, 1
    v_or_b32 v122, s3, v0
    s_waitcnt lgkmcnt(0)
    v_cmp_eq_u32 vcc, 0, v122
    s_and_saveexec_b64 s[98:99], vcc
    s_cbranch_execz L_ADLN0
    global_atomic_add v120, v121, s[96:97]
L_ADLN0:
    s_mov_b64 exec, s[98:99]
    s_waitcnt vmcnt(0)
    s_barrier
    s_load_dwordx2 s[96:97], s[0:1], 96
    v_mov_b32 v120, 200
    v_mov_b32 v121, 1
    v_or_b32 v122, s3, v0
    s_waitcnt lgkmcnt(0)
    v_cmp_eq_u32 vcc, 0, v122
    s_and_saveexec_b64 s[98:99], vcc
    s_cbranch_execz L_ADLN1
    global_atomic_add v120, v121, s[96:97]
L_ADLN1:
    s_mov_b64 exec, s[98:99]
    s_load_dwordx2 s[96:97], s[0:1], 96
    v_mov_b32 v120, 192
    s_mov_b32 s94, 0
    s_waitcnt lgkmcnt(0)
L_WDL:
    global_load_dword v121, v120, s[96:97] sc1
    s_waitcnt vmcnt(0)
    v_readfirstlane_b32 s95, v121
    s_add_u32 s94, s94, 1
    s_cmp_gt_u32 s94, 2000000
    s_cbranch_scc1 L_GBAIL
    s_cmp_ge_u32 s95, 256
    s_cbranch_scc1 L_WDOKL
    s_sleep 4
    s_branch L_WDL
L_WDOKL:
    s_mov_b32 s27, 0x4410000
    s_mov_b32 s26, 1
    s_cmp_eq_u32 s3, 0
    s_cbranch_scc0 L_P2OKLATE
    s_mov_b32 s24, 0
L_P2POLLLATE:
    buffer_load_dword v16, off, s[4:7], s27 sc1
    s_waitcnt vmcnt(0)
    v_readfirstlane_b32 s22, v16
    s_nop 0
    s_cmp_ge_u32 s22, s26
    s_cbranch_scc1 L_P2OKLATE
    s_sleep 4
    s_add_u32 s24, s24, 1
    s_cmp_lt_u32 s24, 400000
    s_cbranch_scc1 L_P2POLLLATE
    s_branch L_P2BAIL
L_P2OKLATE:
    s_barrier
L_P2:
    s_barrier
    s_mov_b32 s12, s80
    s_mov_b32 s13, s81
    s_load_dwordx2 s[8:9], s[0:1], 0
    s_mov_b32 s10, 0x200000
    s_mov_b32 s11, 0x20000
    s_waitcnt lgkmcnt(0)
    s_load_dwordx2 s[40:41], s[0:1], 88
    s_mov_b32 s42, 0x200000
    s_mov_b32 s43, 0x20000
    s_waitcnt lgkmcnt(0)
    s_load_dwordx2 s[48:49], s[0:1], 40
    s_load_dwordx4 s[52:55], s[0:1], 64
    s_load_dwordx2 s[56:57], s[0:1], 80
    v_lshlrev_b32 v1, 4, v0
    v_xor_b32 v16, 0, v0
    v_lshlrev_b32 v32, 4, v16
    v_xor_b32 v16, 4, v0
    v_lshlrev_b32 v33, 4, v16
    v_xor_b32 v16, 8, v0
    v_lshlrev_b32 v34, 4, v16
    v_xor_b32 v16, 12, v0
    v_lshlrev_b32 v35, 4, v16
    v_lshrrev_b32 v16, 3, v0
    v_mul_u32_u24 v16, 2752, v16
    v_and_b32 v17, 7, v0
    v_lshl_add_u32 v36, v17, 4, v16
    v_lshrrev_b32 v16, 2, v0
    v_lshlrev_b32 v40, 10, v16
    v_bfe_u32 v16, v0, 2, 2
    v_xor_b32 v16, 0, v16
    v_lshlrev_b32 v16, 2, v16
    v_and_b32 v17, 3, v0
    v_add_u32 v16, v16, v17
    s_lshl_b32 s20, s3, 4
    v_add_u32 v16, s20, v16
    v_lshl_add_u32 v40, v16, 4, v40
    v_lshrrev_b32 v16, 2, v0
    v_lshlrev_b32 v41, 10, v16
    v_bfe_u32 v16, v0, 2, 2
    v_xor_b32 v16, 1, v16
    v_lshlrev_b32 v16, 2, v16
    v_and_b32 v17, 3, v0
    v_add_u32 v16, v16, v17
    s_lshl_b32 s20, s3, 4
    v_add_u32 v16, s20, v16
    v_lshl_add_u32 v41, v16, 4, v41
    v_lshrrev_b32 v16, 2, v0
    v_lshlrev_b32 v42, 10, v16
    v_bfe_u32 v16, v0, 2, 2
    v_xor_b32 v16, 2, v16
    v_lshlrev_b32 v16, 2, v16
    v_and_b32 v17, 3, v0
    v_add_u32 v16, v16, v17
    s_lshl_b32 s20, s3, 4
    v_add_u32 v16, s20, v16
    v_lshl_add_u32 v42, v16, 4, v42
    v_lshrrev_b32 v16, 2, v0
    v_lshlrev_b32 v43, 10, v16
    v_bfe_u32 v16, v0, 2, 2
    v_xor_b32 v16, 3, v16
    v_lshlrev_b32 v16, 2, v16
    v_and_b32 v17, 3, v0
    v_add_u32 v16, v16, v17
    s_lshl_b32 s20, s3, 4
    v_add_u32 v16, s20, v16
    v_lshl_add_u32 v43, v16, 4, v43
    v_lshrrev_b32 v16, 4, v0
    v_lshlrev_b32 v16, 3, v16
    v_bfe_u32 v17, v0, 2, 2
    v_add_u32 v16, v16, v17
    v_lshlrev_b32 v16, 7, v16
    v_and_b32 v17, 3, v0
    v_lshl_add_u32 v16, v17, 3, v16
    s_lshl_b32 s20, s3, 5
    v_add_u32 v44, s20, v16
    s_waitcnt lgkmcnt(0)
    s_mov_b32 s50, 0x400000
    s_mov_b32 s51, 0x20000
    s_mov_b32 s60, s52
    s_mov_b32 s61, s53
    s_mov_b32 s62, 1409024
    s_mov_b32 s63, 0x20000
    s_mov_b32 s52, s54
    s_mov_b32 s53, s55
    s_mov_b32 s54, 1409024
    s_mov_b32 s55, 0x20000
    s_mov_b32 s58, 1409024
    s_mov_b32 s59, 0x20000
    s_cmp_lt_u32 s3, 2
    s_cselect_b32 s44, s60, s52
    s_cselect_b32 s45, s61, s53
    s_mov_b32 s46, 1409024
    s_mov_b32 s47, 0x20000
    s_lshl_b32 s23, s3, 13
    s_add_u32 s23, s23, 0
    s_lshl_b32 s20, s13, 7
    s_lshl_b32 s21, s3, 3
    s_add_u32 s20, s20, s21
    s_add_u32 s20, s20, 0
    s_lshl_b32 s20, s20, 10
    s_mov_b32 m0, s23
    s_add_u32 s23, s23, 1024
    buffer_load_dwordx4 v32, s[48:51], s20 offen lds
    s_add_u32 s20, s20, 1024
    s_mov_b32 m0, s23
    s_add_u32 s23, s23, 1024
    buffer_load_dwordx4 v33, s[48:51], s20 offen lds
    s_add_u32 s20, s20, 1024
    s_mov_b32 m0, s23
    s_add_u32 s23, s23, 1024
    buffer_load_dwordx4 v34, s[48:51], s20 offen lds
    s_add_u32 s20, s20, 1024
    s_mov_b32 m0, s23
    s_add_u32 s23, s23, 1024
    buffer_load_dwordx4 v35, s[48:51], s20 offen lds
    s_add_u32 s20, s20, 1024
    s_mov_b32 m0, s23
    s_add_u32 s23, s23, 1024
    buffer_load_dwordx4 v32, s[48:51], s20 offen lds
    s_add_u32 s20, s20, 1024
    s_mov_b32 m0, s23
    s_add_u32 s23, s23, 1024
    buffer_load_dwordx4 v33, s[48:51], s20 offen lds
    s_add_u32 s20, s20, 1024
    s_mov_b32 m0, s23
    s_add_u32 s23, s23, 1024
    buffer_load_dwordx4 v34, s[48:51], s20 offen lds
    s_add_u32 s20, s20, 1024
    s_mov_b32 m0, s23
    s_add_u32 s23, s23, 1024
    buffer_load_dwordx4 v35, s[48:51], s20 offen lds
    s_add_u32 s20, s20, 1024
    s_lshl_b32 s23, s3, 13
    s_add_u32 s23, s23, 32768
    s_lshl_b32 s20, s13, 7
    s_lshl_b32 s21, s3, 3
    s_add_u32 s20, s20, s21
    s_add_u32 s20, s20, 32
    s_lshl_b32 s20, s20, 10
    s_mov_b32 m0, s23
    s_add_u32 s23, s23, 1024
    buffer_load_dwordx4 v32, s[48:51], s20 offen lds
    s_add_u32 s20, s20, 1024
    s_mov_b32 m0, s23
    s_add_u32 s23, s23, 1024
    buffer_load_dwordx4 v33, s[48:51], s20 offen lds
    s_add_u32 s20, s20, 1024
    s_mov_b32 m0, s23
    s_add_u32 s23, s23, 1024
    buffer_load_dwordx4 v34, s[48:51], s20 offen lds
    s_add_u32 s20, s20, 1024
    s_mov_b32 m0, s23
    s_add_u32 s23, s23, 1024
    buffer_load_dwordx4 v35, s[48:51], s20 offen lds
    s_add_u32 s20, s20, 1024
    s_mov_b32 m0, s23
    s_add_u32 s23, s23, 1024
    buffer_load_dwordx4 v32, s[48:51], s20 offen lds
    s_add_u32 s20, s20, 1024
    s_mov_b32 m0, s23
    s_add_u32 s23, s23, 1024
    buffer_load_dwordx4 v33, s[48:51], s20 offen lds
    s_add_u32 s20, s20, 1024
    s_mov_b32 m0, s23
    s_add_u32 s23, s23, 1024
    buffer_load_dwordx4 v34, s[48:51], s20 offen lds
    s_add_u32 s20, s20, 1024
    s_mov_b32 m0, s23
    s_add_u32 s23, s23, 1024
    buffer_load_dwordx4 v35, s[48:51], s20 offen lds
    s_add_u32 s20, s20, 1024
    s_lshl_b32 s23, s3, 13
    s_add_u32 s23, s23, 65536
    s_lshl_b32 s20, s13, 7
    s_lshl_b32 s21, s3, 3
    s_add_u32 s20, s20, s21
    s_add_u32 s20, s20, 64
    s_lshl_b32 s20, s20, 10
    s_mov_b32 m0, s23
    s_add_u32 s23, s23, 1024
    buffer_load_dwordx4 v32, s[48:51], s20 offen lds
    s_add_u32 s20, s20, 1024
    s_mov_b32 m0, s23
    s_add_u32 s23, s23, 1024
    buffer_load_dwordx4 v33, s[48:51], s20 offen lds
    s_add_u32 s20, s20, 1024
    s_mov_b32 m0, s23
    s_add_u32 s23, s23, 1024
    buffer_load_dwordx4 v34, s[48:51], s20 offen lds
    s_add_u32 s20, s20, 1024
    s_mov_b32 m0, s23
    s_add_u32 s23, s23, 1024
    buffer_load_dwordx4 v35, s[48:51], s20 offen lds
    s_add_u32 s20, s20, 1024
    s_mov_b32 m0, s23
    s_add_u32 s23, s23, 1024
    buffer_load_dwordx4 v32, s[48:51], s20 offen lds
    s_add_u32 s20, s20, 1024
    s_mov_b32 m0, s23
    s_add_u32 s23, s23, 1024
    buffer_load_dwordx4 v33, s[48:51], s20 offen lds
    s_add_u32 s20, s20, 1024
    s_mov_b32 m0, s23
    s_add_u32 s23, s23, 1024
    buffer_load_dwordx4 v34, s[48:51], s20 offen lds
    s_add_u32 s20, s20, 1024
    s_mov_b32 m0, s23
    s_add_u32 s23, s23, 1024
    buffer_load_dwordx4 v35, s[48:51], s20 offen lds
    s_add_u32 s20, s20, 1024
    s_lshl_b32 s23, s3, 13
    s_add_u32 s23, s23, 98304
    s_lshl_b32 s20, s13, 7
    s_lshl_b32 s21, s3, 3
    s_add_u32 s20, s20, s21
    s_add_u32 s20, s20, 96
    s_lshl_b32 s20, s20, 10
    s_mov_b32 m0, s23
    s_add_u32 s23, s23, 1024
    buffer_load_dwordx4 v32, s[48:51], s20 offen lds
    s_add_u32 s20, s20, 1024
    s_mov_b32 m0, s23
    s_add_u32 s23, s23, 1024
    buffer_load_dwordx4 v33, s[48:51], s20 offen lds
    s_add_u32 s20, s20, 1024
    s_mov_b32 m0, s23
    s_add_u32 s23, s23, 1024
    buffer_load_dwordx4 v34, s[48:51], s20 offen lds
    s_add_u32 s20, s20, 1024
    s_mov_b32 m0, s23
    s_add_u32 s23, s23, 1024
    buffer_load_dwordx4 v35, s[48:51], s20 offen lds
    s_add_u32 s20, s20, 1024
    s_mov_b32 m0, s23
    s_add_u32 s23, s23, 1024
    buffer_load_dwordx4 v32, s[48:51], s20 offen lds
    s_add_u32 s20, s20, 1024
    s_mov_b32 m0, s23
    s_add_u32 s23, s23, 1024
    buffer_load_dwordx4 v33, s[48:51], s20 offen lds
    s_add_u32 s20, s20, 1024
    s_mov_b32 m0, s23
    s_add_u32 s23, s23, 1024
    buffer_load_dwordx4 v34, s[48:51], s20 offen lds
    s_add_u32 s20, s20, 1024
    s_mov_b32 m0, s23
    s_add_u32 s23, s23, 1024
    buffer_load_dwordx4 v35, s[48:51], s20 offen lds
    s_add_u32 s20, s20, 1024
    s_lshl_b32 s23, s3, 13
    s_add_u32 s23, s23, 131072
    s_lshl_b32 s20, s13, 6
    s_lshl_b32 s21, s3, 3
    s_add_u32 s20, s20, s21
    s_add_u32 s20, s20, 0
    s_lshl_b32 s20, s20, 10
    s_mov_b32 m0, s23
    s_add_u32 s23, s23, 1024
    buffer_load_dwordx4 v32, s[56:59], s20 offen lds
    s_add_u32 s20, s20, 1024
    s_mov_b32 m0, s23
    s_add_u32 s23, s23, 1024
    buffer_load_dwordx4 v33, s[56:59], s20 offen lds
    s_add_u32 s20, s20, 1024
    s_mov_b32 m0, s23
    s_add_u32 s23, s23, 1024
    buffer_load_dwordx4 v34, s[56:59], s20 offen lds
    s_add_u32 s20, s20, 1024
    s_mov_b32 m0, s23
    s_add_u32 s23, s23, 1024
    buffer_load_dwordx4 v35, s[56:59], s20 offen lds
    s_add_u32 s20, s20, 1024
    s_mov_b32 m0, s23
    s_add_u32 s23, s23, 1024
    buffer_load_dwordx4 v32, s[56:59], s20 offen lds
    s_add_u32 s20, s20, 1024
    s_mov_b32 m0, s23
    s_add_u32 s23, s23, 1024
    buffer_load_dwordx4 v33, s[56:59], s20 offen lds
    s_add_u32 s20, s20, 1024
    s_mov_b32 m0, s23
    s_add_u32 s23, s23, 1024
    buffer_load_dwordx4 v34, s[56:59], s20 offen lds
    s_add_u32 s20, s20, 1024
    s_mov_b32 m0, s23
    s_add_u32 s23, s23, 1024
    buffer_load_dwordx4 v35, s[56:59], s20 offen lds
    s_add_u32 s20, s20, 1024
    s_waitcnt vmcnt(32)
    s_barrier
    v_add_u32 v48, 0, v40
    v_add_u32 v49, 0, v41
    v_add_u32 v50, 0, v42
    v_add_u32 v51, 0, v43
    ds_read_b64_tr_b16 a[0:1], v48 offset:0
    ds_read_b64_tr_b16 a[2:3], v48 offset:16384
    ds_read_b64_tr_b16 a[16:17], v48 offset:8
    ds_read_b64_tr_b16 a[18:19], v48 offset:16392
    ds_read_b64_tr_b16 a[32:33], v49 offset:0
    ds_read_b64_tr_b16 a[34:35], v49 offset:16384
    ds_read_b64_tr_b16 a[48:49], v49 offset:8
    ds_read_b64_tr_b16 a[50:51], v49 offset:16392
    ds_read_b64_tr_b16 a[64:65], v50 offset:0
    ds_read_b64_tr_b16 a[66:67], v50 offset:16384
    ds_read_b64_tr_b16 a[80:81], v50 offset:8
    ds_read_b64_tr_b16 a[82:83], v50 offset:16392
    ds_read_b64_tr_b16 a[96:97], v51 offset:0
    ds_read_b64_tr_b16 a[98:99], v51 offset:16384
    ds_read_b64_tr_b16 a[112:113], v51 offset:8
    ds_read_b64_tr_b16 a[114:115], v51 offset:16392
    s_waitcnt lgkmcnt(0)
    s_barrier
    s_lshl_b32 s23, s3, 13
    s_add_u32 s23, s23, 0
    s_lshl_b32 s20, s13, 6
    s_lshl_b32 s21, s3, 3
    s_add_u32 s20, s20, s21
    s_add_u32 s20, s20, 32
    s_lshl_b32 s20, s20, 10
    s_mov_b32 m0, s23
    s_add_u32 s23, s23, 1024
    buffer_load_dwordx4 v32, s[56:59], s20 offen lds
    s_add_u32 s20, s20, 1024
    s_mov_b32 m0, s23
    s_add_u32 s23, s23, 1024
    buffer_load_dwordx4 v33, s[56:59], s20 offen lds
    s_add_u32 s20, s20, 1024
    s_mov_b32 m0, s23
    s_add_u32 s23, s23, 1024
    buffer_load_dwordx4 v34, s[56:59], s20 offen lds
    s_add_u32 s20, s20, 1024
    s_mov_b32 m0, s23
    s_add_u32 s23, s23, 1024
    buffer_load_dwordx4 v35, s[56:59], s20 offen lds
    s_add_u32 s20, s20, 1024
    s_mov_b32 m0, s23
    s_add_u32 s23, s23, 1024
    buffer_load_dwordx4 v32, s[56:59], s20 offen lds
    s_add_u32 s20, s20, 1024
    s_mov_b32 m0, s23
    s_add_u32 s23, s23, 1024
    buffer_load_dwordx4 v33, s[56:59], s20 offen lds
    s_add_u32 s20, s20, 1024
    s_mov_b32 m0, s23
    s_add_u32 s23, s23, 1024
    buffer_load_dwordx4 v34, s[56:59], s20 offen lds
    s_add_u32 s20, s20, 1024
    s_mov_b32 m0, s23
    s_add_u32 s23, s23, 1024
    buffer_load_dwordx4 v35, s[56:59], s20 offen lds
    s_add_u32 s20, s20, 1024
    s_waitcnt vmcnt(32)
    s_barrier
    v_add_u32 v48, 32768, v40
    v_add_u32 v49, 32768, v41
    v_add_u32 v50, 32768, v42
    v_add_u32 v51, 32768, v43
    ds_read_b64_tr_b16 a[4:5], v48 offset:0
    ds_read_b64_tr_b16 a[6:7], v48 offset:16384
    ds_read_b64_tr_b16 a[20:21], v48 offset:8
    ds_read_b64_tr_b16 a[22:23], v48 offset:16392
    ds_read_b64_tr_b16 a[36:37], v49 offset:0
    ds_read_b64_tr_b16 a[38:39], v49 offset:16384
    ds_read_b64_tr_b16 a[52:53], v49 offset:8
    ds_read_b64_tr_b16 a[54:55], v49 offset:16392
    ds_read_b64_tr_b16 a[68:69], v50 offset:0
    ds_read_b64_tr_b16 a[70:71], v50 offset:16384
    ds_read_b64_tr_b16 a[84:85], v50 offset:8
    ds_read_b64_tr_b16 a[86:87], v50 offset:16392
    ds_read_b64_tr_b16 a[100:101], v51 offset:0
    ds_read_b64_tr_b16 a[102:103], v51 offset:16384
    ds_read_b64_tr_b16 a[116:117], v51 offset:8
    ds_read_b64_tr_b16 a[118:119], v51 offset:16392
    s_waitcnt lgkmcnt(0)
    s_barrier
    s_lshl_b32 s23, s3, 13
    s_add_u32 s23, s23, 32768
    s_and_b32 s20, s3, 1
    s_lshl_b32 s20, s20, 6
    s_add_u32 s20, s20, 0
    s_mul_i32 s20, s20, 2752
    s_lshl_b32 s21, s13, 7
    s_add_u32 s20, s20, s21
    s_mov_b32 m0, s23
    s_add_u32 s23, s23, 1024
    buffer_load_dwordx4 v36, s[44:47], s20 offen lds
    s_add_u32 s20, s20, 22016
    s_mov_b32 m0, s23
    s_add_u32 s23, s23, 1024
    buffer_load_dwordx4 v36, s[44:47], s20 offen lds
    s_add_u32 s20, s20, 22016
    s_mov_b32 m0, s23
    s_add_u32 s23, s23, 1024
    buffer_load_dwordx4 v36, s[44:47], s20 offen lds
    s_add_u32 s20, s20, 22016
    s_mov_b32 m0, s23
    s_add_u32 s23, s23, 1024
    buffer_load_dwordx4 v36, s[44:47], s20 offen lds
    s_add_u32 s20, s20, 22016
    s_mov_b32 m0, s23
    s_add_u32 s23, s23, 1024
    buffer_load_dwordx4 v36, s[44:47], s20 offen lds
    s_add_u32 s20, s20, 22016
    s_mov_b32 m0, s23
    s_add_u32 s23, s23, 1024
    buffer_load_dwordx4 v36, s[44:47], s20 offen lds
    s_add_u32 s20, s20, 22016
    s_mov_b32 m0, s23
    s_add_u32 s23, s23, 1024
    buffer_load_dwordx4 v36, s[44:47], s20 offen lds
    s_add_u32 s20, s20, 22016
    s_mov_b32 m0, s23
    s_add_u32 s23, s23, 1024
    buffer_load_dwordx4 v36, s[44:47], s20 offen lds
    s_add_u32 s20, s20, 22016
    s_waitcnt vmcnt(32)
    s_barrier
    v_add_u32 v48, 65536, v40
    v_add_u32 v49, 65536, v41
    v_add_u32 v50, 65536, v42
    v_add_u32 v51, 65536, v43
    ds_read_b64_tr_b16 a[8:9], v48 offset:0
    ds_read_b64_tr_b16 a[10:11], v48 offset:16384
    ds_read_b64_tr_b16 a[24:25], v48 offset:8
    ds_read_b64_tr_b16 a[26:27], v48 offset:16392
    ds_read_b64_tr_b16 a[40:41], v49 offset:0
    ds_read_b64_tr_b16 a[42:43], v49 offset:16384
    ds_read_b64_tr_b16 a[56:57], v49 offset:8
    ds_read_b64_tr_b16 a[58:59], v49 offset:16392
    ds_read_b64_tr_b16 a[72:73], v50 offset:0
    ds_read_b64_tr_b16 a[74:75], v50 offset:16384
    ds_read_b64_tr_b16 a[88:89], v50 offset:8
    ds_read_b64_tr_b16 a[90:91], v50 offset:16392
    ds_read_b64_tr_b16 a[104:105], v51 offset:0
    ds_read_b64_tr_b16 a[106:107], v51 offset:16384
    ds_read_b64_tr_b16 a[120:121], v51 offset:8
    ds_read_b64_tr_b16 a[122:123], v51 offset:16392
    s_waitcnt lgkmcnt(0)
    s_barrier
    s_lshl_b32 s23, s3, 13
    s_add_u32 s23, s23, 65536
    s_and_b32 s20, s3, 1
    s_lshl_b32 s20, s20, 6
    s_add_u32 s20, s20, 128
    s_mul_i32 s20, s20, 2752
    s_lshl_b32 s21, s13, 7
    s_add_u32 s20, s20, s21
    s_mov_b32 m0, s23
    s_add_u32 s23, s23, 1024
    buffer_load_dwordx4 v36, s[44:47], s20 offen lds
    s_add_u32 s20, s20, 22016
    s_mov_b32 m0, s23
    s_add_u32 s23, s23, 1024
    buffer_load_dwordx4 v36, s[44:47], s20 offen lds
    s_add_u32 s20, s20, 22016
    s_mov_b32 m0, s23
    s_add_u32 s23, s23, 1024
    buffer_load_dwordx4 v36, s[44:47], s20 offen lds
    s_add_u32 s20, s20, 22016
    s_mov_b32 m0, s23
    s_add_u32 s23, s23, 1024
    buffer_load_dwordx4 v36, s[44:47], s20 offen lds
    s_add_u32 s20, s20, 22016
    s_mov_b32 m0, s23
    s_add_u32 s23, s23, 1024
    buffer_load_dwordx4 v36, s[44:47], s20 offen lds
    s_add_u32 s20, s20, 22016
    s_mov_b32 m0, s23
    s_add_u32 s23, s23, 1024
    buffer_load_dwordx4 v36, s[44:47], s20 offen lds
    s_add_u32 s20, s20, 22016
    s_mov_b32 m0, s23
    s_add_u32 s23, s23, 1024
    buffer_load_dwordx4 v36, s[44:47], s20 offen lds
    s_add_u32 s20, s20, 22016
    s_mov_b32 m0, s23
    s_add_u32 s23, s23, 1024
    buffer_load_dwordx4 v36, s[44:47], s20 offen lds
    s_add_u32 s20, s20, 22016
    s_waitcnt vmcnt(32)
    s_barrier
    v_add_u32 v48, 98304, v40
    v_add_u32 v49, 98304, v41
    v_add_u32 v50, 98304, v42
    v_add_u32 v51, 98304, v43
    ds_read_b64_tr_b16 a[12:13], v48 offset:0
    ds_read_b64_tr_b16 a[14:15], v48 offset:16384
    ds_read_b64_tr_b16 a[28:29], v48 offset:8
    ds_read_b64_tr_b16 a[30:31], v48 offset:16392
    ds_read_b64_tr_b16 a[44:45], v49 offset:0
    ds_read_b64_tr_b16 a[46:47], v49 offset:16384
    ds_read_b64_tr_b16 a[60:61], v49 offset:8
    ds_read_b64_tr_b16 a[62:63], v49 offset:16392
    ds_read_b64_tr_b16 a[76:77], v50 offset:0
    ds_read_b64_tr_b16 a[78:79], v50 offset:16384
    ds_read_b64_tr_b16 a[92:93], v50 offset:8
    ds_read_b64_tr_b16 a[94:95], v50 offset:16392
    ds_read_b64_tr_b16 a[108:109], v51 offset:0
    ds_read_b64_tr_b16 a[110:111], v51 offset:16384
    ds_read_b64_tr_b16 a[124:125], v51 offset:8
    ds_read_b64_tr_b16 a[126:127], v51 offset:16392
    s_waitcnt lgkmcnt(0)
    s_barrier
    s_lshl_b32 s23, s3, 13
    s_add_u32 s23, s23, 98304
    s_and_b32 s20, s3, 1
    s_lshl_b32 s20, s20, 6
    s_add_u32 s20, s20, 256
    s_mul_i32 s20, s20, 2752
    s_lshl_b32 s21, s13, 7
    s_add_u32 s20, s20, s21
    s_mov_b32 m0, s23
    s_add_u32 s23, s23, 1024
    buffer_load_dwordx4 v36, s[44:47], s20 offen lds
    s_add_u32 s20, s20, 22016
    s_mov_b32 m0, s23
    s_add_u32 s23, s23, 1024
    buffer_load_dwordx4 v36, s[44:47], s20 offen lds
    s_add_u32 s20, s20, 22016
    s_mov_b32 m0, s23
    s_add_u32 s23, s23, 1024
    buffer_load_dwordx4 v36, s[44:47], s20 offen lds
    s_add_u32 s20, s20, 22016
    s_mov_b32 m0, s23
    s_add_u32 s23, s23, 1024
    buffer_load_dwordx4 v36, s[44:47], s20 offen lds
    s_add_u32 s20, s20, 22016
    s_mov_b32 m0, s23
    s_add_u32 s23, s23, 1024
    buffer_load_dwordx4 v36, s[44:47], s20 offen lds
    s_add_u32 s20, s20, 22016
    s_mov_b32 m0, s23
    s_add_u32 s23, s23, 1024
    buffer_load_dwordx4 v36, s[44:47], s20 offen lds
    s_add_u32 s20, s20, 22016
    s_mov_b32 m0, s23
    s_add_u32 s23, s23, 1024
    buffer_load_dwordx4 v36, s[44:47], s20 offen lds
    s_add_u32 s20, s20, 22016
    s_mov_b32 m0, s23
    s_add_u32 s23, s23, 1024
    buffer_load_dwordx4 v36, s[44:47], s20 offen lds
    s_add_u32 s20, s20, 22016
    s_waitcnt vmcnt(32)
    s_barrier
    v_add_u32 v48, 131072, v40
    v_add_u32 v49, 131072, v41
    v_add_u32 v50, 131072, v42
    v_add_u32 v51, 131072, v43
    ds_read_b64_tr_b16 v[192:193], v48 offset:0
    ds_read_b64_tr_b16 v[194:195], v48 offset:16384
    ds_read_b64_tr_b16 v[200:201], v48 offset:8
    ds_read_b64_tr_b16 v[202:203], v48 offset:16392
    ds_read_b64_tr_b16 v[208:209], v49 offset:0
    ds_read_b64_tr_b16 v[210:211], v49 offset:16384
    ds_read_b64_tr_b16 v[216:217], v49 offset:8
    ds_read_b64_tr_b16 v[218:219], v49 offset:16392
    ds_read_b64_tr_b16 v[224:225], v50 offset:0
    ds_read_b64_tr_b16 v[226:227], v50 offset:16384
    ds_read_b64_tr_b16 v[232:233], v50 offset:8
    ds_read_b64_tr_b16 v[234:235], v50 offset:16392
    ds_read_b64_tr_b16 v[240:241], v51 offset:0
    ds_read_b64_tr_b16 v[242:243], v51 offset:16384
    ds_read_b64_tr_b16 v[248:249], v51 offset:8
    ds_read_b64_tr_b16 v[250:251], v51 offset:16392
    s_waitcnt lgkmcnt(0)
    s_barrier
    s_lshl_b32 s23, s3, 13
    s_add_u32 s23, s23, 131072
    s_and_b32 s20, s3, 1
    s_lshl_b32 s20, s20, 6
    s_add_u32 s20, s20, 384
    s_mul_i32 s20, s20, 2752
    s_lshl_b32 s21, s13, 7
    s_add_u32 s20, s20, s21
    s_mov_b32 m0, s23
    s_add_u32 s23, s23, 1024
    buffer_load_dwordx4 v36, s[44:47], s20 offen lds
    s_add_u32 s20, s20, 22016
    s_mov_b32 m0, s23
    s_add_u32 s23, s23, 1024
    buffer_load_dwordx4 v36, s[44:47], s20 offen lds
    s_add_u32 s20, s20, 22016
    s_mov_b32 m0, s23
    s_add_u32 s23, s23, 1024
    buffer_load_dwordx4 v36, s[44:47], s20 offen lds
    s_add_u32 s20, s20, 22016
    s_mov_b32 m0, s23
    s_add_u32 s23, s23, 1024
    buffer_load_dwordx4 v36, s[44:47], s20 offen lds
    s_add_u32 s20, s20, 22016
    s_mov_b32 m0, s23
    s_add_u32 s23, s23, 1024
    buffer_load_dwordx4 v36, s[44:47], s20 offen lds
    s_add_u32 s20, s20, 22016
    s_mov_b32 m0, s23
    s_add_u32 s23, s23, 1024
    buffer_load_dwordx4 v36, s[44:47], s20 offen lds
    s_add_u32 s20, s20, 22016
    s_mov_b32 m0, s23
    s_add_u32 s23, s23, 1024
    buffer_load_dwordx4 v36, s[44:47], s20 offen lds
    s_add_u32 s20, s20, 22016
    s_mov_b32 m0, s23
    s_add_u32 s23, s23, 1024
    buffer_load_dwordx4 v36, s[44:47], s20 offen lds
    s_add_u32 s20, s20, 22016
    s_waitcnt vmcnt(32)
    s_barrier
    v_add_u32 v48, 0, v40
    v_add_u32 v49, 0, v41
    v_add_u32 v50, 0, v42
    v_add_u32 v51, 0, v43
    ds_read_b64_tr_b16 v[196:197], v48 offset:0
    ds_read_b64_tr_b16 v[198:199], v48 offset:16384
    ds_read_b64_tr_b16 v[204:205], v48 offset:8
    ds_read_b64_tr_b16 v[206:207], v48 offset:16392
    ds_read_b64_tr_b16 v[212:213], v49 offset:0
    ds_read_b64_tr_b16 v[214:215], v49 offset:16384
    ds_read_b64_tr_b16 v[220:221], v49 offset:8
    ds_read_b64_tr_b16 v[222:223], v49 offset:16392
    ds_read_b64_tr_b16 v[228:229], v50 offset:0
    ds_read_b64_tr_b16 v[230:231], v50 offset:16384
    ds_read_b64_tr_b16 v[236:237], v50 offset:8
    ds_read_b64_tr_b16 v[238:239], v50 offset:16392
    ds_read_b64_tr_b16 v[244:245], v51 offset:0
    ds_read_b64_tr_b16 v[246:247], v51 offset:16384
    ds_read_b64_tr_b16 v[252:253], v51 offset:8
    ds_read_b64_tr_b16 v[254:255], v51 offset:16392
    s_waitcnt lgkmcnt(0)
    s_barrier
    s_waitcnt vmcnt(24)
    s_barrier
    v_add_u32 v48, 32768, v44
    ds_read_b64_tr_b16 a[128:129], v48 offset:0
    ds_read_b64_tr_b16 a[130:131], v48 offset:512
    ds_read_b64_tr_b16 a[132:133], v48 offset:16384
    ds_read_b64_tr_b16 a[134:135], v48 offset:16896
    ds_read_b64_tr_b16 a[136:137], v48 offset:4096
    ds_read_b64_tr_b16 a[138:139], v48 offset:4608
    ds_read_b64_tr_b16 a[140:141], v48 offset:20480
    ds_read_b64_tr_b16 a[142:143], v48 offset:20992
    ds_read_b64_tr_b16 a[144:145], v48 offset:8192
    ds_read_b64_tr_b16 a[146:147], v48 offset:8704
    ds_read_b64_tr_b16 a[148:149], v48 offset:24576
    ds_read_b64_tr_b16 a[150:151], v48 offset:25088
    ds_read_b64_tr_b16 a[152:153], v48 offset:12288
    ds_read_b64_tr_b16 a[154:155], v48 offset:12800
    ds_read_b64_tr_b16 a[156:157], v48 offset:28672
    ds_read_b64_tr_b16 a[158:159], v48 offset:29184
    s_waitcnt lgkmcnt(0)
    s_barrier
    s_waitcnt vmcnt(16)
    s_barrier
    v_add_u32 v48, 65536, v44
    ds_read_b64_tr_b16 a[160:161], v48 offset:0
    ds_read_b64_tr_b16 a[162:163], v48 offset:512
    ds_read_b64_tr_b16 a[164:165], v48 offset:16384
    ds_read_b64_tr_b16 a[166:167], v48 offset:16896
    ds_read_b64_tr_b16 a[168:169], v48 offset:4096
    ds_read_b64_tr_b16 a[170:171], v48 offset:4608
    ds_read_b64_tr_b16 a[172:173], v48 offset:20480
    ds_read_b64_tr_b16 a[174:175], v48 offset:20992
    ds_read_b64_tr_b16 a[176:177], v48 offset:8192
    ds_read_b64_tr_b16 a[178:179], v48 offset:8704
    ds_read_b64_tr_b16 a[180:181], v48 offset:24576
    ds_read_b64_tr_b16 a[182:183], v48 offset:25088
    ds_read_b64_tr_b16 a[184:185], v48 offset:12288
    ds_read_b64_tr_b16 a[186:187], v48 offset:12800
    ds_read_b64_tr_b16 a[188:189], v48 offset:28672
    ds_read_b64_tr_b16 a[190:191], v48 offset:29184
    s_waitcnt lgkmcnt(0)
    s_barrier
    s_waitcnt vmcnt(8)
    s_barrier
    v_add_u32 v48, 98304, v44
    ds_read_b64_tr_b16 a[192:193], v48 offset:0
    ds_read_b64_tr_b16 a[194:195], v48 offset:512
    ds_read_b64_tr_b16 a[196:197], v48 offset:16384
    ds_read_b64_tr_b16 a[198:199], v48 offset:16896
    ds_read_b64_tr_b16 a[200:201], v48 offset:4096
    ds_read_b64_tr_b16 a[202:203], v48 offset:4608
    ds_read_b64_tr_b16 a[204:205], v48 offset:20480
    ds_read_b64_tr_b16 a[206:207], v48 offset:20992
    ds_read_b64_tr_b16 a[208:209], v48 offset:8192
    ds_read_b64_tr_b16 a[210:211], v48 offset:8704
    ds_read_b64_tr_b16 a[212:213], v48 offset:24576
    ds_read_b64_tr_b16 a[214:215], v48 offset:25088
    ds_read_b64_tr_b16 a[216:217], v48 offset:12288
    ds_read_b64_tr_b16 a[218:219], v48 offset:12800
    ds_read_b64_tr_b16 a[220:221], v48 offset:28672
    ds_read_b64_tr_b16 a[222:223], v48 offset:29184
    s_waitcnt lgkmcnt(0)
    s_barrier
    s_waitcnt vmcnt(0)
    s_barrier
    v_add_u32 v48, 131072, v44
    ds_read_b64_tr_b16 a[224:225], v48 offset:0
    ds_read_b64_tr_b16 a[226:227], v48 offset:512
    ds_read_b64_tr_b16 a[228:229], v48 offset:16384
    ds_read_b64_tr_b16 a[230:231], v48 offset:16896
    ds_read_b64_tr_b16 a[232:233], v48 offset:4096
    ds_read_b64_tr_b16 a[234:235], v48 offset:4608
    ds_read_b64_tr_b16 a[236:237], v48 offset:20480
    ds_read_b64_tr_b16 a[238:239], v48 offset:20992
    ds_read_b64_tr_b16 a[240:241], v48 offset:8192
    ds_read_b64_tr_b16 a[242:243], v48 offset:8704
    ds_read_b64_tr_b16 a[244:245], v48 offset:24576
    ds_read_b64_tr_b16 a[246:247], v48 offset:25088
    ds_read_b64_tr_b16 a[248:249], v48 offset:12288
    ds_read_b64_tr_b16 a[250:251], v48 offset:12800
    ds_read_b64_tr_b16 a[252:253], v48 offset:28672
    ds_read_b64_tr_b16 a[254:255], v48 offset:29184
    s_waitcnt lgkmcnt(0)
    s_barrier
    s_lshl_b32 s16, s12, 22
    s_add_u32 s16, s16, 0x4800000
    s_mov_b32 s18, 0x3e0293ee
    s_mov_b32 s19, 0x3e0293ee
    v_lshlrev_b32 v1, 4, v0
    v_and_b32 v16, 15, v0
    v_and_b32 v17, 1, v0
    v_lshlrev_b32 v17, 4, v17
    v_mov_b32 v18, 0x3f80
    v_lshlrev_b32 v18, v17, v18
    v_lshrrev_b32 v16, 1, v16
    v_cmp_eq_u32 vcc, 0, v16
    v_mov_b32 v20, 0
    s_nop 0
    v_cndmask_b32 v20, v20, v18, vcc
    v_cmp_eq_u32 vcc, 1, v16
    v_mov_b32 v21, 0
    s_nop 0
    v_cndmask_b32 v21, v21, v18, vcc
    v_cmp_eq_u32 vcc, 2, v16
    v_mov_b32 v22, 0
    s_nop 0
    v_cndmask_b32 v22, v22, v18, vcc
    v_cmp_eq_u32 vcc, 3, v16
    v_mov_b32 v23, 0
    s_nop 0
    v_cndmask_b32 v23, v23, v18, vcc
    s_mul_i32 s20, s3, 8704
    s_add_u32 s20, s20, 16384
    v_and_b32 v16, 15, v0
    v_mul_u32_u24 v16, 272, v16
    v_lshrrev_b32 v17, 4, v0
    v_lshl_add_u32 v16, v17, 4, v16
    v_add_u32 v3, s20, v16
    v_mul_u32_u24 v16, 272, v17
    v_and_b32 v18, 15, v0
    v_lshl_add_u32 v16, v18, 4, v16
    v_add_u32 v4, s20, v16
    v_lshlrev_b32 v16, 15, v17
    v_lshl_add_u32 v16, v18, 4, v16
    s_lshl_b32 s20, s13, 10
    s_lshl_b32 s21, s3, 8
    s_add_u32 s20, s20, s21
    v_add_u32 v6, s20, v16
    v_lshlrev_b32 v16, 10, v17
    v_lshl_add_u32 v16, v18, 4, v16
    s_lshl_b32 s20, s13, 15
    s_add_u32 s20, s20, s21
    v_add_u32 v5, s20, v16
    v_mov_b32 v16, 0x40000000
    v_cmp_gt_u32 vcc, 32, v0
    s_nop 1
    v_cndmask_b32 v14, v16, v5, vcc
    v_lshlrev_b32 v16, 4, v0
    v_add_u32 v16, s21, v16
    v_mov_b32 v17, 0x40000000
    v_cmp_gt_u32 vcc, 16, v0
    s_nop 1
    v_cndmask_b32 v13, v17, v16, vcc
    v_lshrrev_b32 v16, 4, v0
    v_lshlrev_b32 v16, 6, v16
    v_and_b32 v17, 7, v0
    v_lshl_add_u32 v16, v17, 1, v16
    s_add_u32 s20, s21, 12800
    v_add_u32 v16, s20, v16
    v_mov_b32 v17, 12416
    v_bfe_u32 v18, v0, 3, 1
    v_cmp_eq_u32 vcc, 0, v18
    s_nop 1
    v_cndmask_b32 v7, v17, v16, vcc
    v_bfe_u32 v16, v0, 2, 2
    v_lshlrev_b32 v16, 10, v16
    v_and_b32 v17, 3, v0
    v_lshl_add_u32 v16, v17, 8, v16
    s_lshl_b32 s20, s3, 12
    s_lshr_b32 s22, s13, 4
    s_lshl_b32 s22, s22, 14
    s_add_u32 s20, s20, s22
    s_and_b32 s22, s13, 15
    s_lshl_b32 s22, s22, 4
    s_add_u32 s20, s20, s22
    v_add_u32 v16, s20, v16
    v_mov_b32 v17, 0x40000000
    v_cmp_gt_u32 vcc, 16, v0
    s_nop 1
    v_cndmask_b32 v10, v17, v16, vcc
    s_and_b32 s20, s3, 1
    s_lshl_b32 s20, s20, 12
    s_lshr_b32 s22, s3, 1
    s_lshl_b32 s22, s22, 11
    s_add_u32 s20, s20, s22
    s_add_u32 s20, s20, 0
    v_add_u32 v11, s20, v1
    v_lshlrev_b32 v16, 3, v0
    s_lshl_b32 s20, s3, 9
    s_add_u32 s20, s20, 8192
    v_add_u32 v12, s20, v16
    v_lshlrev_b32 v16, 2, v0
    v_mov_b32 v17, 0x40000000
    v_cmp_gt_u32 vcc, 32, v0
    s_nop 1
    v_cndmask_b32 v8, v17, v16, vcc
    v_or_b32 v16, s3, v0
    s_lshl_b32 s20, s13, 2
    v_mov_b32 v18, s20
    v_cmp_eq_u32 vcc, 0, v16
    s_nop 1
    v_cndmask_b32 v9, v17, v18, vcc
    v_and_b32 v16, 15, v0
    s_and_b32 s20, s3, 1
    s_lshl_b32 s20, s20, 4
    v_add_u32 v16, s20, v16
    v_lshrrev_b32 v17, 4, v0
    v_lshlrev_b32 v17, 2, v17
    v_add_u32 v18, 0, v17
    v_cmp_le_u32 s[64:65], v18, v16
    v_add_u32 v18, 1, v17
    v_cmp_le_u32 s[66:67], v18, v16
    v_add_u32 v18, 2, v17
    v_cmp_le_u32 s[68:69], v18, v16
    v_add_u32 v18, 3, v17
    v_cmp_le_u32 s[70:71], v18, v16
    v_add_u32 v18, 16, v17
    v_cmp_le_u32 s[72:73], v18, v16
    v_add_u32 v18, 17, v17
    v_cmp_le_u32 s[74:75], v18, v16
    v_add_u32 v18, 18, v17
    v_cmp_le_u32 s[76:77], v18, v16
    v_add_u32 v18, 19, v17
    v_cmp_le_u32 s[78:79], v18, v16
    s_mov_b32 s14, s12
    s_mov_b32 s15, 1
L_P2SEG:
    s_and_b32 s21, s14, 3
    s_lshr_b32 s26, s14, 2
    s_add_u32 s26, s26, 1
    s_lshl_b32 s20, s13, 2
    s_add_u32 s20, s20, s21
    s_lshl_b32 s20, s20, 7
    s_add_u32 s27, s20, 0x4420000
    s_cmp_eq_u32 s3, 0
    s_cbranch_scc0 L_P2OKKV
    s_mov_b32 s24, 0
L_P2POLLKV:
    buffer_load_dword v16, off, s[4:7], s27 sc1
    s_waitcnt vmcnt(0)
    v_readfirstlane_b32 s22, v16
    s_nop 0
    s_cmp_ge_u32 s22, s26
    s_cbranch_scc1 L_P2OKKV
    s_sleep 4
    s_add_u32 s24, s24, 1
    s_cmp_lt_u32 s24, 400000
    s_cbranch_scc1 L_P2POLLKV
    s_branch L_P2BAIL
L_P2OKKV:
    s_barrier
    s_lshr_b32 s20, s13, 1
    s_add_u32 s20, s20, 32
    s_lshl_b32 s20, s20, 2
    s_add_u32 s20, s20, s21
    s_lshl_b32 s20, s20, 7
    s_add_u32 s27, s20, 0x4420000
    s_cmp_eq_u32 s3, 0
    s_cbranch_scc0 L_P2OKQ
    s_mov_b32 s24, 0
L_P2POLLQ:
    buffer_load_dword v16, off, s[4:7], s27 sc1
    s_waitcnt vmcnt(0)
    v_readfirstlane_b32 s22, v16
    s_nop 0
    s_cmp_ge_u32 s22, s26
    s_cbranch_scc1 L_P2OKQ
    s_sleep 4
    s_add_u32 s24, s24, 1
    s_cmp_lt_u32 s24, 400000
    s_cbranch_scc1 L_P2POLLQ
    s_branch L_P2BAIL
L_P2OKQ:
    s_barrier
    s_lshl_b32 s25, s14, 5
    s_add_u32 s25, s25, s13
    s_lshl_b32 s20, s25, 13
    s_and_b32 s21, s3, 1
    s_lshl_b32 s21, s21, 12
    s_add_u32 s21, s21, s20
    s_add_u32 s21, s21, 0x2000000
    buffer_load_dwordx4 v[32:35], v1, s[4:7], s21 offen offset:0
    buffer_load_dwordx4 v[36:39], v1, s[4:7], s21 offen offset:1024
    buffer_load_dwordx4 v[40:43], v1, s[4:7], s21 offen offset:2048
    buffer_load_dwordx4 v[44:47], v1, s[4:7], s21 offen offset:3072
    s_add_u32 s21, s20, 0x0
    buffer_load_dwordx4 v[48:51], v1, s[4:7], s21 offen offset:0
    buffer_load_dwordx4 v[52:55], v1, s[4:7], s21 offen offset:1024
    buffer_load_dwordx4 v[56:59], v1, s[4:7], s21 offen offset:2048
    buffer_load_dwordx4 v[60:63], v1, s[4:7], s21 offen offset:3072
    s_add_u32 s21, s21, 4096
    buffer_load_dwordx4 v[64:67], v1, s[4:7], s21 offen offset:0
    buffer_load_dwordx4 v[68:71], v1, s[4:7], s21 offen offset:1024
    buffer_load_dwordx4 v[72:75], v1, s[4:7], s21 offen offset:2048
    buffer_load_dwordx4 v[76:79], v1, s[4:7], s21 offen offset:3072
    s_lshr_b32 s21, s3, 1
    s_lshl_b32 s21, s21, 12
    s_add_u32 s21, s21, s20
    s_add_u32 s21, s21, 0x1000000
    buffer_load_dwordx4 v[96:99], v1, s[4:7], s21 offen offset:0
    buffer_load_dwordx4 v[100:103], v1, s[4:7], s21 offen offset:1024
    buffer_load_dwordx4 v[104:107], v1, s[4:7], s21 offen offset:2048
    buffer_load_dwordx4 v[108:111], v1, s[4:7], s21 offen offset:3072
    s_lshl_b32 s21, s14, 5
    s_add_u32 s21, s21, s13
    s_lshl_b32 s28, s21, 10
    buffer_load_dwordx4 v[132:135], v13, s[8:11], s28 offen
    s_lshl_b32 s21, s13, 7
    s_add_u32 s27, s21, 0x4410000
    s_add_u32 s26, s14, 1
    s_cmp_eq_u32 s3, 0
    s_cbranch_scc0 L_P2OKCH
    s_mov_b32 s24, 0
L_P2POLLCH:
    buffer_load_dword v16, off, s[4:7], s27 sc1
    s_waitcnt vmcnt(0)
    v_readfirstlane_b32 s22, v16
    s_nop 0
    s_cmp_ge_u32 s22, s26
    s_cbranch_scc1 L_P2OKCH
    s_sleep 4
    s_add_u32 s24, s24, 1
    s_cmp_lt_u32 s24, 400000
    s_cbranch_scc1 L_P2POLLCH
    s_branch L_P2BAIL
L_P2OKCH:
    s_barrier
    s_lshl_b32 s20, s25, 12
    s_add_u32 s21, s20, 0x3220000
    buffer_load_dwordx4 v[80:83], v1, s[4:7], s21 offen offset:0
    buffer_load_dwordx4 v[84:87], v1, s[4:7], s21 offen offset:1024
    buffer_load_dwordx4 v[88:91], v1, s[4:7], s21 offen offset:2048
    buffer_load_dwordx4 v[92:95], v1, s[4:7], s21 offen offset:3072
    s_lshr_b32 s21, s3, 1
    s_lshl_b32 s21, s21, 11
    s_add_u32 s21, s21, s20
    s_add_u32 s21, s21, 0x3a60000
    buffer_load_dwordx4 v[112:115], v1, s[4:7], s21 offen offset:0
    buffer_load_dwordx4 v[116:119], v1, s[4:7], s21 offen offset:1024
    s_waitcnt vmcnt(18)
    v_mfma_f32_16x16x32_bf16 v[120:123], v[48:51], v[32:35], 0
    s_waitcnt vmcnt(14)
    v_mfma_f32_16x16x32_bf16 v[124:127], v[64:67], v[32:35], 0
    v_mfma_f32_16x16x32_bf16 v[120:123], v[52:55], v[36:39], v[120:123]
    s_waitcnt vmcnt(13)
    v_mfma_f32_16x16x32_bf16 v[124:127], v[68:71], v[36:39], v[124:127]
    v_mfma_f32_16x16x32_bf16 v[120:123], v[56:59], v[40:43], v[120:123]
    s_waitcnt vmcnt(12)
    v_mfma_f32_16x16x32_bf16 v[124:127], v[72:75], v[40:43], v[124:127]
    v_mfma_f32_16x16x32_bf16 v[120:123], v[60:63], v[44:47], v[120:123]
    s_waitcnt vmcnt(11)
    v_mfma_f32_16x16x32_bf16 v[124:127], v[76:79], v[44:47], v[124:127]
    s_waitcnt vmcnt(5)
    v_mfma_f32_16x16x32_bf16 v[128:131], v[80:83], v[32:35], 0
    s_waitcnt vmcnt(4)
    v_mfma_f32_16x16x32_bf16 v[128:131], v[84:87], v[36:39], v[128:131]
    s_waitcnt vmcnt(3)
    v_mfma_f32_16x16x32_bf16 v[128:131], v[88:91], v[40:43], v[128:131]
    s_waitcnt vmcnt(2)
    v_mfma_f32_16x16x32_bf16 v[128:131], v[92:95], v[44:47], v[128:131]
    v_mov_b32 v18, 0xf149f2ca
    v_cndmask_b32 v120, v18, v120, s[64:65]
    v_cndmask_b32 v121, v18, v121, s[66:67]
    v_cndmask_b32 v122, v18, v122, s[68:69]
    v_cndmask_b32 v123, v18, v123, s[70:71]
    v_cndmask_b32 v124, v18, v124, s[72:73]
    v_cndmask_b32 v125, v18, v125, s[74:75]
    v_cndmask_b32 v126, v18, v126, s[76:77]
    v_cndmask_b32 v127, v18, v127, s[78:79]
    v_max3_f32 v16, v120, v121, v122
    v_max3_f32 v17, v123, v124, v125
    v_max3_f32 v16, v16, v126, v127
    v_max3_f32 v17, v17, v128, v129
    v_max_f32 v16, v16, v17
    v_mov_b32 v17, v16
    s_nop 1
    v_permlane16_swap_b32 v17, v16
    v_max_f32 v16, v16, v17
    v_mov_b32 v17, v16
    s_nop 1
    v_permlane32_swap_b32 v17, v16
    v_max_f32 v16, v16, v17
    v_mul_f32 v16, s18, v16
    v_pk_fma_f32 v[120:121], v[120:121], s[18:19], v[16:17] op_sel_hi:[1,0,0] neg_lo:[0,0,1] neg_hi:[0,0,1]
    v_pk_fma_f32 v[122:123], v[122:123], s[18:19], v[16:17] op_sel_hi:[1,0,0] neg_lo:[0,0,1] neg_hi:[0,0,1]
    v_pk_fma_f32 v[124:125], v[124:125], s[18:19], v[16:17] op_sel_hi:[1,0,0] neg_lo:[0,0,1] neg_hi:[0,0,1]
    v_pk_fma_f32 v[126:127], v[126:127], s[18:19], v[16:17] op_sel_hi:[1,0,0] neg_lo:[0,0,1] neg_hi:[0,0,1]
    v_pk_fma_f32 v[128:129], v[128:129], s[18:19], v[16:17] op_sel_hi:[1,0,0] neg_lo:[0,0,1] neg_hi:[0,0,1]
    v_exp_f32 v120, v120
    v_exp_f32 v121, v121
    v_exp_f32 v122, v122
    v_exp_f32 v123, v123
    v_exp_f32 v124, v124
    v_exp_f32 v125, v125
    v_exp_f32 v126, v126
    v_exp_f32 v127, v127
    v_exp_f32 v128, v128
    v_exp_f32 v129, v129
    v_cvt_pk_bf16_f32 v32, v120, v121
    v_cvt_pk_bf16_f32 v33, v122, v123
    v_cvt_pk_bf16_f32 v34, v124, v125
    v_cvt_pk_bf16_f32 v35, v126, v127
    v_cvt_pk_bf16_f32 v36, v128, v129
    v_cvt_pk_bf16_f32 v37, v128, v129
    v_mfma_f32_16x16x32_bf16 v[48:51], v[96:99], v[32:35], 0
    v_mfma_f32_16x16x32_bf16 v[52:55], v[100:103], v[32:35], 0
    v_mfma_f32_16x16x32_bf16 v[56:59], v[104:107], v[32:35], 0
    v_mfma_f32_16x16x32_bf16 v[60:63], v[108:111], v[32:35], 0
    s_waitcnt vmcnt(1)
    v_mfma_f32_16x16x16_bf16 v[48:51], v[112:113], v[36:37], v[48:51]
    v_mfma_f32_16x16x16_bf16 v[52:55], v[114:115], v[36:37], v[52:55]
    s_waitcnt vmcnt(0)
    v_mfma_f32_16x16x16_bf16 v[56:59], v[116:117], v[36:37], v[56:59]
    v_mfma_f32_16x16x16_bf16 v[60:63], v[118:119], v[36:37], v[60:63]
    v_pk_add_f32 v[120:121], v[120:121], v[122:123]
    v_pk_add_f32 v[124:125], v[124:125], v[126:127]
    v_pk_add_f32 v[120:121], v[120:121], v[128:129]
    v_pk_add_f32 v[120:121], v[120:121], v[124:125]
    v_add_f32 v120, v120, v121
    v_mov_b32 v121, v120
    s_nop 1
    v_permlane16_swap_b32 v121, v120
    v_add_f32 v120, v120, v121
    v_mov_b32 v121, v120
    s_nop 1
    v_permlane32_swap_b32 v121, v120
    v_add_f32 v120, v120, v121
    v_rcp_f32 v16, v120
    s_nop 0
    v_pk_mul_f32 v[48:49], v[48:49], v[16:17] op_sel_hi:[1,0]
    v_pk_mul_f32 v[50:51], v[50:51], v[16:17] op_sel_hi:[1,0]
    v_pk_mul_f32 v[52:53], v[52:53], v[16:17] op_sel_hi:[1,0]
    v_pk_mul_f32 v[54:55], v[54:55], v[16:17] op_sel_hi:[1,0]
    v_pk_mul_f32 v[56:57], v[56:57], v[16:17] op_sel_hi:[1,0]
    v_pk_mul_f32 v[58:59], v[58:59], v[16:17] op_sel_hi:[1,0]
    v_pk_mul_f32 v[60:61], v[60:61], v[16:17] op_sel_hi:[1,0]
    v_pk_mul_f32 v[62:63], v[62:63], v[16:17] op_sel_hi:[1,0]
    v_cvt_pk_bf16_f32 v40, v48, v49
    v_cvt_pk_bf16_f32 v41, v50, v51
    v_cvt_pk_bf16_f32 v42, v52, v53
    v_cvt_pk_bf16_f32 v43, v54, v55
    ds_write_b128 v11, v[40:43] offset:0
    v_cvt_pk_bf16_f32 v44, v56, v57
    v_cvt_pk_bf16_f32 v45, v58, v59
    v_cvt_pk_bf16_f32 v46, v60, v61
    v_cvt_pk_bf16_f32 v47, v62, v63
    ds_write_b128 v11, v[44:47] offset:1024
    v_mov_b32 v28, v132
    v_mov_b32 v29, v133
    v_mov_b32 v30, v134
    v_mov_b32 v31, v135
    s_waitcnt lgkmcnt(0)
    s_barrier
    ds_read_b128 v[32:35], v1 offset:0
    ds_read_b128 v[36:39], v1 offset:1024
    ds_read_b128 v[40:43], v1 offset:2048
    ds_read_b128 v[44:47], v1 offset:3072
    ds_read_b128 v[48:51], v1 offset:4096
    ds_read_b128 v[52:55], v1 offset:5120
    ds_read_b128 v[56:59], v1 offset:6144
    ds_read_b128 v[60:63], v1 offset:7168
    s_add_u32 s29, s16, 0
    s_waitcnt lgkmcnt(7)
    v_mfma_f32_16x16x32_bf16 v[64:67], a[0:3], v[32:35], 0
    v_mfma_f32_16x16x32_bf16 v[68:71], a[16:19], v[32:35], 0
    v_mfma_f32_16x16x32_bf16 v[72:75], a[32:35], v[32:35], 0
    v_mfma_f32_16x16x32_bf16 v[76:79], a[48:51], v[32:35], 0
    v_mfma_f32_16x16x32_bf16 v[80:83], a[64:67], v[32:35], 0
    v_mfma_f32_16x16x32_bf16 v[84:87], a[80:83], v[32:35], 0
    v_mfma_f32_16x16x32_bf16 v[88:91], a[96:99], v[32:35], 0
    v_mfma_f32_16x16x32_bf16 v[92:95], a[112:115], v[32:35], 0
    s_waitcnt lgkmcnt(6)
    v_mfma_f32_16x16x32_bf16 v[64:67], a[4:7], v[36:39], v[64:67]
    v_mfma_f32_16x16x32_bf16 v[68:71], a[20:23], v[36:39], v[68:71]
    v_mfma_f32_16x16x32_bf16 v[72:75], a[36:39], v[36:39], v[72:75]
    v_mfma_f32_16x16x32_bf16 v[76:79], a[52:55], v[36:39], v[76:79]
    v_mfma_f32_16x16x32_bf16 v[80:83], a[68:71], v[36:39], v[80:83]
    v_mfma_f32_16x16x32_bf16 v[84:87], a[84:87], v[36:39], v[84:87]
    v_mfma_f32_16x16x32_bf16 v[88:91], a[100:103], v[36:39], v[88:91]
    v_mfma_f32_16x16x32_bf16 v[92:95], a[116:119], v[36:39], v[92:95]
    s_waitcnt lgkmcnt(5)
    v_mfma_f32_16x16x32_bf16 v[64:67], a[8:11], v[40:43], v[64:67]
    v_mfma_f32_16x16x32_bf16 v[68:71], a[24:27], v[40:43], v[68:71]
    v_mfma_f32_16x16x32_bf16 v[72:75], a[40:43], v[40:43], v[72:75]
    v_mfma_f32_16x16x32_bf16 v[76:79], a[56:59], v[40:43], v[76:79]
    v_mfma_f32_16x16x32_bf16 v[80:83], a[72:75], v[40:43], v[80:83]
    v_mfma_f32_16x16x32_bf16 v[84:87], a[88:91], v[40:43], v[84:87]
    v_mfma_f32_16x16x32_bf16 v[88:91], a[104:107], v[40:43], v[88:91]
    v_mfma_f32_16x16x32_bf16 v[92:95], a[120:123], v[40:43], v[92:95]
    s_waitcnt lgkmcnt(4)
    v_mfma_f32_16x16x32_bf16 v[64:67], a[12:15], v[44:47], v[64:67]
    v_mfma_f32_16x16x32_bf16 v[68:71], a[28:31], v[44:47], v[68:71]
    v_mfma_f32_16x16x32_bf16 v[72:75], a[44:47], v[44:47], v[72:75]
    v_mfma_f32_16x16x32_bf16 v[76:79], a[60:63], v[44:47], v[76:79]
    v_mfma_f32_16x16x32_bf16 v[80:83], a[76:79], v[44:47], v[80:83]
    v_mfma_f32_16x16x32_bf16 v[84:87], a[92:95], v[44:47], v[84:87]
    v_mfma_f32_16x16x32_bf16 v[88:91], a[108:111], v[44:47], v[88:91]
    v_mfma_f32_16x16x32_bf16 v[92:95], a[124:127], v[44:47], v[92:95]
    s_waitcnt lgkmcnt(3)
    v_mfma_f32_16x16x32_bf16 v[96:99], a[0:3], v[48:51], 0
    v_mfma_f32_16x16x32_bf16 v[100:103], a[16:19], v[48:51], 0
    v_mfma_f32_16x16x32_bf16 v[104:107], a[32:35], v[48:51], 0
    v_mfma_f32_16x16x32_bf16 v[108:111], a[48:51], v[48:51], 0
    v_cvt_pk_bf16_f32 v128, v64, v65
    v_mfma_f32_16x16x32_bf16 v[112:115], a[64:67], v[48:51], 0
    v_cvt_pk_bf16_f32 v129, v66, v67
    v_mfma_f32_16x16x32_bf16 v[116:119], a[80:83], v[48:51], 0
    v_cvt_pk_bf16_f32 v130, v68, v69
    v_mfma_f32_16x16x32_bf16 v[120:123], a[96:99], v[48:51], 0
    v_cvt_pk_bf16_f32 v131, v70, v71
    v_mfma_f32_16x16x32_bf16 v[124:127], a[112:115], v[48:51], 0
    ds_write_b128 v3, v[128:131] offset:0
    s_waitcnt lgkmcnt(3)
    v_mfma_f32_16x16x32_bf16 v[96:99], a[4:7], v[52:55], v[96:99]
    v_cvt_pk_bf16_f32 v132, v72, v73
    v_mfma_f32_16x16x32_bf16 v[100:103], a[20:23], v[52:55], v[100:103]
    v_cvt_pk_bf16_f32 v133, v74, v75
    v_mfma_f32_16x16x32_bf16 v[104:107], a[36:39], v[52:55], v[104:107]
    v_cvt_pk_bf16_f32 v134, v76, v77
    v_mfma_f32_16x16x32_bf16 v[108:111], a[52:55], v[52:55], v[108:111]
    v_cvt_pk_bf16_f32 v135, v78, v79
    v_mfma_f32_16x16x32_bf16 v[112:115], a[68:71], v[52:55], v[112:115]
    ds_write_b128 v3, v[132:135] offset:64
    v_mfma_f32_16x16x32_bf16 v[116:119], a[84:87], v[52:55], v[116:119]
    v_cvt_pk_bf16_f32 v136, v80, v81
    v_mfma_f32_16x16x32_bf16 v[120:123], a[100:103], v[52:55], v[120:123]
    v_cvt_pk_bf16_f32 v137, v82, v83
    v_mfma_f32_16x16x32_bf16 v[124:127], a[116:119], v[52:55], v[124:127]
    v_cvt_pk_bf16_f32 v138, v84, v85
    s_waitcnt lgkmcnt(3)
    v_mfma_f32_16x16x32_bf16 v[96:99], a[8:11], v[56:59], v[96:99]
    v_cvt_pk_bf16_f32 v139, v86, v87
    v_mfma_f32_16x16x32_bf16 v[100:103], a[24:27], v[56:59], v[100:103]
    ds_write_b128 v3, v[136:139] offset:128
    v_mfma_f32_16x16x32_bf16 v[104:107], a[40:43], v[56:59], v[104:107]
    v_cvt_pk_bf16_f32 v140, v88, v89
    v_mfma_f32_16x16x32_bf16 v[108:111], a[56:59], v[56:59], v[108:111]
    v_cvt_pk_bf16_f32 v141, v90, v91
    v_mfma_f32_16x16x32_bf16 v[112:115], a[72:75], v[56:59], v[112:115]
    v_cvt_pk_bf16_f32 v142, v92, v93
    v_mfma_f32_16x16x32_bf16 v[116:119], a[88:91], v[56:59], v[116:119]
    v_cvt_pk_bf16_f32 v143, v94, v95
    v_mfma_f32_16x16x32_bf16 v[120:123], a[104:107], v[56:59], v[120:123]
    ds_write_b128 v3, v[140:143] offset:192
    v_mfma_f32_16x16x32_bf16 v[124:127], a[120:123], v[56:59], v[124:127]
    ds_read_b128 v[128:131], v4 offset:0
    s_waitcnt lgkmcnt(5)
    v_mfma_f32_16x16x32_bf16 v[96:99], a[12:15], v[60:63], v[96:99]
    ds_read_b128 v[132:135], v4 offset:1088
    v_mfma_f32_16x16x32_bf16 v[100:103], a[28:31], v[60:63], v[100:103]
    ds_read_b128 v[136:139], v4 offset:2176
    v_mfma_f32_16x16x32_bf16 v[104:107], a[44:47], v[60:63], v[104:107]
    ds_read_b128 v[140:143], v4 offset:3264
    v_mfma_f32_16x16x32_bf16 v[108:111], a[60:63], v[60:63], v[108:111]
    s_waitcnt lgkmcnt(3)
    buffer_store_dwordx4 v[128:131], v6, s[4:7], s29 offen
    s_add_u32 s29, s29, 131072
    v_mfma_f32_16x16x32_bf16 v[112:115], a[76:79], v[60:63], v[112:115]
    s_waitcnt lgkmcnt(2)
    buffer_store_dwordx4 v[132:135], v6, s[4:7], s29 offen
    s_add_u32 s29, s29, 131072
    v_mfma_f32_16x16x32_bf16 v[116:119], a[92:95], v[60:63], v[116:119]
    s_waitcnt lgkmcnt(1)
    buffer_store_dwordx4 v[136:139], v6, s[4:7], s29 offen
    s_add_u32 s29, s29, 131072
    v_mfma_f32_16x16x32_bf16 v[120:123], a[108:111], v[60:63], v[120:123]
    s_waitcnt lgkmcnt(0)
    buffer_store_dwordx4 v[140:143], v6, s[4:7], s29 offen
    s_add_u32 s29, s29, 131072
    v_mfma_f32_16x16x32_bf16 v[124:127], a[124:127], v[60:63], v[124:127]
    v_cvt_pk_bf16_f32 v144, v96, v97
    v_cvt_pk_bf16_f32 v145, v98, v99
    v_cvt_pk_bf16_f32 v146, v100, v101
    v_cvt_pk_bf16_f32 v147, v102, v103
    ds_write_b128 v3, v[144:147] offset:4352
    v_cvt_pk_bf16_f32 v148, v104, v105
    v_cvt_pk_bf16_f32 v149, v106, v107
    v_cvt_pk_bf16_f32 v150, v108, v109
    v_cvt_pk_bf16_f32 v151, v110, v111
    ds_write_b128 v3, v[148:151] offset:4416
    v_cvt_pk_bf16_f32 v152, v112, v113
    v_cvt_pk_bf16_f32 v153, v114, v115
    v_cvt_pk_bf16_f32 v154, v116, v117
    v_cvt_pk_bf16_f32 v155, v118, v119
    ds_write_b128 v3, v[152:155] offset:4480
    v_cvt_pk_bf16_f32 v156, v120, v121
    v_cvt_pk_bf16_f32 v157, v122, v123
    v_cvt_pk_bf16_f32 v158, v124, v125
    v_cvt_pk_bf16_f32 v159, v126, v127
    ds_write_b128 v3, v[156:159] offset:4544
    ds_read_b128 v[144:147], v4 offset:4352
    ds_read_b128 v[148:151], v4 offset:5440
    ds_read_b128 v[152:155], v4 offset:6528
    ds_read_b128 v[156:159], v4 offset:7616
    s_waitcnt lgkmcnt(3)
    buffer_store_dwordx4 v[144:147], v6, s[4:7], s29 offen
    s_add_u32 s29, s29, 131072
    s_waitcnt lgkmcnt(2)
    buffer_store_dwordx4 v[148:151], v6, s[4:7], s29 offen
    s_add_u32 s29, s29, 131072
    s_waitcnt lgkmcnt(1)
    buffer_store_dwordx4 v[152:155], v6, s[4:7], s29 offen
    s_add_u32 s29, s29, 131072
    s_waitcnt lgkmcnt(0)
    buffer_store_dwordx4 v[156:159], v6, s[4:7], s29 offen
    s_waitcnt vmcnt(0)
    s_barrier
    v_mov_b32 v16, s15
    s_add_u32 s20, s16, 2162688
    buffer_store_dword v16, v9, s[4:7], s20 offen offset:0
    s_add_u32 s29, s16, 2162688
    s_mov_b32 s24, 0
L_P2POLLF1:
    buffer_load_dword v16, v8, s[4:7], s29 offen offset:0 sc1
    s_waitcnt vmcnt(0)
    v_cmp_gt_u32 vcc, s15, v16
    s_and_b32 vcc_hi, vcc_hi, 0
    s_cbranch_vccz L_P2OKF1
    s_add_u32 s24, s24, 1
    s_cmp_lt_u32 s24, 400000
    s_cbranch_scc1 L_P2POLLF1
    s_branch L_P2BAIL
L_P2OKF1:
    s_add_u32 s29, s16, 0
    buffer_load_dwordx4 v[32:35], v5, s[4:7], s29 offen sc1
    s_add_u32 s29, s29, 4096
    buffer_load_dwordx4 v[36:39], v5, s[4:7], s29 offen sc1
    s_add_u32 s29, s29, 4096
    buffer_load_dwordx4 v[40:43], v5, s[4:7], s29 offen sc1
    s_add_u32 s29, s29, 4096
    buffer_load_dwordx4 v[44:47], v5, s[4:7], s29 offen sc1
    s_add_u32 s29, s29, 4096
    buffer_load_dwordx4 v[48:51], v5, s[4:7], s29 offen sc1
    s_add_u32 s29, s29, 4096
    buffer_load_dwordx4 v[52:55], v5, s[4:7], s29 offen sc1
    s_add_u32 s29, s29, 4096
    buffer_load_dwordx4 v[56:59], v5, s[4:7], s29 offen sc1
    s_add_u32 s29, s29, 4096
    buffer_load_dwordx4 v[60:63], v5, s[4:7], s29 offen sc1
    v_mfma_f32_16x16x32_bf16 v[24:27], v[28:31], v[20:23], 0
    s_waitcnt vmcnt(7)
    v_mfma_f32_16x16x32_bf16 v[24:27], v[32:35], v[20:23], v[24:27]
    s_waitcnt vmcnt(6)
    v_mfma_f32_16x16x32_bf16 v[24:27], v[36:39], v[20:23], v[24:27]
    s_waitcnt vmcnt(5)
    v_mfma_f32_16x16x32_bf16 v[24:27], v[40:43], v[20:23], v[24:27]
    s_waitcnt vmcnt(4)
    v_mfma_f32_16x16x32_bf16 v[24:27], v[44:47], v[20:23], v[24:27]
    s_waitcnt vmcnt(3)
    v_mfma_f32_16x16x32_bf16 v[24:27], v[48:51], v[20:23], v[24:27]
    s_waitcnt vmcnt(2)
    v_mfma_f32_16x16x32_bf16 v[24:27], v[52:55], v[20:23], v[24:27]
    s_waitcnt vmcnt(1)
    v_mfma_f32_16x16x32_bf16 v[24:27], v[56:59], v[20:23], v[24:27]
    s_waitcnt vmcnt(0)
    v_mfma_f32_16x16x32_bf16 v[24:27], v[60:63], v[20:23], v[24:27]
    s_nop 7
    v_add_f32 v72, v24, v25
    v_mul_f32 v73, v24, v24
    v_add_f32 v72, v72, v26
    v_fmac_f32 v73, v25, v25
    v_add_f32 v72, v72, v27
    v_fmac_f32 v73, v26, v26
    v_fmac_f32 v73, v27, v27
    v_add_f32_dpp v72, v72, v72 row_ror:1 row_mask:0xf bank_mask:0xf
    s_nop 1
    v_add_f32_dpp v72, v72, v72 row_ror:2 row_mask:0xf bank_mask:0xf
    s_nop 1
    v_add_f32_dpp v72, v72, v72 row_ror:4 row_mask:0xf bank_mask:0xf
    s_nop 1
    v_add_f32_dpp v72, v72, v72 row_ror:8 row_mask:0xf bank_mask:0xf
    v_mov_b32 v16, v72
    s_nop 1
    v_permlane16_swap_b32 v16, v72
    v_add_f32 v72, v72, v16
    v_mov_b32 v16, v72
    s_nop 1
    v_permlane32_swap_b32 v16, v72
    v_add_f32 v72, v72, v16
    v_add_f32_dpp v73, v73, v73 row_ror:1 row_mask:0xf bank_mask:0xf
    s_nop 1
    v_add_f32_dpp v73, v73, v73 row_ror:2 row_mask:0xf bank_mask:0xf
    s_nop 1
    v_add_f32_dpp v73, v73, v73 row_ror:4 row_mask:0xf bank_mask:0xf
    s_nop 1
    v_add_f32_dpp v73, v73, v73 row_ror:8 row_mask:0xf bank_mask:0xf
    v_mov_b32 v17, v73
    s_nop 1
    v_permlane16_swap_b32 v17, v73
    v_add_f32 v73, v73, v17
    v_mov_b32 v17, v73
    s_nop 1
    v_permlane32_swap_b32 v17, v73
    v_add_f32 v73, v73, v17
    s_lshl_b32 s20, s3, 3
    s_add_u32 s20, s20, 12288
    v_mov_b32 v18, s20
    ds_write_b64 v18, v[72:73]
    s_waitcnt lgkmcnt(0)
    s_barrier
    v_mov_b32 v18, 12288
    ds_read_b128 v[76:79], v18
    ds_read_b128 v[80:83], v18 offset:16
    s_waitcnt lgkmcnt(1)
    v_pk_add_f32 v[76:77], v[76:77], v[78:79]
    s_waitcnt lgkmcnt(0)
    v_pk_add_f32 v[80:81], v[80:81], v[82:83]
    v_pk_add_f32 v[76:77], v[76:77], v[80:81]
    v_mul_f32 v76, 0x3b000000, v76
    v_mul_f32 v77, 0x3b000000, v77
    v_fma_f32 v77, -v76, v76, v77
    v_max_f32 v77, 0, v77
    v_add_f32 v77, 0x3727c5ac, v77
    v_rsq_f32 v77, v77
    v_sub_f32 v84, v24, v76
    v_sub_f32 v85, v25, v76
    v_sub_f32 v86, v26, v76
    v_sub_f32 v87, v27, v76
    v_mul_f32 v84, v84, v77
    v_mul_f32 v85, v85, v77
    v_mul_f32 v86, v86, v77
    v_mul_f32 v87, v87, v77
    v_cvt_pk_bf16_f32 v88, v84, v84
    ds_write_b16 v7, v88 offset:0
    v_cvt_pk_bf16_f32 v89, v85, v85
    ds_write_b16 v7, v89 offset:16
    v_cvt_pk_bf16_f32 v90, v86, v86
    ds_write_b16 v7, v90 offset:32
    v_cvt_pk_bf16_f32 v91, v87, v87
    ds_write_b16 v7, v91 offset:48
    s_lshl_b32 s20, s3, 8
    s_add_u32 s20, s20, 12800
    v_and_b32 v16, 15, v0
    v_lshlrev_b32 v16, 4, v16
    v_add_u32 v16, s20, v16
    s_waitcnt lgkmcnt(0)
    ds_read_b128 v[88:91], v16
    s_add_u32 s29, s16, 2097152
    s_waitcnt lgkmcnt(0)
    buffer_store_dwordx4 v[88:91], v10, s[4:7], s29 offen
    s_waitcnt vmcnt(0)
    s_barrier
    v_mov_b32 v16, s15
    s_add_u32 s20, s16, 2162688
    buffer_store_dword v16, v9, s[4:7], s20 offen offset:128
    s_cmp_ge_u32 s13, 22
    s_cbranch_scc1 L_P2NOFFN
    s_add_u32 s29, s16, 2162688
    s_mov_b32 s24, 0
L_P2POLLF2:
    buffer_load_dword v16, v8, s[4:7], s29 offen offset:128 sc1
    s_waitcnt vmcnt(0)
    v_cmp_gt_u32 vcc, s15, v16
    s_and_b32 vcc_hi, vcc_hi, 0
    s_cbranch_vccz L_P2OKF2
    s_add_u32 s24, s24, 1
    s_cmp_lt_u32 s24, 400000
    s_cbranch_scc1 L_P2POLLF2
    s_branch L_P2BAIL
L_P2OKF2:
    s_add_u32 s29, s16, 2097152
    s_lshl_b32 s20, s3, 13
    s_add_u32 s29, s29, s20
    s_add_u32 s23, s20, 65536
    s_mov_b32 m0, s23
    s_add_u32 s23, s23, 1024
    buffer_load_dwordx4 v1, s[4:7], s29 offen sc1 lds
    s_add_u32 s29, s29, 1024
    s_mov_b32 m0, s23
    s_add_u32 s23, s23, 1024
    buffer_load_dwordx4 v1, s[4:7], s29 offen sc1 lds
    s_add_u32 s29, s29, 1024
    s_mov_b32 m0, s23
    s_add_u32 s23, s23, 1024
    buffer_load_dwordx4 v1, s[4:7], s29 offen sc1 lds
    s_add_u32 s29, s29, 1024
    s_mov_b32 m0, s23
    s_add_u32 s23, s23, 1024
    buffer_load_dwordx4 v1, s[4:7], s29 offen sc1 lds
    s_add_u32 s29, s29, 1024
    s_mov_b32 m0, s23
    s_add_u32 s23, s23, 1024
    buffer_load_dwordx4 v1, s[4:7], s29 offen sc1 lds
    s_add_u32 s29, s29, 1024
    s_mov_b32 m0, s23
    s_add_u32 s23, s23, 1024
    buffer_load_dwordx4 v1, s[4:7], s29 offen sc1 lds
    s_add_u32 s29, s29, 1024
    s_mov_b32 m0, s23
    s_add_u32 s23, s23, 1024
    buffer_load_dwordx4 v1, s[4:7], s29 offen sc1 lds
    s_add_u32 s29, s29, 1024
    s_mov_b32 m0, s23
    s_add_u32 s23, s23, 1024
    buffer_load_dwordx4 v1, s[4:7], s29 offen sc1 lds
    s_add_u32 s29, s29, 1024
    s_waitcnt vmcnt(0)
    s_barrier
    v_add_u32 v18, 65536, v1
    ds_read_b128 v[48:51], v18 offset:0
    ds_read_b128 v[52:55], v18 offset:16384
    ds_read_b128 v[56:59], v18 offset:1024
    ds_read_b128 v[60:63], v18 offset:17408
    s_waitcnt lgkmcnt(3)
    v_mfma_f32_16x16x32_bf16 v[32:35], a[128:131], v[48:51], 0
    v_mfma_f32_16x16x32_bf16 v[36:39], a[132:135], v[48:51], 0
    ds_read_b128 v[48:51], v18 offset:2048
    s_waitcnt lgkmcnt(3)
    v_mfma_f32_16x16x32_bf16 v[40:43], a[128:131], v[52:55], 0
    v_mfma_f32_16x16x32_bf16 v[44:47], a[132:135], v[52:55], 0
    ds_read_b128 v[52:55], v18 offset:18432
    s_waitcnt lgkmcnt(3)
    v_mfma_f32_16x16x32_bf16 v[32:35], a[136:139], v[56:59], v[32:35]
    v_mfma_f32_16x16x32_bf16 v[36:39], a[140:143], v[56:59], v[36:39]
    ds_read_b128 v[56:59], v18 offset:3072
    s_waitcnt lgkmcnt(3)
    v_mfma_f32_16x16x32_bf16 v[40:43], a[136:139], v[60:63], v[40:43]
    v_mfma_f32_16x16x32_bf16 v[44:47], a[140:143], v[60:63], v[44:47]
    ds_read_b128 v[60:63], v18 offset:19456
    s_waitcnt lgkmcnt(3)
    v_mfma_f32_16x16x32_bf16 v[32:35], a[144:147], v[48:51], v[32:35]
    v_mfma_f32_16x16x32_bf16 v[36:39], a[148:151], v[48:51], v[36:39]
    ds_read_b128 v[48:51], v18 offset:4096
    s_waitcnt lgkmcnt(3)
    v_mfma_f32_16x16x32_bf16 v[40:43], a[144:147], v[52:55], v[40:43]
    v_mfma_f32_16x16x32_bf16 v[44:47], a[148:151], v[52:55], v[44:47]
    ds_read_b128 v[52:55], v18 offset:20480
    s_waitcnt lgkmcnt(3)
    v_mfma_f32_16x16x32_bf16 v[32:35], a[152:155], v[56:59], v[32:35]
    v_mfma_f32_16x16x32_bf16 v[36:39], a[156:159], v[56:59], v[36:39]
    ds_read_b128 v[56:59], v18 offset:5120
    s_waitcnt lgkmcnt(3)
    v_mfma_f32_16x16x32_bf16 v[40:43], a[152:155], v[60:63], v[40:43]
    v_mfma_f32_16x16x32_bf16 v[44:47], a[156:159], v[60:63], v[44:47]
    ds_read_b128 v[60:63], v18 offset:21504
    s_waitcnt lgkmcnt(3)
    v_mfma_f32_16x16x32_bf16 v[32:35], a[160:163], v[48:51], v[32:35]
    v_mfma_f32_16x16x32_bf16 v[36:39], a[164:167], v[48:51], v[36:39]
    ds_read_b128 v[48:51], v18 offset:6144
    s_waitcnt lgkmcnt(3)
    v_mfma_f32_16x16x32_bf16 v[40:43], a[160:163], v[52:55], v[40:43]
    v_mfma_f32_16x16x32_bf16 v[44:47], a[164:167], v[52:55], v[44:47]
    ds_read_b128 v[52:55], v18 offset:22528
    s_waitcnt lgkmcnt(3)
    v_mfma_f32_16x16x32_bf16 v[32:35], a[168:171], v[56:59], v[32:35]
    v_mfma_f32_16x16x32_bf16 v[36:39], a[172:175], v[56:59], v[36:39]
    ds_read_b128 v[56:59], v18 offset:7168
    s_waitcnt lgkmcnt(3)
    v_mfma_f32_16x16x32_bf16 v[40:43], a[168:171], v[60:63], v[40:43]
    v_mfma_f32_16x16x32_bf16 v[44:47], a[172:175], v[60:63], v[44:47]
    ds_read_b128 v[60:63], v18 offset:23552
    s_waitcnt lgkmcnt(3)
    v_mfma_f32_16x16x32_bf16 v[32:35], a[176:179], v[48:51], v[32:35]
    v_mfma_f32_16x16x32_bf16 v[36:39], a[180:183], v[48:51], v[36:39]
    ds_read_b128 v[48:51], v18 offset:8192
    s_waitcnt lgkmcnt(3)
    v_mfma_f32_16x16x32_bf16 v[40:43], a[176:179], v[52:55], v[40:43]
    v_mfma_f32_16x16x32_bf16 v[44:47], a[180:183], v[52:55], v[44:47]
    ds_read_b128 v[52:55], v18 offset:24576
    s_waitcnt lgkmcnt(3)
    v_mfma_f32_16x16x32_bf16 v[32:35], a[184:187], v[56:59], v[32:35]
    v_mfma_f32_16x16x32_bf16 v[36:39], a[188:191], v[56:59], v[36:39]
    ds_read_b128 v[56:59], v18 offset:9216
    s_waitcnt lgkmcnt(3)
    v_mfma_f32_16x16x32_bf16 v[40:43], a[184:187], v[60:63], v[40:43]
    v_mfma_f32_16x16x32_bf16 v[44:47], a[188:191], v[60:63], v[44:47]
    ds_read_b128 v[60:63], v18 offset:25600
    s_waitcnt lgkmcnt(3)
    v_mfma_f32_16x16x32_bf16 v[32:35], a[192:195], v[48:51], v[32:35]
    v_mfma_f32_16x16x32_bf16 v[36:39], a[196:199], v[48:51], v[36:39]
    ds_read_b128 v[48:51], v18 offset:10240
    s_waitcnt lgkmcnt(3)
    v_mfma_f32_16x16x32_bf16 v[40:43], a[192:195], v[52:55], v[40:43]
    v_mfma_f32_16x16x32_bf16 v[44:47], a[196:199], v[52:55], v[44:47]
    ds_read_b128 v[52:55], v18 offset:26624
    s_waitcnt lgkmcnt(3)
    v_mfma_f32_16x16x32_bf16 v[32:35], a[200:203], v[56:59], v[32:35]
    v_mfma_f32_16x16x32_bf16 v[36:39], a[204:207], v[56:59], v[36:39]
    ds_read_b128 v[56:59], v18 offset:11264
    s_waitcnt lgkmcnt(3)
    v_mfma_f32_16x16x32_bf16 v[40:43], a[200:203], v[60:63], v[40:43]
    v_mfma_f32_16x16x32_bf16 v[44:47], a[204:207], v[60:63], v[44:47]
    ds_read_b128 v[60:63], v18 offset:27648
    s_waitcnt lgkmcnt(3)
    v_mfma_f32_16x16x32_bf16 v[32:35], a[208:211], v[48:51], v[32:35]
    v_mfma_f32_16x16x32_bf16 v[36:39], a[212:215], v[48:51], v[36:39]
    ds_read_b128 v[48:51], v18 offset:12288
    s_waitcnt lgkmcnt(3)
    v_mfma_f32_16x16x32_bf16 v[40:43], a[208:211], v[52:55], v[40:43]
    v_mfma_f32_16x16x32_bf16 v[44:47], a[212:215], v[52:55], v[44:47]
    ds_read_b128 v[52:55], v18 offset:28672
    s_waitcnt lgkmcnt(3)
    v_mfma_f32_16x16x32_bf16 v[32:35], a[216:219], v[56:59], v[32:35]
    v_mfma_f32_16x16x32_bf16 v[36:39], a[220:223], v[56:59], v[36:39]
    ds_read_b128 v[56:59], v18 offset:13312
    s_waitcnt lgkmcnt(3)
    v_mfma_f32_16x16x32_bf16 v[40:43], a[216:219], v[60:63], v[40:43]
    v_mfma_f32_16x16x32_bf16 v[44:47], a[220:223], v[60:63], v[44:47]
    ds_read_b128 v[60:63], v18 offset:29696
    s_waitcnt lgkmcnt(3)
    v_mfma_f32_16x16x32_bf16 v[32:35], a[224:227], v[48:51], v[32:35]
    v_mfma_f32_16x16x32_bf16 v[36:39], a[228:231], v[48:51], v[36:39]
    ds_read_b128 v[48:51], v18 offset:14336
    s_waitcnt lgkmcnt(3)
    v_mfma_f32_16x16x32_bf16 v[40:43], a[224:227], v[52:55], v[40:43]
    v_mfma_f32_16x16x32_bf16 v[44:47], a[228:231], v[52:55], v[44:47]
    ds_read_b128 v[52:55], v18 offset:30720
    s_waitcnt lgkmcnt(3)
    v_mfma_f32_16x16x32_bf16 v[32:35], a[232:235], v[56:59], v[32:35]
    v_mfma_f32_16x16x32_bf16 v[36:39], a[236:239], v[56:59], v[36:39]
    ds_read_b128 v[56:59], v18 offset:15360
    s_waitcnt lgkmcnt(3)
    v_mfma_f32_16x16x32_bf16 v[40:43], a[232:235], v[60:63], v[40:43]
    v_mfma_f32_16x16x32_bf16 v[44:47], a[236:239], v[60:63], v[44:47]
    ds_read_b128 v[60:63], v18 offset:31744
    s_waitcnt lgkmcnt(3)
    v_mfma_f32_16x16x32_bf16 v[32:35], a[240:243], v[48:51], v[32:35]
    v_mfma_f32_16x16x32_bf16 v[36:39], a[244:247], v[48:51], v[36:39]
    s_waitcnt lgkmcnt(2)
    v_mfma_f32_16x16x32_bf16 v[40:43], a[240:243], v[52:55], v[40:43]
    v_mfma_f32_16x16x32_bf16 v[44:47], a[244:247], v[52:55], v[44:47]
    s_waitcnt lgkmcnt(1)
    v_mfma_f32_16x16x32_bf16 v[32:35], a[248:251], v[56:59], v[32:35]
    v_mfma_f32_16x16x32_bf16 v[36:39], a[252:255], v[56:59], v[36:39]
    s_waitcnt lgkmcnt(0)
    v_mfma_f32_16x16x32_bf16 v[40:43], a[248:251], v[60:63], v[40:43]
    v_mfma_f32_16x16x32_bf16 v[44:47], a[252:255], v[60:63], v[44:47]
    s_nop 4
    v_pk_mul_f32 v[32:33], v[32:33], v[36:37]
    v_pk_mul_f32 v[34:35], v[34:35], v[38:39]
    v_cvt_pk_bf16_f32 v48, v32, v33
    v_cvt_pk_bf16_f32 v49, v34, v35
    ds_write_b64 v12, v[48:49] offset:0
    v_pk_mul_f32 v[40:41], v[40:41], v[44:45]
    v_pk_mul_f32 v[42:43], v[42:43], v[46:47]
    v_cvt_pk_bf16_f32 v50, v40, v41
    v_cvt_pk_bf16_f32 v51, v42, v43
    ds_write_b64 v12, v[50:51] offset:2048
    s_waitcnt lgkmcnt(0)
    s_barrier
    v_lshlrev_b32 v18, 3, v0
    ds_read_b64 v[32:33], v18 offset:8192
    ds_read_b64 v[34:35], v18 offset:8704
    ds_read_b64 v[36:37], v18 offset:9216
    ds_read_b64 v[38:39], v18 offset:9728
    ds_read_b64 v[40:41], v18 offset:10240
    ds_read_b64 v[42:43], v18 offset:10752
    ds_read_b64 v[44:45], v18 offset:11264
    ds_read_b64 v[46:47], v18 offset:11776
    s_add_u32 s29, s16, 1048576
    s_waitcnt lgkmcnt(6)
    v_mfma_f32_16x16x32_bf16 v[64:67], v[192:195], v[32:35], 0
    v_mfma_f32_16x16x32_bf16 v[68:71], v[200:203], v[32:35], 0
    v_mfma_f32_16x16x32_bf16 v[72:75], v[208:211], v[32:35], 0
    v_mfma_f32_16x16x32_bf16 v[76:79], v[216:219], v[32:35], 0
    v_mfma_f32_16x16x32_bf16 v[80:83], v[224:227], v[32:35], 0
    v_mfma_f32_16x16x32_bf16 v[84:87], v[232:235], v[32:35], 0
    v_mfma_f32_16x16x32_bf16 v[88:91], v[240:243], v[32:35], 0
    v_mfma_f32_16x16x32_bf16 v[92:95], v[248:251], v[32:35], 0
    s_waitcnt lgkmcnt(4)
    v_mfma_f32_16x16x32_bf16 v[64:67], v[196:199], v[36:39], v[64:67]
    v_mfma_f32_16x16x32_bf16 v[68:71], v[204:207], v[36:39], v[68:71]
    v_mfma_f32_16x16x32_bf16 v[72:75], v[212:215], v[36:39], v[72:75]
    v_mfma_f32_16x16x32_bf16 v[76:79], v[220:223], v[36:39], v[76:79]
    v_mfma_f32_16x16x32_bf16 v[80:83], v[228:231], v[36:39], v[80:83]
    v_mfma_f32_16x16x32_bf16 v[84:87], v[236:239], v[36:39], v[84:87]
    v_mfma_f32_16x16x32_bf16 v[88:91], v[244:247], v[36:39], v[88:91]
    v_mfma_f32_16x16x32_bf16 v[92:95], v[252:255], v[36:39], v[92:95]
    s_waitcnt lgkmcnt(2)
    v_mfma_f32_16x16x32_bf16 v[96:99], v[192:195], v[40:43], 0
    v_mfma_f32_16x16x32_bf16 v[100:103], v[200:203], v[40:43], 0
    v_mfma_f32_16x16x32_bf16 v[104:107], v[208:211], v[40:43], 0
    v_mfma_f32_16x16x32_bf16 v[108:111], v[216:219], v[40:43], 0
    v_cvt_pk_bf16_f32 v128, v64, v65
    v_cvt_pk_bf16_f32 v129, v66, v67
    v_cvt_pk_bf16_f32 v130, v68, v69
    v_mfma_f32_16x16x32_bf16 v[112:115], v[224:227], v[40:43], 0
    v_cvt_pk_bf16_f32 v131, v70, v71
    ds_write_b128 v3, v[128:131] offset:0
    v_cvt_pk_bf16_f32 v132, v72, v73
    v_mfma_f32_16x16x32_bf16 v[116:119], v[232:235], v[40:43], 0
    v_cvt_pk_bf16_f32 v133, v74, v75
    v_cvt_pk_bf16_f32 v134, v76, v77
    v_cvt_pk_bf16_f32 v135, v78, v79
    v_mfma_f32_16x16x32_bf16 v[120:123], v[240:243], v[40:43], 0
    ds_write_b128 v3, v[132:135] offset:64
    v_cvt_pk_bf16_f32 v136, v80, v81
    v_cvt_pk_bf16_f32 v137, v82, v83
    v_mfma_f32_16x16x32_bf16 v[124:127], v[248:251], v[40:43], 0
    v_cvt_pk_bf16_f32 v138, v84, v85
    v_cvt_pk_bf16_f32 v139, v86, v87
    ds_write_b128 v3, v[136:139] offset:128
    s_waitcnt lgkmcnt(3)
    v_mfma_f32_16x16x32_bf16 v[96:99], v[196:199], v[44:47], v[96:99]
    v_cvt_pk_bf16_f32 v140, v88, v89
    v_cvt_pk_bf16_f32 v141, v90, v91
    v_cvt_pk_bf16_f32 v142, v92, v93
    v_mfma_f32_16x16x32_bf16 v[100:103], v[204:207], v[44:47], v[100:103]
    v_cvt_pk_bf16_f32 v143, v94, v95
    ds_write_b128 v3, v[140:143] offset:192
    ds_read_b128 v[128:131], v4 offset:0
    v_mfma_f32_16x16x32_bf16 v[104:107], v[212:215], v[44:47], v[104:107]
    ds_read_b128 v[132:135], v4 offset:1088
    ds_read_b128 v[136:139], v4 offset:2176
    ds_read_b128 v[140:143], v4 offset:3264
    v_mfma_f32_16x16x32_bf16 v[108:111], v[220:223], v[44:47], v[108:111]
    s_waitcnt lgkmcnt(3)
    buffer_store_dwordx4 v[128:131], v6, s[4:7], s29 offen
    s_add_u32 s29, s29, 131072
    s_waitcnt lgkmcnt(2)
    buffer_store_dwordx4 v[132:135], v6, s[4:7], s29 offen
    s_add_u32 s29, s29, 131072
    s_waitcnt lgkmcnt(1)
    buffer_store_dwordx4 v[136:139], v6, s[4:7], s29 offen
    s_add_u32 s29, s29, 131072
    v_mfma_f32_16x16x32_bf16 v[112:115], v[228:231], v[44:47], v[112:115]
    s_waitcnt lgkmcnt(0)
    buffer_store_dwordx4 v[140:143], v6, s[4:7], s29 offen
    s_add_u32 s29, s29, 131072
    v_mfma_f32_16x16x32_bf16 v[116:119], v[236:239], v[44:47], v[116:119]
    v_mfma_f32_16x16x32_bf16 v[120:123], v[244:247], v[44:47], v[120:123]
    v_mfma_f32_16x16x32_bf16 v[124:127], v[252:255], v[44:47], v[124:127]
    v_cvt_pk_bf16_f32 v144, v96, v97
    v_cvt_pk_bf16_f32 v145, v98, v99
    v_cvt_pk_bf16_f32 v146, v100, v101
    v_cvt_pk_bf16_f32 v147, v102, v103
    ds_write_b128 v3, v[144:147] offset:4352
    v_cvt_pk_bf16_f32 v148, v104, v105
    v_cvt_pk_bf16_f32 v149, v106, v107
    v_cvt_pk_bf16_f32 v150, v108, v109
    v_cvt_pk_bf16_f32 v151, v110, v111
    ds_write_b128 v3, v[148:151] offset:4416
    v_cvt_pk_bf16_f32 v152, v112, v113
    v_cvt_pk_bf16_f32 v153, v114, v115
    v_cvt_pk_bf16_f32 v154, v116, v117
    v_cvt_pk_bf16_f32 v155, v118, v119
    ds_write_b128 v3, v[152:155] offset:4480
    v_cvt_pk_bf16_f32 v156, v120, v121
    v_cvt_pk_bf16_f32 v157, v122, v123
    v_cvt_pk_bf16_f32 v158, v124, v125
    v_cvt_pk_bf16_f32 v159, v126, v127
    ds_write_b128 v3, v[156:159] offset:4544
    ds_read_b128 v[144:147], v4 offset:4352
    ds_read_b128 v[148:151], v4 offset:5440
    ds_read_b128 v[152:155], v4 offset:6528
    ds_read_b128 v[156:159], v4 offset:7616
    s_waitcnt lgkmcnt(3)
    buffer_store_dwordx4 v[144:147], v6, s[4:7], s29 offen
    s_add_u32 s29, s29, 131072
    s_waitcnt lgkmcnt(2)
    buffer_store_dwordx4 v[148:151], v6, s[4:7], s29 offen
    s_add_u32 s29, s29, 131072
    s_waitcnt lgkmcnt(1)
    buffer_store_dwordx4 v[152:155], v6, s[4:7], s29 offen
    s_add_u32 s29, s29, 131072
    s_waitcnt lgkmcnt(0)
    buffer_store_dwordx4 v[156:159], v6, s[4:7], s29 offen
    s_waitcnt vmcnt(0)
    s_barrier
    v_mov_b32 v16, s15
    s_add_u32 s20, s16, 2162688
    buffer_store_dword v16, v9, s[4:7], s20 offen offset:256
L_P2NOFFN:
    s_add_u32 s29, s16, 2162688
    s_mov_b32 s24, 0
L_P2POLLF3:
    buffer_load_dword v16, v8, s[4:7], s29 offen offset:256 sc1
    s_waitcnt vmcnt(0)
    v_cmp_gt_u32 vcc, s15, v16
    s_and_b32 vcc_hi, vcc_hi, 0
    s_and_b32 vcc_lo, vcc_lo, 0x3fffff
    s_cbranch_vccz L_P2OKF3
    s_add_u32 s24, s24, 1
    s_cmp_lt_u32 s24, 400000
    s_cbranch_scc1 L_P2POLLF3
    s_branch L_P2BAIL
L_P2OKF3:
    s_add_u32 s29, s16, 1048576
    buffer_load_dwordx4 v[32:35], v5, s[4:7], s29 offen sc1
    s_add_u32 s29, s29, 4096
    buffer_load_dwordx4 v[36:39], v5, s[4:7], s29 offen sc1
    s_add_u32 s29, s29, 4096
    buffer_load_dwordx4 v[40:43], v5, s[4:7], s29 offen sc1
    s_add_u32 s29, s29, 4096
    buffer_load_dwordx4 v[44:47], v5, s[4:7], s29 offen sc1
    s_add_u32 s29, s29, 4096
    buffer_load_dwordx4 v[48:51], v5, s[4:7], s29 offen sc1
    s_add_u32 s29, s29, 4096
    buffer_load_dwordx4 v[52:55], v14, s[4:7], s29 offen sc1
    s_waitcnt vmcnt(5)
    v_mfma_f32_16x16x32_bf16 v[24:27], v[32:35], v[20:23], v[24:27]
    s_waitcnt vmcnt(4)
    v_mfma_f32_16x16x32_bf16 v[24:27], v[36:39], v[20:23], v[24:27]
    s_waitcnt vmcnt(3)
    v_mfma_f32_16x16x32_bf16 v[24:27], v[40:43], v[20:23], v[24:27]
    s_waitcnt vmcnt(2)
    v_mfma_f32_16x16x32_bf16 v[24:27], v[44:47], v[20:23], v[24:27]
    s_waitcnt vmcnt(1)
    v_mfma_f32_16x16x32_bf16 v[24:27], v[48:51], v[20:23], v[24:27]
    s_waitcnt vmcnt(0)
    v_mfma_f32_16x16x32_bf16 v[24:27], v[52:55], v[20:23], v[24:27]
    s_nop 7
    v_cvt_pk_bf16_f32 v88, v24, v24
    ds_write_b16 v7, v88 offset:0
    v_cvt_pk_bf16_f32 v89, v25, v25
    ds_write_b16 v7, v89 offset:16
    v_cvt_pk_bf16_f32 v90, v26, v26
    ds_write_b16 v7, v90 offset:32
    v_cvt_pk_bf16_f32 v91, v27, v27
    ds_write_b16 v7, v91 offset:48
    s_lshl_b32 s20, s3, 8
    s_add_u32 s20, s20, 12800
    v_and_b32 v16, 15, v0
    v_lshlrev_b32 v16, 4, v16
    v_add_u32 v16, s20, v16
    s_waitcnt lgkmcnt(0)
    ds_read_b128 v[88:91], v16
    s_waitcnt lgkmcnt(0)
    buffer_store_dwordx4 v[88:91], v13, s[40:43], s28 offen
    s_add_u32 s14, s14, 7
    s_add_u32 s15, s15, 1
    s_cmp_lt_u32 s14, 64
    s_cbranch_scc1 L_P2SEG
    s_waitcnt vmcnt(0)
    s_endpgm
L_P2BAIL:
    s_load_dwordx2 s[30:31], s[0:1], 96
    v_mov_b32 v16, 0x200
    v_or_b32 v16, s14, v16
    v_mov_b32 v17, 212
    s_waitcnt lgkmcnt(0)
    global_store_dword v17, v16, s[30:31]
    s_waitcnt vmcnt(0)
    s_endpgm
L_GBAIL:
L_EXIT:
    s_endpgm
.section .rodata,"a"
.p2align 6
.amdhsa_kernel sequential_preLN__memory_aug_recurrent_mem_tr__glu_gated_bilinear__prompt_kernel
  .amdhsa_next_free_vgpr 512
  .amdhsa_next_free_sgpr 102
  .amdhsa_accum_offset 256
  .amdhsa_group_segment_fixed_size 0
  .amdhsa_kernarg_size 112
  .amdhsa_user_sgpr_count 2
  .amdhsa_user_sgpr_kernarg_segment_ptr 1
  .amdhsa_system_sgpr_workgroup_id_x 1
.end_amdhsa_kernel
```
